```python
import torch

def _softmax(x, axis=-1):
    return torch.softmax(x, dim=axis)

def _gelu(x):
    return torch.nn.functional.gelu(x, approximate='tanh')

def _silu(x):
    return torch.nn.functional.silu(x)

def _sigmoid(x):
    return torch.sigmoid(x)

def _layernorm(x, axis=-1, eps=1e-05):
    m = x.mean(dim=axis, keepdim=True)
    v = x.var(dim=axis, keepdim=True, unbiased=False)
    return (x - m) / torch.sqrt(v + eps)

def _scatter_add(tgt, idx, src, axis=0):
    return tgt.clone().index_add_(axis, idx, src)

def _segment_sum(src, seg, n):
    out = torch.zeros((n,) + src.shape[1:], dtype=src.dtype)
    return out.index_add_(0, seg, src)

def _pad(x, pw):
    flat = tuple((v for pair in reversed(pw) for v in pair))
    return torch.nn.functional.pad(x, flat)
kernel_name = 'adaLN_cond__spectral_gfnet__glu_gated_reglu__prompt'

def setup_inputs():

    _w = lambda a: (lambda t: t.to(torch.bfloat16) if t.is_floating_point() else t)(torch.as_tensor(a))

    def _A_setup():
        B, S, D = (1, 2048, 448)
        Df = D // 2 + 1
        return {'x': _w((lambda *s: torch.randn(*s, dtype=torch.bfloat16) * 0.05)(B, S, D)), 'w_r': _w((lambda *s: torch.randn(*s, dtype=torch.bfloat16) * 3.2)(S, Df) * 0.02), 'w_i': _w((lambda *s: torch.randn(*s, dtype=torch.bfloat16) * 3.2)(S, Df) * 0.02)}
    _A_in = _A_setup()

    def _B_setup():
        B, S, D, F = (1, 2048, 448, 1792)
        return {'x': _w((lambda *s: torch.randn(*s, dtype=torch.bfloat16) * 0.05)(B, S, D)), 'W_gate': _w((lambda *s: torch.randn(*s, dtype=torch.bfloat16) * 0.4)(D, F) * (2.0 / D) ** 0.5), 'W_up': _w((lambda *s: torch.randn(*s, dtype=torch.bfloat16) * 0.4)(D, F) * (2.0 / D) ** 0.5), 'W_down': _w((lambda *s: torch.randn(*s, dtype=torch.bfloat16) * 0.4)(F, D) * (1.0 / F) ** 0.5)}
    _B_in = _B_setup()
    return {'A_x': _A_in['x'], 'A_w_r': _A_in['w_r'], 'A_w_i': _A_in['w_i'], 'B_x': _B_in['x'], 'B_W_gate': _B_in['W_gate'], 'B_W_up': _B_in['W_up'], 'B_W_down': _B_in['W_down'], 'c': _w((lambda *s: torch.randn(*s, dtype=torch.bfloat16) * 0.1)(1, 448) * 8.0), 'w_mod': _w((lambda *s: torch.randn(*s, dtype=torch.bfloat16) * 0.1)(448, 6 * 448) * 448 ** (-0.5) * 8.0)}

def reference(A_x, A_w_r, A_w_i, B_x, B_W_gate, B_W_up, B_W_down, c, w_mod):

    def _A_ref(x, w_r, w_i):
        B, S, D = x.shape
        X = (lambda x, axes=(-2, -1): torch.fft.rfft2(x.float(), dim=axes))(x, axes=(-2, -1))
        W = w_r + 1j * w_i
        X = X * W
        y = (lambda x, s, axes=(-2, -1): torch.fft.irfft2(x, s=s, dim=axes).to(torch.bfloat16))(X, (S, D), axes=(-2, -1))
        return y

    def _B_ref(x, W_gate, W_up, W_down):
        gate = torch.einsum('bsd,df->bsf', x, W_gate)
        up = torch.einsum('bsd,df->bsf', x, W_up)
        gate = gate * (lambda x, dt: x.to(dt))(gate > 0, gate.dtype)
        h = gate * up
        return torch.einsum('bsf,fd->bsd', h, W_down)
    x = A_x
    mod = (_silu(c) @ w_mod).reshape(c.shape[0], 6, 1, -1)
    sa, ca, ga, sb, cb, gb = (mod[:, 0].clone(), mod[:, 1].clone(), mod[:, 2].clone(), mod[:, 3].clone(), mod[:, 4].clone(), mod[:, 5].clone())
    h = _layernorm(x, axis=-1) * (1 + ca) + sa
    x = x + ga * _A_ref(h, A_w_r, A_w_i)
    h = _layernorm(x, axis=-1) * (1 + cb) + sb
    x = x + gb * _B_ref(h, B_W_gate, B_W_up, B_W_down)
    return x
```

```asm
; @launch grid=(256,1,1) block=(256,1,1) lds=163840
.amdgcn_target "amdgcn-amd-amdhsa--gfx950"
.text
.p2align 8
.type L_mt,@object
L_mt:
    .long 0x3f803f80,0x3f803f80,0x3f803f80,0x3f803f80,0x3f7f3f80,0x3f753f7b,0xbdc90000,0xbe95be48
    .long 0x3f7b3f80,0x3f553f6d,0xbf7bbf80,0xbf55bf6d,0x3f753f80,0x3f223f55,0x3e950000,0x3f463f0e
    .long 0x3f6d3f80,0x3ec43f35,0x3f6d3f80,0x3ec43f35,0x3f623f80,0x3dc93f0e,0xbef10000,0xbf7fbf55
    .long 0x3f553f80,0xbe483ec4,0xbf55bf80,0x3e48bec4,0x3f463f80,0xbef13e48,0x3f220000,0x3f623f7b
    .long 0x3f353f80,0xbf350000,0x3f353f80,0xbf350000,0x3f223f80,0xbf62be48,0xbf460000,0xbef1bf7b
    .long 0x3f0e3f80,0xbf7bbec4,0xbf0ebf80,0x3f7b3ec4,0x3ef13f80,0xbf7fbf0e,0x3f620000,0xbdc93f55
    .long 0x3ec43f80,0xbf6dbf35,0x3ec43f80,0xbf6dbf35,0x3e953f80,0xbf46bf55,0xbf750000,0x3f22bf0e
    .long 0x3e483f80,0xbf0ebf6d,0xbe48bf80,0x3f0e3f6d,0x3dc93f80,0xbe95bf7b,0x3f7f0000,0xbf753e48
    .long 0x3f803f80,0x3f803f80,0x3f803f80,0x3f803f80,0x3f623f6d,0x3f463f55,0xbef1bec4,0xbf22bf0e
    .long 0x3f0e3f35,0x3e483ec4,0xbf0ebf35,0xbe48bec4,0x3dc93ec4,0xbef1be48,0x3f7f3f6d,0x3f623f7b
    .long 0xbec40000,0xbf6dbf35,0xbec40000,0xbf6dbf35,0xbf46bec4,0xbf75bf7b,0xbf22bf6d,0x3e95be48
    .long 0xbf7bbf35,0xbf0ebf6d,0x3f7b3f35,0x3f0e3f6d,0xbf75bf6d,0x3dc9bf0e,0xbe953ec4,0xbf7fbf55
    .long 0xbf35bf80,0x3f350000,0xbf35bf80,0x3f350000,0xbe95bf6d,0x3f7f3f0e,0x3f753ec4,0x3dc93f55
    .long 0x3e48bf35,0x3f553f6d,0xbe483f35,0xbf55bf6d,0x3f22bec4,0x3e953f7b,0xbf46bf6d,0x3f753e48
    .long 0x3f6d0000,0xbec43f35,0x3f6d0000,0xbec43f35,0x3f7f3ec4,0xbf623e48,0xbdc93f6d,0xbef1bf7b
    .long 0x3f553f35,0xbf7bbec4,0xbf55bf35,0x3f7b3ec4,0x3ef13f6d,0xbf22bf55,0x3f62bec4,0xbf463f0e
    .long 0x3f803f80,0x3f803f80,0x3f803f80,0x3f803f80,0x3f223f35,0x3ef13f0e,0xbf46bf35,0xbf62bf55
    .long 0xbe480000,0xbf0ebec4,0x3e480000,0x3f0e3ec4,0xbf62bf35,0xbf7fbf7b,0x3ef13f35,0xbdc93e48
    .long 0xbf6dbf80,0xbec4bf35,0xbf6dbf80,0xbec4bf35,0xbe95bf35,0x3f223e48,0x3f753f35,0x3f463f7b
    .long 0x3f0e0000,0x3f7b3f6d,0xbf0e0000,0xbf7bbf6d,0x3f7f3f35,0x3e953f55,0xbdc9bf35,0x3f753f0e
    .long 0x3f353f80,0xbf350000,0x3f353f80,0xbf350000,0xbdc93f35,0xbf75bf55,0xbf7fbf35,0x3e95bf0e
    .long 0xbf550000,0xbe48bf6d,0x3f550000,0x3e483f6d,0xbf75bf35,0x3f46be48,0xbe953f35,0xbf22bf7b
    .long 0xbec4bf80,0x3f6d3f35,0xbec4bf80,0x3f6d3f35,0x3ef1bf35,0x3dc93f7b,0x3f623f35,0xbf7fbe48
    .long 0x3f7b0000,0xbf553ec4,0xbf7b0000,0x3f55bec4,0x3f463f35,0xbf62bf0e,0x3f22bf35,0xbef13f55
    .long 0x3f803f80,0x3f803f80,0x3f803f80,0x3f803f80,0x3e953ec4,0x3dc93e48,0xbf75bf6d,0xbf7fbf7b
    .long 0xbf55bf35,0xbf7bbf6d,0x3f553f35,0x3f7b3f6d,0xbf46bf6d,0xbe95bf0e,0xbf22bec4,0xbf75bf55
    .long 0x3ec40000,0x3f6d3f35,0x3ec40000,0x3f6d3f35,0x3f7f3f6d,0x3ef13f55,0xbdc93ec4,0xbf62bf0e
    .long 0x3e483f35,0xbf55bec4,0xbe48bf35,0x3f553ec4,0xbf62bec4,0xbf22bf7b,0x3ef13f6d,0xbf46be48
    .long 0xbf35bf80,0x3f350000,0xbf35bf80,0x3f350000,0x3ef1bec4,0x3f463f7b,0x3f623f6d,0xbf223e48
    .long 0x3f7b3f35,0xbf0e3ec4,0xbf7bbf35,0x3f0ebec4,0x3dc93f6d,0xbf62bf55,0x3f7f3ec4,0xbef13f0e
    .long 0xbf6d0000,0x3ec4bf35,0xbf6d0000,0x3ec4bf35,0xbf22bf6d,0x3f753f0e,0x3f46bec4,0xbe953f55
    .long 0x3f0ebf35,0xbe483f6d,0xbf0e3f35,0x3e48bf6d,0x3f753ec4,0xbf7fbe48,0x3e95bf6d,0xbdc93f7b
    .long 0xbf803f80,0xbf803f80,0xbf803f80,0xbf803f80,0xbdc98000,0xbe95be48,0xbf7fbf80,0xbf75bf7b
    .long 0xbe488000,0xbf0ebec4,0x3e488000,0x3f0e3ec4,0xbe958000,0xbf46bf0e,0x3f753f80,0x3f223f55
    .long 0xbec48000,0xbf6dbf35,0xbec48000,0xbf6dbf35,0xbef18000,0xbf7fbf55,0xbf62bf80,0xbdc9bf0e
    .long 0xbf0e8000,0xbf7bbf6d,0x3f0e8000,0x3f7b3f6d,0xbf228000,0xbf62bf7b,0x3f463f80,0xbef13e48
    .long 0xbf358000,0xbf35bf80,0xbf358000,0xbf35bf80,0xbf468000,0xbef1bf7b,0xbf22bf80,0x3f623e48
    .long 0xbf558000,0xbe48bf6d,0x3f558000,0x3e483f6d,0xbf628000,0x3dc9bf55,0x3ef13f80,0xbf7fbf0e
    .long 0xbf6d8000,0x3ec4bf35,0xbf6d8000,0x3ec4bf35,0xbf758000,0x3f22bf0e,0xbe95bf80,0x3f463f55
    .long 0xbf7b8000,0x3f55bec4,0x3f7b8000,0xbf553ec4,0xbf7f8000,0x3f75be48,0x3dc93f80,0xbe95bf7b
    .long 0xbf803f80,0xbf803f80,0xbf803f80,0xbf803f80,0xbef1bec4,0xbf22bf0e,0xbf62bf6d,0xbf46bf55
    .long 0xbf55bf35,0xbf7bbf6d,0x3f553f35,0x3f7b3f6d,0xbf7fbf6d,0xbf62bf7b,0x3dc93ec4,0xbef1be48
    .long 0xbf6dbf80,0xbec4bf35,0xbf6dbf80,0xbec4bf35,0xbf22bf6d,0x3e95be48,0x3f463ec4,0x3f753f7b
    .long 0xbe48bf35,0x3f553ec4,0x3e483f35,0xbf55bec4,0x3e95bec4,0x3f7f3f55,0xbf75bf6d,0x3dc9bf0e
    .long 0x3f358000,0x3f353f80,0x3f358000,0x3f353f80,0x3f753ec4,0x3dc93f55,0x3e953f6d,0xbf7fbf0e
    .long 0x3f7b3f35,0xbf0e3ec4,0xbf7bbf35,0x3f0ebec4,0x3f463f6d,0xbf75be48,0x3f22bec4,0x3e953f7b
    .long 0x3ec43f80,0xbf6dbf35,0x3ec43f80,0xbf6dbf35,0xbdc93f6d,0xbef1bf7b,0xbf7fbec4,0x3f62be48
    .long 0xbf0e3f35,0x3e48bf6d,0x3f0ebf35,0xbe483f6d,0xbf623ec4,0x3f46bf0e,0x3ef13f6d,0xbf22bf55
    .long 0xbf803f80,0xbf803f80,0xbf803f80,0xbf803f80,0xbf46bf35,0xbf62bf55,0xbf22bf35,0xbef1bf0e
    .long 0xbf7bbf80,0xbf55bf6d,0x3f7b3f80,0x3f553f6d,0xbef1bf35,0x3dc9be48,0xbf62bf35,0xbf7fbf7b
    .long 0x3ec48000,0x3f6d3f35,0x3ec48000,0x3f6d3f35,0x3f753f35,0x3f463f7b,0x3e953f35,0xbf22be48
    .long 0x3f553f80,0xbe483ec4,0xbf55bf80,0x3e48bec4,0x3dc93f35,0xbf75bf0e,0x3f7f3f35,0x3e953f55
    .long 0xbf358000,0xbf35bf80,0xbf358000,0xbf35bf80,0xbf7fbf35,0x3e95bf0e,0x3dc9bf35,0x3f753f55
    .long 0xbf0ebf80,0x3f7b3ec4,0x3f0e3f80,0xbf7bbec4,0x3e95bf35,0x3f223f7b,0xbf75bf35,0x3f46be48
    .long 0x3f6d8000,0xbec43f35,0x3f6d8000,0xbec43f35,0x3f623f35,0xbf7fbe48,0xbef13f35,0xbdc9bf7b
    .long 0x3e483f80,0xbf0ebf6d,0xbe48bf80,0x3f0e3f6d,0xbf223f35,0x3ef1bf55,0x3f463f35,0xbf62bf0e
    .long 0xbf803f80,0xbf803f80,0xbf803f80,0xbf803f80,0xbf75bf6d,0xbf7fbf7b,0xbe95bec4,0xbdc9be48
    .long 0xbf0ebf35,0xbe48bec4,0x3f0e3f35,0x3e483ec4,0x3f223ec4,0x3f753f55,0xbf46bf6d,0xbe95bf0e
    .long 0x3f6d3f80,0x3ec43f35,0x3f6d3f80,0x3ec43f35,0xbdc93ec4,0xbf62bf0e,0xbf7fbf6d,0xbef1bf55
    .long 0xbf7bbf35,0xbf0ebf6d,0x3f7b3f35,0x3f0e3f6d,0xbef1bf6d,0x3f463e48,0xbf62bec4,0xbf22bf7b
    .long 0x3f358000,0x3f353f80,0x3f358000,0x3f353f80,0x3f623f6d,0xbf223e48,0xbef13ec4,0xbf46bf7b
    .long 0xbe483f35,0xbf55bf6d,0x3e48bf35,0x3f553f6d,0xbf7fbec4,0x3ef1bf0e,0x3dc93f6d,0xbf62bf55
    .long 0xbec4bf80,0x3f6d3f35,0xbec4bf80,0x3f6d3f35,0x3f46bec4,0xbe953f55,0x3f223f6d,0xbf75bf0e
    .long 0x3f553f35,0xbf7bbec4,0xbf55bf35,0x3f7b3ec4,0xbe953f6d,0x3dc9bf7b,0x3f753ec4,0xbf7fbe48
    .long 0x3f80,0xbf80,0x3f80,0xbf80,0xbdc93f80,0x3e95bf7b,0xbf7f0000,0x3f753e48
    .long 0xbe483f80,0x3f0ebf6d,0x3e48bf80,0xbf0e3f6d,0xbe953f80,0x3f46bf55,0x3f750000,0xbf22bf0e
    .long 0xbec43f80,0x3f6dbf35,0xbec43f80,0x3f6dbf35,0xbef13f80,0x3f7fbf0e,0xbf620000,0x3dc93f55
    .long 0xbf0e3f80,0x3f7bbec4,0x3f0ebf80,0xbf7b3ec4,0xbf223f80,0x3f62be48,0x3f460000,0x3ef1bf7b
    .long 0xbf353f80,0x3f350000,0xbf353f80,0x3f350000,0xbf463f80,0x3ef13e48,0xbf220000,0xbf623f7b
    .long 0xbf553f80,0x3e483ec4,0x3f55bf80,0xbe48bec4,0xbf623f80,0xbdc93f0e,0x3ef10000,0x3f7fbf55
    .long 0xbf6d3f80,0xbec43f35,0xbf6d3f80,0xbec43f35,0xbf753f80,0xbf223f55,0xbe950000,0xbf463f0e
    .long 0xbf7b3f80,0xbf553f6d,0x3f7bbf80,0x3f55bf6d,0xbf7f3f80,0xbf753f7b,0x3dc90000,0x3e95be48
    .long 0x3f80,0xbf80,0x3f80,0xbf80,0xbef13f6d,0x3f22bf55,0xbf62bec4,0x3f463f0e
    .long 0xbf553f35,0x3f7bbec4,0x3f55bf35,0xbf7b3ec4,0xbf7f3ec4,0x3f623e48,0x3dc93f6d,0x3ef1bf7b
    .long 0xbf6d0000,0x3ec43f35,0xbf6d0000,0x3ec43f35,0xbf22bec4,0xbe953f7b,0x3f46bf6d,0xbf753e48
    .long 0xbe48bf35,0xbf553f6d,0x3e483f35,0x3f55bf6d,0x3e95bf6d,0xbf7f3f0e,0xbf753ec4,0xbdc93f55
    .long 0x3f35bf80,0xbf350000,0x3f35bf80,0xbf350000,0x3f75bf6d,0xbdc9bf0e,0x3e953ec4,0x3f7fbf55
    .long 0x3f7bbf35,0x3f0ebf6d,0xbf7b3f35,0xbf0e3f6d,0x3f46bec4,0x3f75bf7b,0x3f22bf6d,0xbe95be48
    .long 0x3ec40000,0x3f6dbf35,0x3ec40000,0x3f6dbf35,0xbdc93ec4,0x3ef1be48,0xbf7f3f6d,0xbf623f7b
    .long 0xbf0e3f35,0xbe483ec4,0x3f0ebf35,0x3e48bec4,0xbf623f6d,0xbf463f55,0x3ef1bec4,0x3f22bf0e
    .long 0x3f80,0xbf80,0x3f80,0xbf80,0xbf463f35,0x3f62bf0e,0xbf22bf35,0x3ef13f55
    .long 0xbf7b0000,0x3f553ec4,0x3f7b0000,0xbf55bec4,0xbef1bf35,0xbdc93f7b,0xbf623f35,0x3f7fbe48
    .long 0x3ec4bf80,0xbf6d3f35,0x3ec4bf80,0xbf6d3f35,0x3f75bf35,0xbf46be48,0x3e953f35,0x3f22bf7b
    .long 0x3f550000,0x3e48bf6d,0xbf550000,0xbe483f6d,0x3dc93f35,0x3f75bf55,0x3f7fbf35,0xbe95bf0e
    .long 0xbf353f80,0x3f350000,0xbf353f80,0x3f350000,0xbf7f3f35,0xbe953f55,0x3dc9bf35,0xbf753f0e
    .long 0xbf0e0000,0xbf7b3f6d,0x3f0e0000,0x3f7bbf6d,0x3e95bf35,0xbf223e48,0xbf753f35,0xbf463f7b
    .long 0x3f6dbf80,0x3ec4bf35,0x3f6dbf80,0x3ec4bf35,0x3f62bf35,0x3f7fbf7b,0xbef13f35,0x3dc93e48
    .long 0x3e480000,0x3f0ebec4,0xbe480000,0xbf0e3ec4,0xbf223f35,0xbef13f0e,0x3f46bf35,0x3f62bf55
    .long 0x3f80,0xbf80,0x3f80,0xbf80,0xbf753ec4,0x3f7fbe48,0xbe95bf6d,0x3dc93f7b
    .long 0xbf0ebf35,0x3e483f6d,0x3f0e3f35,0xbe48bf6d,0x3f22bf6d,0xbf753f0e,0xbf46bec4,0x3e953f55
    .long 0x3f6d0000,0xbec4bf35,0x3f6d0000,0xbec4bf35,0xbdc93f6d,0x3f62bf55,0xbf7f3ec4,0x3ef13f0e
    .long 0xbf7b3f35,0x3f0e3ec4,0x3f7bbf35,0xbf0ebec4,0xbef1bec4,0xbf463f7b,0xbf623f6d,0x3f223e48
    .long 0x3f35bf80,0xbf350000,0x3f35bf80,0xbf350000,0x3f62bec4,0x3f22bf7b,0xbef13f6d,0x3f46be48
    .long 0xbe483f35,0x3f55bec4,0x3e48bf35,0xbf553ec4,0xbf7f3f6d,0xbef13f55,0x3dc93ec4,0x3f62bf0e
    .long 0xbec40000,0xbf6d3f35,0xbec40000,0xbf6d3f35,0x3f46bf6d,0x3e95bf0e,0x3f22bec4,0x3f75bf55
    .long 0x3f55bf35,0x3f7bbf6d,0xbf553f35,0xbf7b3f6d,0xbe953ec4,0xbdc93e48,0x3f75bf6d,0x3f7fbf7b
    .long 0xbf808000,0x3f808000,0xbf808000,0x3f808000,0xbf7f8000,0x3f753e48,0x3dc9bf80,0xbe953f7b
    .long 0xbf7b8000,0x3f553ec4,0x3f7b8000,0xbf55bec4,0xbf758000,0x3f223f0e,0xbe953f80,0x3f46bf55
    .long 0xbf6d8000,0x3ec43f35,0xbf6d8000,0x3ec43f35,0xbf628000,0x3dc93f55,0x3ef1bf80,0xbf7f3f0e
    .long 0xbf558000,0xbe483f6d,0x3f558000,0x3e48bf6d,0xbf468000,0xbef13f7b,0xbf223f80,0x3f62be48
    .long 0xbf358000,0xbf353f80,0xbf358000,0xbf353f80,0xbf228000,0xbf623f7b,0x3f46bf80,0xbef1be48
    .long 0xbf0e8000,0xbf7b3f6d,0x3f0e8000,0x3f7bbf6d,0xbef18000,0xbf7f3f55,0xbf623f80,0xbdc93f0e
    .long 0xbec48000,0xbf6d3f35,0xbec48000,0xbf6d3f35,0xbe958000,0xbf463f0e,0x3f75bf80,0x3f22bf55
    .long 0xbe488000,0xbf0e3ec4,0x3e488000,0x3f0ebec4,0xbdc98000,0xbe953e48,0xbf7f3f80,0xbf753f7b
    .long 0xbf808000,0x3f808000,0xbf808000,0x3f808000,0xbf62bec4,0x3f463f0e,0x3ef1bf6d,0xbf223f55
    .long 0xbf0ebf35,0x3e483f6d,0x3f0e3f35,0xbe48bf6d,0xbdc9bf6d,0xbef13f7b,0xbf7f3ec4,0x3f623e48
    .long 0x3ec4bf80,0xbf6d3f35,0x3ec4bf80,0xbf6d3f35,0x3f46bf6d,0xbf753e48,0x3f223ec4,0x3e95bf7b
    .long 0x3f7bbf35,0xbf0ebec4,0xbf7b3f35,0x3f0e3ec4,0x3f75bec4,0x3dc9bf55,0x3e95bf6d,0xbf7f3f0e
    .long 0x3f358000,0x3f35bf80,0x3f358000,0x3f35bf80,0x3e953ec4,0x3f7fbf55,0xbf753f6d,0x3dc93f0e
    .long 0xbe483f35,0x3f55bec4,0x3e48bf35,0xbf553ec4,0xbf223f6d,0x3e953e48,0x3f46bec4,0x3f75bf7b
    .long 0xbf6d3f80,0xbec43f35,0xbf6d3f80,0xbec43f35,0xbf7f3f6d,0xbf623f7b,0x3dc9bec4,0xbef13e48
    .long 0xbf553f35,0xbf7b3f6d,0x3f55bf35,0x3f7bbf6d,0xbef13ec4,0xbf223f0e,0xbf623f6d,0xbf463f55
    .long 0xbf808000,0x3f808000,0xbf808000,0x3f808000,0xbf22bf35,0x3ef13f55,0x3f46bf35,0xbf623f0e
    .long 0x3e48bf80,0xbf0e3f6d,0xbe483f80,0x3f0ebf6d,0x3f62bf35,0xbf7f3e48,0xbef1bf35,0xbdc93f7b
    .long 0x3f6d8000,0xbec4bf35,0x3f6d8000,0xbec4bf35,0x3e953f35,0x3f22bf7b,0xbf753f35,0x3f463e48
    .long 0xbf0e3f80,0x3f7bbec4,0x3f0ebf80,0xbf7b3ec4,0xbf7f3f35,0x3e953f0e,0x3dc93f35,0x3f75bf55
    .long 0xbf358000,0xbf353f80,0xbf358000,0xbf353f80,0x3dc9bf35,0xbf753f0e,0x3f7fbf35,0x3e95bf55
    .long 0x3f55bf80,0xbe48bec4,0xbf553f80,0x3e483ec4,0x3f75bf35,0x3f46bf7b,0x3e95bf35,0xbf223e48
    .long 0x3ec48000,0x3f6dbf35,0x3ec48000,0x3f6dbf35,0xbef13f35,0x3dc93e48,0xbf623f35,0xbf7f3f7b
    .long 0xbf7b3f80,0xbf553f6d,0x3f7bbf80,0x3f55bf6d,0xbf463f35,0xbf623f55,0xbf223f35,0xbef13f0e
    .long 0xbf808000,0x3f808000,0xbf808000,0x3f808000,0xbe95bf6d,0x3dc93f7b,0x3f75bec4,0xbf7f3e48
    .long 0x3f55bf35,0xbf7b3ec4,0xbf553f35,0x3f7bbec4,0x3f463ec4,0xbe95bf55,0x3f22bf6d,0xbf753f0e
    .long 0xbec43f80,0x3f6dbf35,0xbec43f80,0x3f6dbf35,0xbf7f3ec4,0x3ef13f0e,0x3dc9bf6d,0xbf623f55
    .long 0xbe48bf35,0xbf553f6d,0x3e483f35,0x3f55bf6d,0x3f62bf6d,0xbf22be48,0xbef1bec4,0xbf463f7b
    .long 0x3f358000,0x3f35bf80,0x3f358000,0x3f35bf80,0xbef13f6d,0x3f46be48,0xbf623ec4,0xbf223f7b
    .long 0xbf7b3f35,0xbf0e3f6d,0x3f7bbf35,0x3f0ebf6d,0xbdc9bec4,0xbf623f0e,0xbf7f3f6d,0xbef13f55
    .long 0x3f6dbf80,0x3ec4bf35,0x3f6dbf80,0x3ec4bf35,0x3f22bec4,0x3f75bf55,0xbf463f6d,0xbe953f0e
    .long 0xbf0e3f35,0xbe483ec4,0x3f0ebf35,0x3e48bec4,0xbf753f6d,0xbf7f3f7b,0xbe953ec4,0xbdc93e48
.size L_mt, 4096
.globl adaLN_cond__spectral_gfnet__glu_gated_reglu__prompt_kernel
.p2align 8
.type adaLN_cond__spectral_gfnet__glu_gated_reglu__prompt_kernel,@function
adaLN_cond__spectral_gfnet__glu_gated_reglu__prompt_kernel:
    s_load_dwordx8 s[48:55], s[0:1], 64
    s_load_dwordx16 s[32:47], s[0:1], 0
    s_memrealtime s[68:69]
    s_cmp_ge_u32 s2, 256
    s_cbranch_scc1 L_end
    s_getpc_b64 s[72:73]
L_pc:
    s_lshr_b32 s18, s2, 3
    s_lshl_b32 s3, s18, 10
    s_sub_u32 s4, s72, L_pc-L_mt
    s_subb_u32 s5, s73, 0
    v_lshrrev_b32 v4, 5, v0
    v_lshl_add_u32 v4, v4, 7, s3
    v_mov_b32 v247, s5
    v_add_co_u32 v4, vcc, s4, v4
    v_lshrrev_b32 v1, 6, v0
    v_and_b32 v2, 63, v0
    v_addc_co_u32 v5, vcc, 0, v247, vcc
    global_load_dword v245, v[4:5], off
    s_and_b32 s17, s2, 7
    v_readfirstlane_b32 s16, v1
    s_and_b32 s19, s18, 3
    s_lshl_b32 s22, s17, 2
    s_add_u32 s22, s22, s19
    s_lshr_b32 s23, s18, 2
    v_lshlrev_b32 v9, 4, v2
    v_lshrrev_b32 v126, 3, v0
    v_and_b32 v127, 7, v0
    s_mov_b32 s11, 0x20000
    s_cmp_ge_u32 s18, 16
    s_cbranch_scc1 L_help
    v_add_co_u32 v246, vcc, s4, v9
    s_mul_i32 s5, s22, 896
    v_mul_u32_u24 v124, 28672, v126
    v_addc_co_u32 v247, vcc, 0, v247, vcc
    v_lshl_add_u32 v124, v127, 4, v124
    v_add_u32 v124, s5, v124
    v_add_u32 v125, 917504, v124
    s_lshl_b32 s60, s23, 8
    s_movk_i32 s6, 896
    s_add_u32 s61, s60, 128
    s_cmp_ge_u32 s61, s6
    s_cselect_b32 s61, 0, s61
    s_add_u32 s62, s61, 128
    s_cmp_ge_u32 s62, s6
    s_cselect_b32 s62, 0, s62
    s_add_u32 s63, s62, 128
    s_cmp_ge_u32 s63, s6
    s_cselect_b32 s63, 0, s63
    s_add_u32 s64, s63, 128
    s_cmp_ge_u32 s64, s6
    s_cselect_b32 s64, 0, s64
    s_add_u32 s65, s64, 128
    s_cmp_ge_u32 s65, s6
    s_cselect_b32 s65, 0, s65
    s_add_u32 s66, s65, 128
    s_cmp_ge_u32 s66, s6
    s_cselect_b32 s66, 0, s66
    s_mov_b32 s10, 1835008
    s_waitcnt lgkmcnt(0)
    s_mov_b32 s8, s32
    s_and_b32 s9, s33, 0xffff
    buffer_load_dwordx4 v[32:35], v124, s[8:11], s60 offen
    buffer_load_dwordx4 v[60:63], v125, s[8:11], s60 offen
    buffer_load_dwordx4 v[36:39], v124, s[8:11], s61 offen
    buffer_load_dwordx4 v[64:67], v125, s[8:11], s61 offen
    s_mov_b32 s12, s54
    s_and_b32 s13, s55, 0xffff
    s_mov_b32 s14, 0x10000000
    s_mov_b32 s15, 0x20000
    v_and_b32 v7, 15, v2
    v_lshrrev_b32 v8, 4, v2
    s_mov_b32 s31, 0
    s_mov_b32 s76, 0
    s_sub_u32 s70, s68, 256
    s_mul_i32 s29, s16, 31744
    s_add_u32 s29, s29, 36864
    s_cmp_eq_u32 s16, 0
    s_cselect_b32 s4, 0xffff, 0
    s_mov_b32 s5, 0
    s_lshl_b32 s3, s2, 7
    v_mov_b32 v3, 1073741568
    v_lshl_add_u32 v254, v2, 3, s3
    v_cndmask_b32 v254, v3, v254, s[4:5]
    s_lshl_b32 s3, s16, 8
    s_add_u32 s3, s3, s2
    s_lshl_b32 s3, s3, 3
    s_add_u32 s3, s3, 32768
    v_mul_u32_u24 v26, 66048, v7
    v_lshl_add_u32 v26, v8, 4, v26
    v_writelane_b32 v254, s3, 16
    v_bfe_i32 v27, v2, 0, 1
    v_and_b32 v27, 0x80008000, v27
    v_mov_b32 v248, -1
    v_mov_b32 v249, -1
    v_mov_b32 v250, -1
    v_mov_b32 v251, -1
    s_mul_i32 s77, s22, 448
    s_lshl_b32 s3, s23, 7
    s_add_u32 s77, s77, s3
    s_lshl_b32 s3, s16, 14
    s_add_u32 s77, s77, s3
    s_add_u32 s77, s77, 1048576
    s_cmp_ge_u32 s18, 12
    s_cselect_b32 s52, 2139094784, s77
    s_add_u32 s53, s52, 1048576
    s_add_u32 s74, s77, 1048576
    v_mul_u32_u24 v14, 160, v126
    v_lshl_add_u32 v14, v127, 4, v14
    v_lshrrev_b32 v15, 2, v2
    v_mul_u32_u24 v15, 160, v15
    s_lshl_b32 s3, s16, 5
    v_and_b32 v1, 3, v2
    v_lshl_add_u32 v3, v1, 3, s3
    v_add_u32 v15, v15, v3
    s_and_b32 s3, s17, 3
    s_lshl_b32 s3, s3, 4
    v_mul_u32_u24 v244, 65536, v7
    v_lshl_add_u32 v244, v8, 4, v244
    v_xor_b32 v244, s3, v244
    s_mov_b32 s71, 0x3f803f80
    v_mov_b32 v120, 0
    v_mov_b32 v121, 0
    v_mov_b32 v122, 0
    v_mov_b32 v123, 0
    s_mul_i32 s3, s16, 6144
    s_add_u32 s3, s3, L_ct-L_pc+4096
    s_add_u32 s72, s72, s3
    s_addc_u32 s73, s73, 0
    v_mov_b32 v1, s73
    v_add_co_u32 v0, vcc, s72, v9
    s_nop 1
    v_addc_co_u32 v1, vcc, 0, v1, vcc
    s_cmp_lg_u32 s23, 0
    s_addc_u32 s25, s23, 0
    s_lshl_b32 s30, s17, 3
    s_add_u32 s30, s30, s25
    s_lshl_b32 s30, s30, 2
    s_add_u32 s30, s30, s19
    s_and_b32 s24, s25, 1
    s_lshr_b32 s25, s25, 1
    s_lshl_b32 s26, s19, 3
    s_add_u32 s26, s26, s17
    s_sub_u32 s75, 64, s26
    s_cmp_eq_u32 s26, 0
    s_cselect_b32 s75, 32, s75
    s_cmp_eq_u32 s24, 0
    s_cselect_b32 s27, s26, s75
    s_lshl_b32 s30, s30, 6
    s_lshl_b32 s3, s16, 14
    s_add_u32 s30, s30, s3
    s_add_u32 s30, s30, 4194304
    s_and_b32 s28, s17, 3
    s_mul_i32 s28, s28, 28
    s_add_u32 s28, s28, s18
    s_lshr_b32 s28, s28, 3
    s_lshl_b32 s28, s28, 2
    s_add_u32 s28, s28, s16
    s_lshl_b32 s28, s28, 6
    v_cvt_f32_u32 v213, v8
    v_mul_f32 v213, 4.0, v213
    v_lshl_add_u32 v208, v7, 6, s27
    v_cvt_f32_u32 v208, v208
    v_mul_f32 v208, 0x3a000000, v208
    v_mul_f32 v209, v213, v208
    s_mov_b32 s0, 0x80000000
    v_fmamk_f32 v210, v208, 0x0, v209
    v_cos_f32 v224, v210
    v_sin_f32 v226, v210
    v_fmamk_f32 v211, v208, 0x3f800000, v209
    v_cos_f32 v225, v211
    v_sin_f32 v227, v211
    v_cvt_pk_bf16_f32 v160, v224, v225
    v_cvt_pk_bf16_f32 v168, v226, v227
    v_xor_b32 v164, s0, v160
    v_xor_b32 v172, s0, v168
    v_fmamk_f32 v210, v208, 0x40000000, v209
    v_cos_f32 v224, v210
    v_sin_f32 v226, v210
    v_fmamk_f32 v211, v208, 0x40400000, v209
    v_cos_f32 v225, v211
    v_sin_f32 v227, v211
    v_cvt_pk_bf16_f32 v161, v224, v225
    v_cvt_pk_bf16_f32 v169, v226, v227
    v_xor_b32 v165, s0, v161
    v_xor_b32 v173, s0, v169
    v_fmamk_f32 v210, v208, 0x41800000, v209
    v_cos_f32 v224, v210
    v_sin_f32 v226, v210
    v_fmamk_f32 v211, v208, 0x41880000, v209
    v_cos_f32 v225, v211
    v_sin_f32 v227, v211
    v_cvt_pk_bf16_f32 v162, v224, v225
    v_cvt_pk_bf16_f32 v170, v226, v227
    v_xor_b32 v166, s0, v162
    v_xor_b32 v174, s0, v170
    v_fmamk_f32 v210, v208, 0x41900000, v209
    v_cos_f32 v224, v210
    v_sin_f32 v226, v210
    v_fmamk_f32 v211, v208, 0x41980000, v209
    v_cos_f32 v225, v211
    v_sin_f32 v227, v211
    v_cvt_pk_bf16_f32 v163, v224, v225
    v_cvt_pk_bf16_f32 v171, v226, v227
    v_xor_b32 v167, s0, v163
    v_xor_b32 v175, s0, v171
    v_cvt_f32_u32 v212, s27
    v_fmamk_f32 v212, v213, 0x42800000, v212
    v_add_u32 v208, 0, v7
    v_cvt_f32_u32 v208, v208
    v_mul_f32 v208, 0x3a000000, v208
    v_mul_f32 v209, v208, v212
    v_fmamk_f32 v210, v208, 0x0, v209
    v_cos_f32 v224, v210
    v_sin_f32 v226, v210
    v_fmamk_f32 v211, v208, 0x42800000, v209
    v_cos_f32 v225, v211
    v_sin_f32 v227, v211
    v_cvt_pk_bf16_f32 v176, v224, v225
    v_cvt_pk_bf16_f32 v184, v226, v227
    v_fmamk_f32 v210, v208, 0x43000000, v209
    v_cos_f32 v224, v210
    v_sin_f32 v226, v210
    v_fmamk_f32 v211, v208, 0x43400000, v209
    v_cos_f32 v225, v211
    v_sin_f32 v227, v211
    v_cvt_pk_bf16_f32 v177, v224, v225
    v_cvt_pk_bf16_f32 v185, v226, v227
    v_add_u32 v208, 16, v7
    v_cvt_f32_u32 v208, v208
    v_mul_f32 v208, 0x3a000000, v208
    v_mul_f32 v209, v208, v212
    v_fmamk_f32 v210, v208, 0x0, v209
    v_cos_f32 v224, v210
    v_sin_f32 v226, v210
    v_fmamk_f32 v211, v208, 0x42800000, v209
    v_cos_f32 v225, v211
    v_sin_f32 v227, v211
    v_cvt_pk_bf16_f32 v180, v224, v225
    v_cvt_pk_bf16_f32 v188, v226, v227
    v_fmamk_f32 v210, v208, 0x43000000, v209
    v_cos_f32 v224, v210
    v_sin_f32 v226, v210
    v_fmamk_f32 v211, v208, 0x43400000, v209
    v_cos_f32 v225, v211
    v_sin_f32 v227, v211
    v_cvt_pk_bf16_f32 v181, v224, v225
    v_cvt_pk_bf16_f32 v189, v226, v227
    v_lshrrev_b32 v210, 1, v7
    v_lshl_add_u32 v210, v8, 6, v210
    v_lshl_add_u32 v210, s16, 4, v210
    v_cvt_f32_u32 v208, s25
    v_mul_f32 v208, 0xbb124925, v208
    v_cvt_f32_u32 v209, v210
    v_and_b32 v210, 1, v7
    v_cvt_f32_u32 v210, v210
    v_mul_f32 v210, 0xbe800000, v210
    v_fma_f32 v209, v209, v208, v210
    s_cmp_eq_u32 s24, 0
    s_mov_b32 s4, 0x3e800000
    s_cselect_b32 s4, s4, 0xbe800000
    s_cmp_eq_u32 s27, 32
    s_cselect_b32 s4, 0, s4
    v_fmamk_f32 v210, v208, 0x0, v209
    v_add_f32 v211, s4, v210
    v_cos_f32 v216, v210
    v_cos_f32 v220, v211
    v_fmamk_f32 v210, v208, 0x41000000, v209
    v_add_f32 v211, s4, v210
    v_cos_f32 v217, v210
    v_cos_f32 v221, v211
    v_fmamk_f32 v210, v208, 0x43800000, v209
    v_add_f32 v211, s4, v210
    v_cos_f32 v218, v210
    v_cos_f32 v222, v211
    v_fmamk_f32 v210, v208, 0x43840000, v209
    v_add_f32 v211, s4, v210
    v_cos_f32 v219, v210
    v_cos_f32 v223, v211
    s_cmp_eq_u32 s25, 0
    s_cselect_b32 s4, 2.0, 1.0
    s_cmp_eq_u32 s26, 0
    s_cselect_b32 s4, 1.0, s4
    v_cmp_gt_u32 vcc, 3, v8
    v_mov_b32 v210, s4
    s_nop 0
    v_cndmask_b32 v211, 0, v210, vcc
    v_mul_f32 v216, v216, v210
    v_mul_f32 v217, v217, v210
    v_mul_f32 v218, v218, v211
    v_mul_f32 v219, v219, v211
    v_mul_f32 v220, v220, v210
    v_mul_f32 v221, v221, v210
    v_mul_f32 v222, v222, v211
    v_mul_f32 v223, v223, v211
    s_waitcnt vmcnt(0)
    buffer_load_dwordx4 v[40:43], v124, s[8:11], s62 offen
    buffer_load_dwordx4 v[68:71], v125, s[8:11], s62 offen
    buffer_load_dwordx4 v[44:47], v124, s[8:11], s63 offen
    buffer_load_dwordx4 v[72:75], v125, s[8:11], s63 offen
    buffer_load_dwordx4 v[48:51], v124, s[8:11], s64 offen
    buffer_load_dwordx4 v[76:79], v125, s[8:11], s64 offen
    buffer_load_dwordx4 v[52:55], v124, s[8:11], s65 offen
    buffer_load_dwordx4 v[80:83], v125, s[8:11], s65 offen
    buffer_load_dwordx4 v[56:59], v124, s[8:11], s66 offen
    buffer_load_dwordx4 v[84:87], v125, s[8:11], s66 offen
    global_load_dwordx4 v[88:91], v[246:247], off offset:0
    global_load_dwordx4 v[92:95], v[246:247], off offset:1024
    global_load_dwordx4 v[96:99], v[246:247], off offset:2048
    global_load_dwordx4 v[100:103], v[246:247], off offset:3072
    v_dot2c_f32_bf16 v120, s71, v32
    v_dot2c_f32_bf16 v121, v32, v32
    v_lshlrev_b32 v128, 16, v32
    v_and_b32 v129, 0xffff0000, v32
    v_dot2c_f32_bf16 v120, s71, v33
    v_dot2c_f32_bf16 v121, v33, v33
    v_lshlrev_b32 v130, 16, v33
    v_and_b32 v131, 0xffff0000, v33
    v_dot2c_f32_bf16 v120, s71, v34
    v_dot2c_f32_bf16 v121, v34, v34
    v_lshlrev_b32 v132, 16, v34
    v_and_b32 v133, 0xffff0000, v34
    v_dot2c_f32_bf16 v120, s71, v35
    v_dot2c_f32_bf16 v121, v35, v35
    v_lshlrev_b32 v134, 16, v35
    v_and_b32 v135, 0xffff0000, v35
    v_dot2c_f32_bf16 v122, s71, v60
    v_dot2c_f32_bf16 v123, v60, v60
    v_lshlrev_b32 v136, 16, v60
    v_and_b32 v137, 0xffff0000, v60
    v_dot2c_f32_bf16 v122, s71, v61
    v_dot2c_f32_bf16 v123, v61, v61
    v_lshlrev_b32 v138, 16, v61
    v_and_b32 v139, 0xffff0000, v61
    v_dot2c_f32_bf16 v122, s71, v62
    v_dot2c_f32_bf16 v123, v62, v62
    v_lshlrev_b32 v140, 16, v62
    v_and_b32 v141, 0xffff0000, v62
    v_dot2c_f32_bf16 v122, s71, v63
    v_dot2c_f32_bf16 v123, v63, v63
    v_lshlrev_b32 v142, 16, v63
    v_and_b32 v143, 0xffff0000, v63
    v_dot2c_f32_bf16 v120, s71, v36
    v_dot2c_f32_bf16 v121, v36, v36
    v_lshlrev_b32 v144, 16, v36
    v_and_b32 v145, 0xffff0000, v36
    v_dot2c_f32_bf16 v120, s71, v37
    v_dot2c_f32_bf16 v121, v37, v37
    v_lshlrev_b32 v146, 16, v37
    v_and_b32 v147, 0xffff0000, v37
    v_dot2c_f32_bf16 v120, s71, v38
    v_dot2c_f32_bf16 v121, v38, v38
    v_lshlrev_b32 v148, 16, v38
    v_and_b32 v149, 0xffff0000, v38
    v_dot2c_f32_bf16 v120, s71, v39
    v_dot2c_f32_bf16 v121, v39, v39
    v_lshlrev_b32 v150, 16, v39
    v_and_b32 v151, 0xffff0000, v39
    v_dot2c_f32_bf16 v122, s71, v64
    v_dot2c_f32_bf16 v123, v64, v64
    v_lshlrev_b32 v152, 16, v64
    v_and_b32 v153, 0xffff0000, v64
    v_dot2c_f32_bf16 v122, s71, v65
    v_dot2c_f32_bf16 v123, v65, v65
    v_lshlrev_b32 v154, 16, v65
    v_and_b32 v155, 0xffff0000, v65
    v_dot2c_f32_bf16 v122, s71, v66
    v_dot2c_f32_bf16 v123, v66, v66
    v_lshlrev_b32 v156, 16, v66
    v_and_b32 v157, 0xffff0000, v66
    v_dot2c_f32_bf16 v122, s71, v67
    v_dot2c_f32_bf16 v123, v67, v67
    v_lshlrev_b32 v158, 16, v67
    v_and_b32 v159, 0xffff0000, v67
    s_waitcnt vmcnt(13)
    v_dot2c_f32_bf16 v120, s71, v40
    v_dot2c_f32_bf16 v121, v40, v40
    v_dot2c_f32_bf16 v120, s71, v41
    v_dot2c_f32_bf16 v121, v41, v41
    v_dot2c_f32_bf16 v120, s71, v42
    v_dot2c_f32_bf16 v121, v42, v42
    v_dot2c_f32_bf16 v120, s71, v43
    v_dot2c_f32_bf16 v121, v43, v43
    s_waitcnt vmcnt(12)
    v_dot2c_f32_bf16 v122, s71, v68
    v_dot2c_f32_bf16 v123, v68, v68
    v_dot2c_f32_bf16 v122, s71, v69
    v_dot2c_f32_bf16 v123, v69, v69
    v_dot2c_f32_bf16 v122, s71, v70
    v_dot2c_f32_bf16 v123, v70, v70
    v_dot2c_f32_bf16 v122, s71, v71
    v_dot2c_f32_bf16 v123, v71, v71
    s_waitcnt vmcnt(11)
    v_dot2c_f32_bf16 v120, s71, v44
    v_dot2c_f32_bf16 v121, v44, v44
    v_dot2c_f32_bf16 v120, s71, v45
    v_dot2c_f32_bf16 v121, v45, v45
    v_dot2c_f32_bf16 v120, s71, v46
    v_dot2c_f32_bf16 v121, v46, v46
    v_dot2c_f32_bf16 v120, s71, v47
    v_dot2c_f32_bf16 v121, v47, v47
    s_waitcnt vmcnt(10)
    v_dot2c_f32_bf16 v122, s71, v72
    v_dot2c_f32_bf16 v123, v72, v72
    v_dot2c_f32_bf16 v122, s71, v73
    v_dot2c_f32_bf16 v123, v73, v73
    v_dot2c_f32_bf16 v122, s71, v74
    v_dot2c_f32_bf16 v123, v74, v74
    v_dot2c_f32_bf16 v122, s71, v75
    v_dot2c_f32_bf16 v123, v75, v75
    s_waitcnt vmcnt(9)
    v_dot2c_f32_bf16 v120, s71, v48
    v_dot2c_f32_bf16 v121, v48, v48
    v_dot2c_f32_bf16 v120, s71, v49
    v_dot2c_f32_bf16 v121, v49, v49
    v_dot2c_f32_bf16 v120, s71, v50
    v_dot2c_f32_bf16 v121, v50, v50
    v_dot2c_f32_bf16 v120, s71, v51
    v_dot2c_f32_bf16 v121, v51, v51
    s_waitcnt vmcnt(8)
    v_dot2c_f32_bf16 v122, s71, v76
    v_dot2c_f32_bf16 v123, v76, v76
    v_dot2c_f32_bf16 v122, s71, v77
    v_dot2c_f32_bf16 v123, v77, v77
    v_dot2c_f32_bf16 v122, s71, v78
    v_dot2c_f32_bf16 v123, v78, v78
    v_dot2c_f32_bf16 v122, s71, v79
    v_dot2c_f32_bf16 v123, v79, v79
    s_waitcnt vmcnt(7)
    v_dot2c_f32_bf16 v120, s71, v52
    v_dot2c_f32_bf16 v121, v52, v52
    v_dot2c_f32_bf16 v120, s71, v53
    v_dot2c_f32_bf16 v121, v53, v53
    v_dot2c_f32_bf16 v120, s71, v54
    v_dot2c_f32_bf16 v121, v54, v54
    v_dot2c_f32_bf16 v120, s71, v55
    v_dot2c_f32_bf16 v121, v55, v55
    s_waitcnt vmcnt(6)
    v_dot2c_f32_bf16 v122, s71, v80
    v_dot2c_f32_bf16 v123, v80, v80
    v_dot2c_f32_bf16 v122, s71, v81
    v_dot2c_f32_bf16 v123, v81, v81
    v_dot2c_f32_bf16 v122, s71, v82
    v_dot2c_f32_bf16 v123, v82, v82
    v_dot2c_f32_bf16 v122, s71, v83
    v_dot2c_f32_bf16 v123, v83, v83
    s_waitcnt vmcnt(5)
    v_dot2c_f32_bf16 v120, s71, v56
    v_dot2c_f32_bf16 v121, v56, v56
    v_dot2c_f32_bf16 v120, s71, v57
    v_dot2c_f32_bf16 v121, v57, v57
    v_dot2c_f32_bf16 v120, s71, v58
    v_dot2c_f32_bf16 v121, v58, v58
    v_dot2c_f32_bf16 v120, s71, v59
    v_dot2c_f32_bf16 v121, v59, v59
    s_waitcnt vmcnt(4)
    v_dot2c_f32_bf16 v122, s71, v84
    v_dot2c_f32_bf16 v123, v84, v84
    v_dot2c_f32_bf16 v122, s71, v85
    v_dot2c_f32_bf16 v123, v85, v85
    v_dot2c_f32_bf16 v122, s71, v86
    v_dot2c_f32_bf16 v123, v86, v86
    v_dot2c_f32_bf16 v122, s71, v87
    v_dot2c_f32_bf16 v123, v87, v87
    v_add_f32_dpp v120, v120, v120 quad_perm:[1,0,3,2] row_mask:0xf bank_mask:0xf
    v_add_f32_dpp v121, v121, v121 quad_perm:[1,0,3,2] row_mask:0xf bank_mask:0xf
    v_add_f32_dpp v122, v122, v122 quad_perm:[1,0,3,2] row_mask:0xf bank_mask:0xf
    v_add_f32_dpp v123, v123, v123 quad_perm:[1,0,3,2] row_mask:0xf bank_mask:0xf
    v_add_f32_dpp v120, v120, v120 quad_perm:[2,3,0,1] row_mask:0xf bank_mask:0xf
    v_add_f32_dpp v121, v121, v121 quad_perm:[2,3,0,1] row_mask:0xf bank_mask:0xf
    v_add_f32_dpp v122, v122, v122 quad_perm:[2,3,0,1] row_mask:0xf bank_mask:0xf
    v_add_f32_dpp v123, v123, v123 quad_perm:[2,3,0,1] row_mask:0xf bank_mask:0xf
    v_add_f32_dpp v120, v120, v120 row_half_mirror row_mask:0xf bank_mask:0xf
    v_add_f32_dpp v121, v121, v121 row_half_mirror row_mask:0xf bank_mask:0xf
    v_add_f32_dpp v122, v122, v122 row_half_mirror row_mask:0xf bank_mask:0xf
    v_add_f32_dpp v123, v123, v123 row_half_mirror row_mask:0xf bank_mask:0xf
    v_mul_f32 v120, 0x3b124925, v120
    v_mul_f32 v121, 0x3b124925, v121
    v_mul_f32 v122, 0x3b124925, v122
    v_mul_f32 v123, 0x3b124925, v123
    v_fma_f32 v121, -v120, v120, v121
    v_fma_f32 v123, -v122, v122, v123
    v_max_f32 v121, 0, v121
    v_max_f32 v123, 0, v123
    v_add_f32 v121, 0x3727c5ac, v121
    v_add_f32 v123, 0x3727c5ac, v123
    v_rsq_f32 v121, v121
    v_rsq_f32 v123, v123
    v_mul_f32 v120, v120, v121
    v_mul_f32 v122, v122, v123
    v_fma_f32 v128, v128, v121, -v120
    v_fma_f32 v129, v129, v121, -v120
    v_fma_f32 v130, v130, v121, -v120
    v_fma_f32 v131, v131, v121, -v120
    v_fma_f32 v132, v132, v121, -v120
    v_fma_f32 v133, v133, v121, -v120
    v_fma_f32 v134, v134, v121, -v120
    v_fma_f32 v135, v135, v121, -v120
    v_cvt_pk_bf16_f32 v192, v128, v129
    v_cvt_pk_bf16_f32 v193, v130, v131
    v_cvt_pk_bf16_f32 v194, v132, v133
    v_cvt_pk_bf16_f32 v195, v134, v135
    ds_write_b128 v14, v[192:195] offset:8192
    v_fma_f32 v136, v136, v123, -v122
    v_fma_f32 v137, v137, v123, -v122
    v_fma_f32 v138, v138, v123, -v122
    v_fma_f32 v139, v139, v123, -v122
    v_fma_f32 v140, v140, v123, -v122
    v_fma_f32 v141, v141, v123, -v122
    v_fma_f32 v142, v142, v123, -v122
    v_fma_f32 v143, v143, v123, -v122
    v_cvt_pk_bf16_f32 v196, v136, v137
    v_cvt_pk_bf16_f32 v197, v138, v139
    v_cvt_pk_bf16_f32 v198, v140, v141
    v_cvt_pk_bf16_f32 v199, v142, v143
    ds_write_b128 v14, v[196:199] offset:13312
    v_fma_f32 v144, v144, v121, -v120
    v_fma_f32 v145, v145, v121, -v120
    v_fma_f32 v146, v146, v121, -v120
    v_fma_f32 v147, v147, v121, -v120
    v_fma_f32 v148, v148, v121, -v120
    v_fma_f32 v149, v149, v121, -v120
    v_fma_f32 v150, v150, v121, -v120
    v_fma_f32 v151, v151, v121, -v120
    v_cvt_pk_bf16_f32 v200, v144, v145
    v_cvt_pk_bf16_f32 v201, v146, v147
    v_cvt_pk_bf16_f32 v202, v148, v149
    v_cvt_pk_bf16_f32 v203, v150, v151
    ds_write_b128 v14, v[200:203] offset:18432
    v_fma_f32 v152, v152, v123, -v122
    v_fma_f32 v153, v153, v123, -v122
    v_fma_f32 v154, v154, v123, -v122
    v_fma_f32 v155, v155, v123, -v122
    v_fma_f32 v156, v156, v123, -v122
    v_fma_f32 v157, v157, v123, -v122
    v_fma_f32 v158, v158, v123, -v122
    v_fma_f32 v159, v159, v123, -v122
    v_cvt_pk_bf16_f32 v204, v152, v153
    v_cvt_pk_bf16_f32 v205, v154, v155
    v_cvt_pk_bf16_f32 v206, v156, v157
    v_cvt_pk_bf16_f32 v207, v158, v159
    ds_write_b128 v14, v[204:207] offset:23552
    s_waitcnt vmcnt(3)
    v_xor_b32 v104, v88, v27
    v_xor_b32 v105, v89, v27
    v_xor_b32 v106, v90, v27
    v_xor_b32 v107, v91, v27
    s_waitcnt vmcnt(2)
    v_xor_b32 v108, v92, v27
    v_xor_b32 v109, v93, v27
    v_xor_b32 v110, v94, v27
    v_xor_b32 v111, v95, v27
    s_waitcnt lgkmcnt(0)
    s_barrier
    ds_read_b64_tr_b16 v[208:209], v15 offset:8192
    ds_read_b64_tr_b16 v[210:211], v15 offset:10752
    ds_read_b64_tr_b16 v[212:213], v15 offset:13312
    ds_read_b64_tr_b16 v[214:215], v15 offset:15872
    ds_read_b64_tr_b16 v[224:225], v15 offset:18432
    ds_read_b64_tr_b16 v[226:227], v15 offset:20992
    ds_read_b64_tr_b16 v[228:229], v15 offset:23552
    ds_read_b64_tr_b16 v[230:231], v15 offset:26112
    s_waitcnt vmcnt(1)
    v_xor_b32 v112, v96, v27
    v_xor_b32 v113, v97, v27
    v_xor_b32 v114, v98, v27
    v_xor_b32 v115, v99, v27
    s_waitcnt vmcnt(0)
    v_xor_b32 v116, v100, v27
    v_xor_b32 v117, v101, v27
    v_xor_b32 v118, v102, v27
    v_xor_b32 v119, v103, v27
    s_waitcnt lgkmcnt(6)
    v_mfma_f32_16x16x32_bf16 v[128:131], v[208:211], v[88:91], 0
    v_mfma_f32_16x16x32_bf16 v[132:135], v[208:211], v[92:95], 0
    s_waitcnt lgkmcnt(4)
    v_mfma_f32_16x16x32_bf16 v[128:131], v[212:215], v[104:107], v[128:131]
    v_mfma_f32_16x16x32_bf16 v[132:135], v[212:215], v[108:111], v[132:135]
    v_mfma_f32_16x16x32_bf16 v[136:139], v[208:211], v[96:99], 0
    v_mfma_f32_16x16x32_bf16 v[140:143], v[208:211], v[100:103], 0
    s_nop 0
    v_cvt_pk_bf16_f32 v192, v128, v132
    v_cvt_pk_bf16_f32 v193, v129, v133
    v_mfma_f32_16x16x32_bf16 v[136:139], v[212:215], v[112:115], v[136:139]
    v_cvt_pk_bf16_f32 v194, v130, v134
    v_cvt_pk_bf16_f32 v195, v131, v135
    v_mfma_f32_16x16x32_bf16 v[140:143], v[212:215], v[116:119], v[140:143]
    buffer_store_dwordx4 v[192:195], v244, s[12:15], s77 offen offset:0 sc1
    s_waitcnt lgkmcnt(2)
    v_mfma_f32_16x16x32_bf16 v[144:147], v[224:227], v[88:91], 0
    v_mfma_f32_16x16x32_bf16 v[148:151], v[224:227], v[92:95], 0
    s_nop 0
    v_cvt_pk_bf16_f32 v196, v136, v140
    v_cvt_pk_bf16_f32 v197, v137, v141
    s_waitcnt lgkmcnt(0)
    v_mfma_f32_16x16x32_bf16 v[144:147], v[228:231], v[104:107], v[144:147]
    v_cvt_pk_bf16_f32 v198, v138, v142
    v_cvt_pk_bf16_f32 v199, v139, v143
    v_mfma_f32_16x16x32_bf16 v[148:151], v[228:231], v[108:111], v[148:151]
    buffer_store_dwordx4 v[196:199], v244, s[12:15], s74 offen offset:0 sc1
    v_mfma_f32_16x16x32_bf16 v[152:155], v[224:227], v[96:99], 0
    v_mfma_f32_16x16x32_bf16 v[156:159], v[224:227], v[100:103], 0
    s_nop 0
    v_cvt_pk_bf16_f32 v200, v144, v148
    v_cvt_pk_bf16_f32 v201, v145, v149
    v_mfma_f32_16x16x32_bf16 v[152:155], v[228:231], v[112:115], v[152:155]
    v_cvt_pk_bf16_f32 v202, v146, v150
    v_cvt_pk_bf16_f32 v203, v147, v151
    v_mfma_f32_16x16x32_bf16 v[156:159], v[228:231], v[116:119], v[156:159]
    buffer_store_dwordx4 v[200:203], v244, s[12:15], s52 offen offset:64 sc1
    s_nop 6
    v_cvt_pk_bf16_f32 v204, v152, v156
    v_cvt_pk_bf16_f32 v205, v153, v157
    v_cvt_pk_bf16_f32 v206, v154, v158
    v_cvt_pk_bf16_f32 v207, v155, v159
    buffer_store_dwordx4 v[204:207], v244, s[12:15], s53 offen offset:64 sc1
    v_cmp_eq_u32 s[52:53], s23, v127
    v_mov_b32 v3, 28672
    v_lshl_add_u32 v3, v126, 4, v3
    v_lshl_add_u32 v232, s60, 3, v3
    v_lshl_add_u32 v233, s61, 3, v3
    v_lshl_add_u32 v234, s62, 3, v3
    v_lshl_add_u32 v235, s63, 3, v3
    v_lshl_add_u32 v236, s64, 3, v3
    v_lshl_add_u32 v237, s65, 3, v3
    v_lshl_add_u32 v238, s66, 3, v3
    global_load_dwordx4 v[88:91], v[0:1], off offset:-4096
    v_min_u32 v253, 13, v2
    v_add_u32 v253, 128, v253
    v_lshlrev_b32 v253, 7, v253
    buffer_load_dwordx2 v[92:93], v253, s[12:15], 0 offen sc1
    s_lshl_b32 s3, s16, 11
    s_add_u32 m0, s3, 0
    s_nop 0
    global_load_lds_dwordx4 v[0:1], off offset:0
    global_load_lds_dwordx4 v[0:1], off offset:1024
    global_load_dwordx4 v[128:131], v[0:1], off offset:-2048
    global_load_dwordx4 v[132:135], v[0:1], off offset:-1024
    s_mov_b64 exec, s[52:53]
    ds_write_b128 v232, v[32:35] offset:0
    ds_write_b128 v232, v[60:63] offset:512
    ds_write_b128 v233, v[36:39] offset:0
    ds_write_b128 v233, v[64:67] offset:512
    ds_write_b128 v234, v[40:43] offset:0
    ds_write_b128 v234, v[68:71] offset:512
    ds_write_b128 v235, v[44:47] offset:0
    ds_write_b128 v235, v[72:75] offset:512
    ds_write_b128 v236, v[48:51] offset:0
    ds_write_b128 v236, v[76:79] offset:512
    ds_write_b128 v237, v[52:55] offset:0
    ds_write_b128 v237, v[80:83] offset:512
    ds_write_b128 v238, v[56:59] offset:0
    ds_write_b128 v238, v[84:87] offset:512
    s_mov_b64 exec, -1
    s_waitcnt vmcnt(6)
    s_memrealtime s[0:1]
    s_waitcnt lgkmcnt(0)
    v_mov_b32 v240, s0
    v_xor_b32 v241, 0x5bd1e995, v240
    buffer_store_dwordx2 v[240:241], v254, s[12:15], 0 offen sc1
L_join0:
    s_cmp_lg_u32 s2, 255
    s_cselect_b32 s21, 1605632, 0
    s_sub_u32 s0, 64, s27
    s_movk_i32 s56, 28800
    s_add_u32 s1, s16, 1
    s_bfe_u32 s1, s1, 0x10001
    s_mul_i32 s1, s1, 224
    s_cmp_ge_u32 s16, 2
    s_cselect_b32 s0, s0, s27
    s_cselect_b32 s57, 547200, 0
    s_cselect_b32 s56, -28800, s56
    s_cselect_b32 s3, 3, 0
    s_mul_i32 s0, s0, 450
    s_add_u32 s0, s0, s1
    s_and_b32 s7, s0, 15
    s_sub_u32 s0, s0, s7
    v_lshrrev_b32 v252, 4, v2
    v_xor_b32 v252, s3, v252
    v_mul_u32_u24 v252, 115200, v252
    v_and_b32 v255, 15, v2
    v_min_u32 v255, 14, v255
    v_lshl_add_u32 v252, v255, 4, v252
    v_add_u32 v252, s0, v252
    v_add_u32 v255, s57, v252
    v_subrev_u32 v14, 921600, v255
    v_min_u32 v255, v255, v14
    s_sub_u32 s7, s7, s1
    s_mov_b32 s60, s42
    s_and_b32 s61, s43, 0xffff
    s_mov_b32 s62, s21
    s_mov_b32 s63, 0x20000
    s_mov_b32 s64, s44
    s_and_b32 s65, s45, 0xffff
    s_mov_b32 s66, s21
    s_mov_b32 s67, 0x20000
    s_mov_b32 s58, s40
    s_mov_b32 s59, s41
    s_mov_b32 s40, s34
    s_and_b32 s41, s35, 0xffff
    s_mov_b32 s42, 0xe1000
    s_mov_b32 s43, 0x20000
    s_mov_b32 s36, s36
    s_and_b32 s37, s37, 0xffff
    s_mov_b32 s38, 0xe1000
    s_mov_b32 s39, 0x20000
    s_mov_b32 s34, s57
    s_mov_b32 s47, s56
    s_mov_b32 s56, s58
    s_and_b32 s57, s59, 0xffff
    s_mov_b32 s58, s62
    s_mov_b32 s59, 0x20000
    s_add_u32 m0, s29, 15360
    s_nop 0
    buffer_load_dwordx4 v255, s[40:43], 0 offen  lds
    s_add_u32 m0, s29, 16384
    s_nop 0
    buffer_load_dwordx4 v255, s[36:39], 0 offen  lds
    s_sub_u32 s0, 64, s27
    s_mul_i32 s1, s16, 112
    s_add_u32 s1, s1, s25
    s_sub_u32 s3, 448, s1
    s_cmp_ge_u32 s16, 2
    s_cselect_b32 s5, s27, s0
    s_cselect_b32 s1, s3, s1
    s_cselect_b32 s4, -14, 14
    s_cselect_b32 s6, 0, 31
    s_lshl_b32 s3, s1, 1
    s_add_u32 s7, s7, s3
    s_add_u32 s7, s7, s29
    v_mul_i32_i24 v15, s4, v7
    v_lshl_add_u32 v15, v8, 8, v15
    v_add_u32 v15, s7, v15
    v_and_b32 v3, 4, v7
    v_and_b32 v14, 3, v7
    v_add_u32 v3, v3, v8
    v_lshl_add_u32 v14, v3, 2, v14
    v_xor_b32 v14, s6, v14
    v_lshl_add_u32 v14, v14, 6, s5
    v_and_b32 v14, 0x7ff, v14
    v_mul_u32_u24 v14, 225, v14
    s_and_b32 s3, s16, 1
    s_or_b32 s3, s3, s25
    s_cmp_eq_u32 s3, 0
    s_cselect_b32 s1, s1, 0x1000000
    s_cselect_b32 s46, 0x00010001, 0
    v_add_lshl_u32 v14, v14, s1, 1
    v_mov_b32 v30, 0
    v_mov_b32 v31, 0
L_join1:
    s_mov_b32 s48, s50
    s_mul_i32 s77, s47, 1
    s_add_u32 s77, s77, s34
    s_add_u32 m0, s29, 17408
    s_nop 0
    buffer_load_dwordx4 v252, s[40:43], s77 offen  lds
    s_and_b32 s49, s51, 0xffff
    s_mov_b32 s50, 0x1c0000
    s_mov_b32 s51, 0x20000
    s_mul_i32 s68, s22, 57344
    s_lshl_b32 s3, s23, 8
    s_add_u32 m0, s29, 18432
    s_nop 0
    buffer_load_dwordx4 v252, s[36:39], s77 offen  lds
    s_add_u32 s68, s68, s3
    s_cmp_eq_u32 s16, 3
    s_cselect_b32 s21, 0, -1
    s_mov_b32 s20, -1
    s_add_u32 s6, s68, 6553600
    s_add_u32 s7, s68, 6582272
    s_lshl_b32 s69, s22, 12
    s_mul_i32 s77, s47, 2
    s_add_u32 s77, s77, s34
    s_add_u32 m0, s29, 19456
    s_nop 0
    buffer_load_dwordx4 v252, s[40:43], s77 offen  lds
    s_lshl_b32 s5, s23, 7
    s_add_u32 s69, s69, s5
    s_mul_i32 s73, s22, 66048
    s_lshr_b32 s4, s23, 1
    s_lshl_b32 s4, s4, 14
    s_add_u32 m0, s29, 20480
    s_nop 0
    buffer_load_dwordx4 v252, s[36:39], s77 offen  lds
    s_add_u32 s73, s73, s4
    s_and_b32 s4, s23, 1
    s_lshl_b32 s4, s4, 5
    s_add_u32 s73, s73, s4
    s_add_u32 s73, s73, 4194304
    s_cmp_eq_u32 s16, 0
    s_cselect_b64 s[52:53], -1, 0
    s_mul_i32 s77, s47, 3
    s_add_u32 s77, s77, s34
    s_add_u32 m0, s29, 21504
    s_nop 0
    buffer_load_dwordx4 v252, s[40:43], s77 offen  lds
    s_mul_i32 s72, s26, 65536
    s_lshl_b32 s3, s16, 14
    s_add_u32 s72, s72, s3
    s_add_u32 s72, s72, 1048576
    s_mov_b32 s32, 0x00030003
    s_mov_b32 s33, 0x00030003
    s_add_u32 m0, s29, 22528
    s_nop 0
    buffer_load_dwordx4 v252, s[36:39], s77 offen  lds
    s_cmp_eq_u32 s27, 32
    s_cselect_b32 s74, 0xffff0000, -1
    s_cmp_eq_u32 s27, 0
    s_cselect_b32 s74, 0xffff, s74
    s_cselect_b32 s75, 0x42800000, 0
    v_mov_b32 v200, 0x3f803f80
    v_mov_b32 v201, 0x3f803f80
    v_mov_b32 v202, 0x3f803f80
    v_mov_b32 v203, 0x3f803f80
    s_mul_i32 s77, s47, 16
    s_add_u32 s77, s77, s34
    s_add_u32 m0, s29, 23552
    s_nop 0
    buffer_load_dwordx4 v252, s[40:43], s77 offen  lds
    v_mov_b32 v194, 0
    v_mov_b32 v195, 0
    v_mov_b32 v198, 0
    v_mov_b32 v199, 0
    v_xor_b32 v178, v176, v27
    s_add_u32 m0, s29, 24576
    s_nop 0
    buffer_load_dwordx4 v252, s[36:39], s77 offen  lds
    v_xor_b32 v179, v177, v27
    v_xor_b32 v186, v184, v27
    v_xor_b32 v187, v185, v27
    v_xor_b32 v182, v180, v27
    v_xor_b32 v183, v181, v27
    v_xor_b32 v190, v188, v27
    s_mul_i32 s77, s47, 17
    s_add_u32 s77, s77, s34
    s_add_u32 m0, s29, 25600
    s_nop 0
    buffer_load_dwordx4 v252, s[40:43], s77 offen  lds
    v_xor_b32 v191, v189, v27
    s_cmp_eq_u32 s16, 0
    s_mov_b32 s3, 6422528
    s_cselect_b32 s3, s3, 2146434816
    s_cselect_b32 s4, 28672, s3
    v_lshl_add_u32 v5, v8, 10, s3
    v_min_u32 v6, 30, v2
    v_lshl_add_u32 v5, v7, 3, v5
    v_lshl_add_u32 v6, v6, 7, s4
    s_lshl_b32 s3, s16, 11
    s_add_u32 s3, s3, 16384
    v_add_u32 v24, s3, v9
    v_mov_b32 v232, 0
    v_mov_b32 v233, 0
    v_mov_b32 v234, 0
    s_add_u32 m0, s29, 26624
    s_nop 0
    buffer_load_dwordx4 v252, s[36:39], s77 offen  lds
    v_mov_b32 v235, 0
    v_mov_b32 v236, 0
    v_mov_b32 v237, 0
    v_mov_b32 v238, 0
    v_mov_b32 v239, 0
    s_mul_i32 s77, s47, 18
    s_add_u32 s77, s77, s34
    s_add_u32 m0, s29, 27648
    s_nop 0
    buffer_load_dwordx4 v252, s[40:43], s77 offen  lds
    v_mov_b32 v240, 0
    v_mov_b32 v241, 0
    v_mov_b32 v242, 0
    v_mov_b32 v243, 0
    v_mov_b32 v244, 0
    v_mov_b32 v245, 0
    s_add_u32 m0, s29, 28672
    s_nop 0
    buffer_load_dwordx4 v252, s[36:39], s77 offen  lds
    v_mov_b32 v246, 0
    v_mov_b32 v247, 0
    s_waitcnt vmcnt(20)
    v_mad_u32_u16 v10, v88, 16, 0
    v_mad_u32_u16 v12, v88, 8, 0 op_sel:[1,0,0,0]
    v_mad_u32_u16 v16, v89, 16, 0
    s_mul_i32 s77, s47, 19
    s_add_u32 s77, s77, s34
    s_add_u32 m0, s29, 29696
    s_nop 0
    buffer_load_dwordx4 v252, s[40:43], s77 offen  lds
    v_mad_u32_u16 v20, v89, 16, 0 op_sel:[1,0,0,0]
    v_mad_u32_u16 v25, v90, 8, 0
    v_mad_u32_u16 v28, v90, 16, 0 op_sel:[1,0,0,0]
    v_mad_u32_u16 v29, v91, 4, 0
    v_mad_u32_u16 v4, v91, 16, 0 op_sel:[1,0,0,0]
    v_add_u32 v11, 56320, v10
    s_add_u32 m0, s29, 30720
    s_nop 0
    buffer_load_dwordx4 v252, s[36:39], s77 offen  lds
    v_xor_b32 v13, 32, v12
    v_xor_b32 v17, 16, v16
    v_xor_b32 v18, 32, v16
    v_xor_b32 v19, 48, v16
    v_xor_b32 v21, 16, v20
    buffer_load_short_d16_hi v30, v14, s[40:43], 0 offen
    v_xor_b32 v22, 32, v20
    v_xor_b32 v23, 48, v20
    s_waitcnt vmcnt(19)
    v_alignbit_b32 v144, v128, v128, 16
    v_xor_b32 v136, v128, v27
    v_alignbit_b32 v145, v129, v129, 16
    v_xor_b32 v137, v129, v27
    buffer_load_short_d16_hi v31, v14, s[36:39], 0 offen
    v_alignbit_b32 v146, v130, v130, 16
    v_xor_b32 v138, v130, v27
    v_alignbit_b32 v147, v131, v131, 16
    v_xor_b32 v139, v131, v27
    s_waitcnt vmcnt(19)
    v_alignbit_b32 v148, v132, v132, 16
    v_xor_b32 v140, v132, v27
    v_alignbit_b32 v149, v133, v133, 16
    v_xor_b32 v141, v133, v27
    v_alignbit_b32 v150, v134, v134, 16
    v_xor_b32 v142, v134, v27
    v_alignbit_b32 v151, v135, v135, 16
    v_xor_b32 v143, v135, v27
    v_xor_b32 v144, 0x8000, v144
    v_xor_b32 v145, 0x8000, v145
    v_xor_b32 v146, 0x8000, v146
    v_xor_b32 v147, 0x8000, v147
    v_xor_b32 v148, 0x8000, v148
    v_xor_b32 v149, 0x8000, v149
    v_xor_b32 v150, 0x8000, v150
    v_xor_b32 v151, 0x8000, v151
    v_xor_b32 v152, v144, v27
    v_xor_b32 v153, v145, v27
    v_xor_b32 v154, v146, v27
    v_xor_b32 v155, v147, v27
    v_xor_b32 v156, v148, v27
    v_xor_b32 v157, v149, v27
    v_xor_b32 v158, v150, v27
    v_xor_b32 v159, v151, v27
    s_branch L_join
L_help:
    s_cmp_ge_u32 s2, 142
    s_cbranch_scc1 L_help2
    s_sub_u32 s20, s2, 128
    s_lshl_b32 s4, s20, 7
    v_mul_u32_u24 v124, 75264, v126
    v_lshl_add_u32 v124, v127, 4, v124
    v_add_u32 v124, s4, v124
    v_add_u32 v125, 37632, v124
    v_mul_u32_u24 v201, 28, v126
    s_movk_i32 s60, 0
    s_movk_i32 s61, 5376
    s_movk_i32 s62, 10752
    s_movk_i32 s63, 16128
    s_movk_i32 s64, 21504
    s_movk_i32 s65, 26880
    s_movk_i32 s66, 32256
    s_mul_i32 s77, s20, 37
    s_lshr_b32 s77, s77, 8
    s_lshl_b32 s3, s20, 8
    s_add_u32 s3, s3, 49152
    s_add_u32 s5, s4, 58240
    s_add_u32 s6, s4, 56320
    s_cmp_eq_u32 s77, 3
    s_cselect_b32 s4, s5, 2147483392
    s_cmp_eq_u32 s77, 4
    s_cselect_b32 s4, s6, s4
    s_cmp_lt_u32 s20, 42
    s_cselect_b32 s3, s3, 2147483392
    s_cselect_b32 s21, 2408448, 0
    s_cmp_eq_u32 s16, 0
    s_cselect_b32 s3, s3, 2147483392
    s_cselect_b32 s4, s4, 2147483392
    v_lshl_add_u32 v202, v2, 2, s3
    v_lshl_add_u32 v203, v2, 1, s4
    v_lshrrev_b32 v200, 1, v126
    v_lshlrev_b32 v200, 8, v200
    v_lshl_add_u32 v200, v127, 5, v200
    v_mov_b32 v3, -1
    s_waitcnt lgkmcnt(0)
    s_mov_b32 s12, s54
    s_and_b32 s13, s55, 0xffff
    s_mov_b32 s14, 0x10000000
    s_mov_b32 s15, 0x20000
    buffer_store_dword v3, v202, s[12:15], 0 offen sc1
    s_mov_b32 s53, s21
    s_mov_b32 s10, s53
    s_mov_b32 s8, s48
    s_and_b32 s9, s49, 0xffff
    buffer_load_dwordx4 v[32:35], v124, s[8:11], s60 offen
    s_mov_b32 s56, s46
    s_and_b32 s57, s47, 0xffff
    s_mov_b32 s58, 0x380
    s_mov_b32 s59, 0x20000
    buffer_load_dwordx4 v[88:91], v201, s[56:59], 0 offen
    buffer_load_dwordx3 v[92:94], v201, s[56:59], 0 offen offset:16
    buffer_load_dwordx4 v[36:39], v124, s[8:11], s61 offen
    buffer_load_dwordx4 v[40:43], v124, s[8:11], s62 offen
    buffer_load_dwordx4 v[44:47], v124, s[8:11], s63 offen
    buffer_load_dwordx4 v[48:51], v124, s[8:11], s64 offen
    buffer_load_dwordx4 v[52:55], v124, s[8:11], s65 offen
    v_mov_b32 v192, 0
    v_mov_b32 v193, 0
    v_mov_b32 v194, 0
    v_mov_b32 v195, 0
    v_mov_b32 v196, 0
    v_mov_b32 v197, 0
    v_mov_b32 v198, 0
    v_mov_b32 v199, 0
    s_mov_b32 s12, s54
    s_and_b32 s13, s55, 0xffff
    s_mov_b32 s14, 0x10000000
    s_mov_b32 s15, 0x20000
    v_and_b32 v7, 15, v2
    v_lshrrev_b32 v8, 4, v2
    s_mov_b32 s31, 0
    s_mov_b32 s76, 0
    s_sub_u32 s70, s68, 256
    s_mul_i32 s29, s16, 31744
    s_add_u32 s29, s29, 36864
    s_cmp_eq_u32 s16, 0
    s_cselect_b32 s4, 0xffff, 0
    s_mov_b32 s5, 0
    s_lshl_b32 s3, s2, 7
    v_mov_b32 v3, 1073741568
    v_lshl_add_u32 v254, v2, 3, s3
    v_cndmask_b32 v254, v3, v254, s[4:5]
    s_lshl_b32 s3, s16, 8
    s_add_u32 s3, s3, s2
    s_lshl_b32 s3, s3, 3
    s_add_u32 s3, s3, 32768
    v_mul_u32_u24 v26, 66048, v7
    v_lshl_add_u32 v26, v8, 4, v26
    v_writelane_b32 v254, s3, 16
    v_bfe_i32 v27, v2, 0, 1
    v_and_b32 v27, 0x80008000, v27
    v_mov_b32 v248, -1
    v_mov_b32 v249, -1
    v_mov_b32 v250, -1
    v_mov_b32 v251, -1
    s_add_u32 s0, s70, 256
    s_waitcnt vmcnt(8)
    v_mov_b32 v240, s0
    v_xor_b32 v241, 0x5bd1e995, v240
    buffer_store_dwordx2 v[240:241], v254, s[12:15], 0 offen sc1
    s_mul_i32 s3, s16, 6144
    s_add_u32 s3, s3, L_ct-L_pc+4096
    s_add_u32 s72, s72, s3
    s_addc_u32 s73, s73, 0
    v_mov_b32 v1, s73
    v_add_co_u32 v0, vcc, s72, v9
    s_nop 1
    v_addc_co_u32 v1, vcc, 0, v1, vcc
    s_cmp_lg_u32 s23, 0
    s_addc_u32 s25, s23, 0
    s_lshl_b32 s30, s17, 3
    s_add_u32 s30, s30, s25
    s_lshl_b32 s30, s30, 2
    s_add_u32 s30, s30, s19
    s_and_b32 s24, s25, 1
    s_lshr_b32 s25, s25, 1
    s_lshl_b32 s26, s19, 3
    s_add_u32 s26, s26, s17
    s_sub_u32 s75, 64, s26
    s_cmp_eq_u32 s26, 0
    s_cselect_b32 s75, 32, s75
    s_cmp_eq_u32 s24, 0
    s_cselect_b32 s27, s26, s75
    s_lshl_b32 s30, s30, 6
    s_lshl_b32 s3, s16, 14
    s_add_u32 s30, s30, s3
    s_add_u32 s30, s30, 4194304
    s_and_b32 s28, s17, 3
    s_mul_i32 s28, s28, 28
    s_add_u32 s28, s28, s18
    s_lshr_b32 s28, s28, 3
    s_lshl_b32 s28, s28, 2
    s_add_u32 s28, s28, s16
    s_lshl_b32 s28, s28, 6
    v_cvt_f32_u32 v213, v8
    v_mul_f32 v213, 4.0, v213
    v_lshl_add_u32 v208, v7, 6, s27
    v_cvt_f32_u32 v208, v208
    v_mul_f32 v208, 0x3a000000, v208
    v_mul_f32 v209, v213, v208
    s_mov_b32 s0, 0x80000000
    v_fmamk_f32 v210, v208, 0x0, v209
    v_cos_f32 v224, v210
    v_sin_f32 v226, v210
    v_fmamk_f32 v211, v208, 0x3f800000, v209
    v_cos_f32 v225, v211
    v_sin_f32 v227, v211
    v_cvt_pk_bf16_f32 v160, v224, v225
    v_cvt_pk_bf16_f32 v168, v226, v227
    v_xor_b32 v164, s0, v160
    v_xor_b32 v172, s0, v168
    v_fmamk_f32 v210, v208, 0x40000000, v209
    v_cos_f32 v224, v210
    v_sin_f32 v226, v210
    v_fmamk_f32 v211, v208, 0x40400000, v209
    v_cos_f32 v225, v211
    v_sin_f32 v227, v211
    v_cvt_pk_bf16_f32 v161, v224, v225
    v_cvt_pk_bf16_f32 v169, v226, v227
    v_xor_b32 v165, s0, v161
    v_xor_b32 v173, s0, v169
    v_fmamk_f32 v210, v208, 0x41800000, v209
    v_cos_f32 v224, v210
    v_sin_f32 v226, v210
    v_fmamk_f32 v211, v208, 0x41880000, v209
    v_cos_f32 v225, v211
    v_sin_f32 v227, v211
    v_cvt_pk_bf16_f32 v162, v224, v225
    v_cvt_pk_bf16_f32 v170, v226, v227
    v_xor_b32 v166, s0, v162
    v_xor_b32 v174, s0, v170
    v_fmamk_f32 v210, v208, 0x41900000, v209
    v_cos_f32 v224, v210
    v_sin_f32 v226, v210
    v_fmamk_f32 v211, v208, 0x41980000, v209
    v_cos_f32 v225, v211
    v_sin_f32 v227, v211
    v_cvt_pk_bf16_f32 v163, v224, v225
    v_cvt_pk_bf16_f32 v171, v226, v227
    v_xor_b32 v167, s0, v163
    v_xor_b32 v175, s0, v171
    v_cvt_f32_u32 v212, s27
    v_fmamk_f32 v212, v213, 0x42800000, v212
    v_add_u32 v208, 0, v7
    v_cvt_f32_u32 v208, v208
    v_mul_f32 v208, 0x3a000000, v208
    v_mul_f32 v209, v208, v212
    v_fmamk_f32 v210, v208, 0x0, v209
    v_cos_f32 v224, v210
    v_sin_f32 v226, v210
    v_fmamk_f32 v211, v208, 0x42800000, v209
    v_cos_f32 v225, v211
    v_sin_f32 v227, v211
    v_cvt_pk_bf16_f32 v176, v224, v225
    v_cvt_pk_bf16_f32 v184, v226, v227
    v_fmamk_f32 v210, v208, 0x43000000, v209
    v_cos_f32 v224, v210
    v_sin_f32 v226, v210
    v_fmamk_f32 v211, v208, 0x43400000, v209
    v_cos_f32 v225, v211
    v_sin_f32 v227, v211
    v_cvt_pk_bf16_f32 v177, v224, v225
    v_cvt_pk_bf16_f32 v185, v226, v227
    v_add_u32 v208, 16, v7
    v_cvt_f32_u32 v208, v208
    v_mul_f32 v208, 0x3a000000, v208
    v_mul_f32 v209, v208, v212
    v_fmamk_f32 v210, v208, 0x0, v209
    v_cos_f32 v224, v210
    v_sin_f32 v226, v210
    v_fmamk_f32 v211, v208, 0x42800000, v209
    v_cos_f32 v225, v211
    v_sin_f32 v227, v211
    v_cvt_pk_bf16_f32 v180, v224, v225
    v_cvt_pk_bf16_f32 v188, v226, v227
    v_fmamk_f32 v210, v208, 0x43000000, v209
    v_cos_f32 v224, v210
    v_sin_f32 v226, v210
    v_fmamk_f32 v211, v208, 0x43400000, v209
    v_cos_f32 v225, v211
    v_sin_f32 v227, v211
    v_cvt_pk_bf16_f32 v181, v224, v225
    v_cvt_pk_bf16_f32 v189, v226, v227
    s_waitcnt vmcnt(1)
    buffer_load_dwordx4 v[56:59], v124, s[8:11], s66 offen
    buffer_load_dwordx4 v[60:63], v125, s[8:11], s60 offen
    buffer_load_dwordx4 v[64:67], v125, s[8:11], s61 offen
    buffer_load_dwordx4 v[68:71], v125, s[8:11], s62 offen
    buffer_load_dwordx4 v[72:75], v125, s[8:11], s63 offen
    buffer_load_dwordx4 v[76:79], v125, s[8:11], s64 offen
    buffer_load_dwordx4 v[80:83], v125, s[8:11], s65 offen
    buffer_load_dwordx4 v[84:87], v125, s[8:11], s66 offen
    v_lshrrev_b32 v210, 1, v7
    v_lshl_add_u32 v210, v8, 6, v210
    v_lshl_add_u32 v210, s16, 4, v210
    v_cvt_f32_u32 v208, s25
    v_mul_f32 v208, 0xbb124925, v208
    v_cvt_f32_u32 v209, v210
    v_and_b32 v210, 1, v7
    v_cvt_f32_u32 v210, v210
    v_mul_f32 v210, 0xbe800000, v210
    v_fma_f32 v209, v209, v208, v210
    s_cmp_eq_u32 s24, 0
    s_mov_b32 s4, 0x3e800000
    s_cselect_b32 s4, s4, 0xbe800000
    s_cmp_eq_u32 s27, 32
    s_cselect_b32 s4, 0, s4
    v_fmamk_f32 v210, v208, 0x0, v209
    v_add_f32 v211, s4, v210
    v_cos_f32 v216, v210
    v_cos_f32 v220, v211
    v_fmamk_f32 v210, v208, 0x41000000, v209
    v_add_f32 v211, s4, v210
    v_cos_f32 v217, v210
    v_cos_f32 v221, v211
    v_fmamk_f32 v210, v208, 0x43800000, v209
    v_add_f32 v211, s4, v210
    v_cos_f32 v218, v210
    v_cos_f32 v222, v211
    v_fmamk_f32 v210, v208, 0x43840000, v209
    v_add_f32 v211, s4, v210
    v_cos_f32 v219, v210
    v_cos_f32 v223, v211
    s_cmp_eq_u32 s25, 0
    s_cselect_b32 s4, 2.0, 1.0
    s_cmp_eq_u32 s26, 0
    s_cselect_b32 s4, 1.0, s4
    v_cmp_gt_u32 vcc, 3, v8
    v_mov_b32 v210, s4
    s_nop 0
    v_cndmask_b32 v211, 0, v210, vcc
    v_mul_f32 v216, v216, v210
    v_mul_f32 v217, v217, v210
    v_mul_f32 v218, v218, v211
    v_mul_f32 v219, v219, v211
    v_mul_f32 v220, v220, v210
    v_mul_f32 v221, v221, v210
    v_mul_f32 v222, v222, v211
    v_mul_f32 v223, v223, v211
    v_lshlrev_b32 v96, 16, v88
    v_mul_f32 v110, 0xbfb8aa3b, v96
    v_and_b32 v97, 0xffff0000, v88
    v_mul_f32 v111, 0xbfb8aa3b, v97
    v_lshlrev_b32 v98, 16, v89
    v_mul_f32 v112, 0xbfb8aa3b, v98
    v_and_b32 v99, 0xffff0000, v89
    v_mul_f32 v113, 0xbfb8aa3b, v99
    v_lshlrev_b32 v100, 16, v90
    v_mul_f32 v114, 0xbfb8aa3b, v100
    v_and_b32 v101, 0xffff0000, v90
    v_mul_f32 v115, 0xbfb8aa3b, v101
    v_lshlrev_b32 v102, 16, v91
    v_mul_f32 v116, 0xbfb8aa3b, v102
    v_and_b32 v103, 0xffff0000, v91
    v_mul_f32 v117, 0xbfb8aa3b, v103
    v_lshlrev_b32 v104, 16, v92
    v_mul_f32 v118, 0xbfb8aa3b, v104
    v_and_b32 v105, 0xffff0000, v92
    v_mul_f32 v119, 0xbfb8aa3b, v105
    v_lshlrev_b32 v106, 16, v93
    v_mul_f32 v120, 0xbfb8aa3b, v106
    v_and_b32 v107, 0xffff0000, v93
    v_mul_f32 v121, 0xbfb8aa3b, v107
    v_lshlrev_b32 v108, 16, v94
    v_mul_f32 v122, 0xbfb8aa3b, v108
    v_and_b32 v109, 0xffff0000, v94
    v_mul_f32 v123, 0xbfb8aa3b, v109
    v_exp_f32 v110, v110
    v_exp_f32 v111, v111
    v_exp_f32 v112, v112
    v_exp_f32 v113, v113
    v_exp_f32 v114, v114
    v_exp_f32 v115, v115
    v_exp_f32 v116, v116
    v_exp_f32 v117, v117
    v_exp_f32 v118, v118
    v_exp_f32 v119, v119
    v_exp_f32 v120, v120
    v_exp_f32 v121, v121
    v_exp_f32 v122, v122
    v_exp_f32 v123, v123
    v_add_f32 v110, 1.0, v110
    v_add_f32 v111, 1.0, v111
    v_add_f32 v112, 1.0, v112
    v_add_f32 v113, 1.0, v113
    v_add_f32 v114, 1.0, v114
    v_add_f32 v115, 1.0, v115
    v_add_f32 v116, 1.0, v116
    v_add_f32 v117, 1.0, v117
    v_add_f32 v118, 1.0, v118
    v_add_f32 v119, 1.0, v119
    v_add_f32 v120, 1.0, v120
    v_add_f32 v121, 1.0, v121
    v_add_f32 v122, 1.0, v122
    v_add_f32 v123, 1.0, v123
    v_rcp_f32 v110, v110
    v_rcp_f32 v111, v111
    v_rcp_f32 v112, v112
    v_rcp_f32 v113, v113
    v_rcp_f32 v114, v114
    v_rcp_f32 v115, v115
    v_rcp_f32 v116, v116
    v_rcp_f32 v117, v117
    v_rcp_f32 v118, v118
    v_rcp_f32 v119, v119
    v_rcp_f32 v120, v120
    v_rcp_f32 v121, v121
    v_rcp_f32 v122, v122
    v_rcp_f32 v123, v123
    v_mul_f32 v110, v110, v96
    v_mul_f32 v111, v111, v97
    v_mul_f32 v112, v112, v98
    v_mul_f32 v113, v113, v99
    v_mul_f32 v114, v114, v100
    v_mul_f32 v115, v115, v101
    v_mul_f32 v116, v116, v102
    v_mul_f32 v117, v117, v103
    v_mul_f32 v118, v118, v104
    v_mul_f32 v119, v119, v105
    v_mul_f32 v120, v120, v106
    v_mul_f32 v121, v121, v107
    v_mul_f32 v122, v122, v108
    v_mul_f32 v123, v123, v109
    v_cvt_pk_bf16_f32 v96, v110, 0
    v_cvt_pk_bf16_f32 v97, v111, 0
    v_cvt_pk_bf16_f32 v98, v112, 0
    v_cvt_pk_bf16_f32 v99, v113, 0
    v_cvt_pk_bf16_f32 v100, v114, 0
    v_cvt_pk_bf16_f32 v101, v115, 0
    v_cvt_pk_bf16_f32 v102, v116, 0
    v_cvt_pk_bf16_f32 v103, v117, 0
    v_cvt_pk_bf16_f32 v104, v118, 0
    v_cvt_pk_bf16_f32 v105, v119, 0
    v_cvt_pk_bf16_f32 v106, v120, 0
    v_cvt_pk_bf16_f32 v107, v121, 0
    v_cvt_pk_bf16_f32 v108, v122, 0
    v_cvt_pk_bf16_f32 v109, v123, 0
    v_lshlrev_b32 v110, 16, v96
    v_lshlrev_b32 v111, 16, v97
    v_lshlrev_b32 v112, 16, v98
    v_lshlrev_b32 v113, 16, v99
    v_lshlrev_b32 v114, 16, v100
    v_lshlrev_b32 v115, 16, v101
    v_lshlrev_b32 v116, 16, v102
    v_lshlrev_b32 v117, 16, v103
    v_lshlrev_b32 v118, 16, v104
    v_lshlrev_b32 v119, 16, v105
    v_lshlrev_b32 v120, 16, v106
    v_lshlrev_b32 v121, 16, v107
    v_lshlrev_b32 v122, 16, v108
    v_lshlrev_b32 v123, 16, v109
    v_dot2c_f32_bf16 v192, v96, v32
    v_dot2c_f32_bf16 v193, v110, v32
    v_dot2c_f32_bf16 v194, v96, v33
    v_dot2c_f32_bf16 v195, v110, v33
    v_dot2c_f32_bf16 v196, v96, v34
    v_dot2c_f32_bf16 v197, v110, v34
    v_dot2c_f32_bf16 v198, v96, v35
    v_dot2c_f32_bf16 v199, v110, v35
    v_dot2c_f32_bf16 v192, v97, v36
    v_dot2c_f32_bf16 v193, v111, v36
    v_dot2c_f32_bf16 v194, v97, v37
    v_dot2c_f32_bf16 v195, v111, v37
    v_dot2c_f32_bf16 v196, v97, v38
    v_dot2c_f32_bf16 v197, v111, v38
    v_dot2c_f32_bf16 v198, v97, v39
    v_dot2c_f32_bf16 v199, v111, v39
    v_dot2c_f32_bf16 v192, v98, v40
    v_dot2c_f32_bf16 v193, v112, v40
    v_dot2c_f32_bf16 v194, v98, v41
    v_dot2c_f32_bf16 v195, v112, v41
    v_dot2c_f32_bf16 v196, v98, v42
    v_dot2c_f32_bf16 v197, v112, v42
    v_dot2c_f32_bf16 v198, v98, v43
    v_dot2c_f32_bf16 v199, v112, v43
    v_dot2c_f32_bf16 v192, v99, v44
    v_dot2c_f32_bf16 v193, v113, v44
    v_dot2c_f32_bf16 v194, v99, v45
    v_dot2c_f32_bf16 v195, v113, v45
    v_dot2c_f32_bf16 v196, v99, v46
    v_dot2c_f32_bf16 v197, v113, v46
    v_dot2c_f32_bf16 v198, v99, v47
    v_dot2c_f32_bf16 v199, v113, v47
    v_dot2c_f32_bf16 v192, v100, v48
    v_dot2c_f32_bf16 v193, v114, v48
    v_dot2c_f32_bf16 v194, v100, v49
    v_dot2c_f32_bf16 v195, v114, v49
    v_dot2c_f32_bf16 v196, v100, v50
    v_dot2c_f32_bf16 v197, v114, v50
    v_dot2c_f32_bf16 v198, v100, v51
    v_dot2c_f32_bf16 v199, v114, v51
    v_dot2c_f32_bf16 v192, v101, v52
    v_dot2c_f32_bf16 v193, v115, v52
    v_dot2c_f32_bf16 v194, v101, v53
    v_dot2c_f32_bf16 v195, v115, v53
    v_dot2c_f32_bf16 v196, v101, v54
    v_dot2c_f32_bf16 v197, v115, v54
    v_dot2c_f32_bf16 v198, v101, v55
    v_dot2c_f32_bf16 v199, v115, v55
    s_waitcnt vmcnt(7)
    v_dot2c_f32_bf16 v192, v102, v56
    v_dot2c_f32_bf16 v193, v116, v56
    v_dot2c_f32_bf16 v194, v102, v57
    v_dot2c_f32_bf16 v195, v116, v57
    v_dot2c_f32_bf16 v196, v102, v58
    v_dot2c_f32_bf16 v197, v116, v58
    v_dot2c_f32_bf16 v198, v102, v59
    v_dot2c_f32_bf16 v199, v116, v59
    s_waitcnt vmcnt(6)
    v_dot2c_f32_bf16 v192, v103, v60
    v_dot2c_f32_bf16 v193, v117, v60
    v_dot2c_f32_bf16 v194, v103, v61
    v_dot2c_f32_bf16 v195, v117, v61
    v_dot2c_f32_bf16 v196, v103, v62
    v_dot2c_f32_bf16 v197, v117, v62
    v_dot2c_f32_bf16 v198, v103, v63
    v_dot2c_f32_bf16 v199, v117, v63
    s_waitcnt vmcnt(5)
    v_dot2c_f32_bf16 v192, v104, v64
    v_dot2c_f32_bf16 v193, v118, v64
    v_dot2c_f32_bf16 v194, v104, v65
    v_dot2c_f32_bf16 v195, v118, v65
    v_dot2c_f32_bf16 v196, v104, v66
    v_dot2c_f32_bf16 v197, v118, v66
    v_dot2c_f32_bf16 v198, v104, v67
    v_dot2c_f32_bf16 v199, v118, v67
    s_waitcnt vmcnt(4)
    v_dot2c_f32_bf16 v192, v105, v68
    v_dot2c_f32_bf16 v193, v119, v68
    v_dot2c_f32_bf16 v194, v105, v69
    v_dot2c_f32_bf16 v195, v119, v69
    v_dot2c_f32_bf16 v196, v105, v70
    v_dot2c_f32_bf16 v197, v119, v70
    v_dot2c_f32_bf16 v198, v105, v71
    v_dot2c_f32_bf16 v199, v119, v71
    s_waitcnt vmcnt(3)
    v_dot2c_f32_bf16 v192, v106, v72
    v_dot2c_f32_bf16 v193, v120, v72
    v_dot2c_f32_bf16 v194, v106, v73
    v_dot2c_f32_bf16 v195, v120, v73
    v_dot2c_f32_bf16 v196, v106, v74
    v_dot2c_f32_bf16 v197, v120, v74
    v_dot2c_f32_bf16 v198, v106, v75
    v_dot2c_f32_bf16 v199, v120, v75
    s_waitcnt vmcnt(2)
    v_dot2c_f32_bf16 v192, v107, v76
    v_dot2c_f32_bf16 v193, v121, v76
    v_dot2c_f32_bf16 v194, v107, v77
    v_dot2c_f32_bf16 v195, v121, v77
    v_dot2c_f32_bf16 v196, v107, v78
    v_dot2c_f32_bf16 v197, v121, v78
    v_dot2c_f32_bf16 v198, v107, v79
    v_dot2c_f32_bf16 v199, v121, v79
    s_waitcnt vmcnt(1)
    v_dot2c_f32_bf16 v192, v108, v80
    v_dot2c_f32_bf16 v193, v122, v80
    v_dot2c_f32_bf16 v194, v108, v81
    v_dot2c_f32_bf16 v195, v122, v81
    v_dot2c_f32_bf16 v196, v108, v82
    v_dot2c_f32_bf16 v197, v122, v82
    v_dot2c_f32_bf16 v198, v108, v83
    v_dot2c_f32_bf16 v199, v122, v83
    s_waitcnt vmcnt(0)
    v_dot2c_f32_bf16 v192, v109, v84
    v_dot2c_f32_bf16 v193, v123, v84
    v_dot2c_f32_bf16 v194, v109, v85
    v_dot2c_f32_bf16 v195, v123, v85
    v_dot2c_f32_bf16 v196, v109, v86
    v_dot2c_f32_bf16 v197, v123, v86
    v_dot2c_f32_bf16 v198, v109, v87
    v_dot2c_f32_bf16 v199, v123, v87
    v_add_f32_dpp v192, v192, v192 row_ror:8 row_mask:0xf bank_mask:0xf
    v_add_f32_dpp v193, v193, v193 row_ror:8 row_mask:0xf bank_mask:0xf
    v_add_f32_dpp v194, v194, v194 row_ror:8 row_mask:0xf bank_mask:0xf
    v_add_f32_dpp v195, v195, v195 row_ror:8 row_mask:0xf bank_mask:0xf
    v_add_f32_dpp v196, v196, v196 row_ror:8 row_mask:0xf bank_mask:0xf
    v_add_f32_dpp v197, v197, v197 row_ror:8 row_mask:0xf bank_mask:0xf
    v_add_f32_dpp v198, v198, v198 row_ror:8 row_mask:0xf bank_mask:0xf
    v_add_f32_dpp v199, v199, v199 row_ror:8 row_mask:0xf bank_mask:0xf
    s_mov_b32 exec_lo, 0x00ff00ff
    s_mov_b32 exec_hi, 0x00ff00ff
    ds_write_b128 v200, v[192:195] offset:8192
    ds_write_b128 v200, v[196:199] offset:8208
    s_mov_b64 exec, -1
    s_waitcnt lgkmcnt(0)
    s_barrier
    s_cmp_lg_u32 s16, 0
    s_cbranch_scc1 L_g1
    v_lshlrev_b32 v3, 2, v2
    ds_read2st64_b32 v[32:33], v3 offset0:32 offset1:33
    ds_read2st64_b32 v[34:35], v3 offset0:34 offset1:35
    ds_read2st64_b32 v[36:37], v3 offset0:36 offset1:37
    ds_read2st64_b32 v[38:39], v3 offset0:38 offset1:39
    ds_read2st64_b32 v[40:41], v3 offset0:40 offset1:41
    ds_read2st64_b32 v[42:43], v3 offset0:42 offset1:43
    ds_read2st64_b32 v[44:45], v3 offset0:44 offset1:45
    ds_read2st64_b32 v[46:47], v3 offset0:46 offset1:47
    s_cmp_eq_u32 s77, 1
    s_cselect_b64 s[4:5], -1, 0
    s_cmp_eq_u32 s77, 4
    s_cselect_b64 s[4:5], -1, s[4:5]
    s_cmp_eq_u32 s77, 2
    s_cselect_b32 s3, 0x35924925, 1.0
    s_waitcnt lgkmcnt(0)
    v_add_f32 v32, v32, v40
    v_add_f32 v33, v33, v41
    v_add_f32 v34, v34, v42
    v_add_f32 v35, v35, v43
    v_add_f32 v36, v36, v44
    v_add_f32 v37, v37, v45
    v_add_f32 v38, v38, v46
    v_add_f32 v39, v39, v47
    v_add_f32 v32, v32, v36
    v_add_f32 v33, v33, v37
    v_add_f32 v34, v34, v38
    v_add_f32 v35, v35, v39
    v_add_f32 v32, v32, v34
    v_add_f32 v33, v33, v35
    v_add_f32 v32, v32, v33
    v_cvt_pk_bf16_f32 v32, 0, v32
    v_add_f32 v33, 1.0, v32
    v_mul_f32 v32, s3, v32
    v_cvt_pk_bf16_f32 v33, 0, v33
    v_cndmask_b32 v32, v32, v33, s[4:5]
    buffer_store_dword v32, v202, s[12:15], 0 offen sc1
    buffer_store_short_d16_hi v32, v203, s[12:15], 0 offen sc1
L_g1:
    global_load_dwordx4 v[88:91], v[0:1], off offset:-4096
    v_min_u32 v253, 13, v2
    v_add_u32 v253, 128, v253
    v_lshlrev_b32 v253, 7, v253
    buffer_load_dwordx2 v[92:93], v253, s[12:15], 0 offen sc1
    s_lshl_b32 s3, s16, 11
    s_add_u32 m0, s3, 0
    s_nop 0
    global_load_lds_dwordx4 v[0:1], off offset:0
    global_load_lds_dwordx4 v[0:1], off offset:1024
    global_load_dwordx4 v[128:131], v[0:1], off offset:-2048
    global_load_dwordx4 v[132:135], v[0:1], off offset:-1024
    s_mov_b32 s8, s32
    s_and_b32 s9, s33, 0xffff
    s_mov_b32 s10, 0x1c0000
    s_mov_b32 s11, 0x20000
    v_mul_u32_u24 v3, 28672, v2
    s_mul_i32 s54, s22, 896
    s_lshl_b32 s3, s16, 8
    s_add_u32 s54, s54, s3
    s_lshl_b32 s3, s23, 4
    s_add_u32 s54, s54, s3
    s_lshl_b32 s55, s16, 11
    s_add_u32 m0, s55, 28672
    s_nop 0
    buffer_load_dwordx4 v3, s[8:11], s54 offen lds
    s_add_u32 m0, s55, 29568
    s_cmp_eq_u32 s16, 3
    s_cselect_b32 s54, 2143289088, s54
    buffer_load_dwordx4 v3, s[8:11], s54 offen offset:128 lds
    s_branch L_join0
L_help2:
    s_cmp_ge_u32 s2, 224
    s_cbranch_scc1 L_spare
    s_cmp_lt_u32 s2, 160
    s_cbranch_scc1 L_free
    s_lshl_b32 s26, s19, 3
    s_add_u32 s26, s26, s17
    s_sub_u32 s27, 64, s26
    s_cmp_eq_u32 s26, 0
    s_cselect_b32 s27, 32, s27
    s_cmp_lt_u32 s18, 24
    s_cselect_b32 s27, s26, s27
    s_mul_i32 s29, s16, 31744
    s_add_u32 s29, s29, 36864
    s_mov_b32 s21, 1605632
    s_sub_u32 s0, 64, s27
    s_movk_i32 s56, 28800
    s_add_u32 s1, s16, 1
    s_bfe_u32 s1, s1, 0x10001
    s_mul_i32 s1, s1, 224
    s_cmp_ge_u32 s16, 2
    s_cselect_b32 s0, s0, s27
    s_cselect_b32 s57, 547200, 0
    s_cselect_b32 s56, -28800, s56
    s_cselect_b32 s3, 3, 0
    s_mul_i32 s0, s0, 450
    s_add_u32 s0, s0, s1
    s_and_b32 s7, s0, 15
    s_sub_u32 s0, s0, s7
    v_lshrrev_b32 v252, 4, v2
    v_xor_b32 v252, s3, v252
    v_mul_u32_u24 v252, 115200, v252
    v_and_b32 v255, 15, v2
    v_min_u32 v255, 14, v255
    v_lshl_add_u32 v252, v255, 4, v252
    v_add_u32 v252, s0, v252
    v_add_u32 v255, s57, v252
    v_subrev_u32 v14, 921600, v255
    v_min_u32 v255, v255, v14
    s_sub_u32 s7, s7, s1
    s_waitcnt lgkmcnt(0)
    s_mov_b32 s60, s42
    s_and_b32 s61, s43, 0xffff
    s_mov_b32 s62, s21
    s_mov_b32 s63, 0x20000
    s_mov_b32 s64, s44
    s_and_b32 s65, s45, 0xffff
    s_mov_b32 s66, s21
    s_mov_b32 s67, 0x20000
    s_mov_b32 s58, s40
    s_mov_b32 s59, s41
    s_mov_b32 s40, s34
    s_and_b32 s41, s35, 0xffff
    s_mov_b32 s42, 0xe1000
    s_mov_b32 s43, 0x20000
    s_mov_b32 s36, s36
    s_and_b32 s37, s37, 0xffff
    s_mov_b32 s38, 0xe1000
    s_mov_b32 s39, 0x20000
    s_mov_b32 s34, s57
    s_mov_b32 s47, s56
    s_mov_b32 s56, s58
    s_and_b32 s57, s59, 0xffff
    s_mov_b32 s58, s62
    s_mov_b32 s59, 0x20000
    s_add_u32 m0, s29, 15360
    s_nop 0
    buffer_load_dwordx4 v255, s[40:43], 0 offen  lds
    s_add_u32 m0, s29, 16384
    s_nop 0
    buffer_load_dwordx4 v255, s[36:39], 0 offen  lds
    s_mul_i32 s77, s47, 1
    s_add_u32 s77, s77, s34
    s_add_u32 m0, s29, 17408
    s_nop 0
    buffer_load_dwordx4 v252, s[40:43], s77 offen  lds
    s_add_u32 m0, s29, 18432
    s_nop 0
    buffer_load_dwordx4 v252, s[36:39], s77 offen  lds
    s_mul_i32 s77, s47, 2
    s_add_u32 s77, s77, s34
    s_add_u32 m0, s29, 19456
    s_nop 0
    buffer_load_dwordx4 v252, s[40:43], s77 offen  lds
    s_add_u32 m0, s29, 20480
    s_nop 0
    buffer_load_dwordx4 v252, s[36:39], s77 offen  lds
    s_mov_b32 s12, s54
    s_and_b32 s13, s55, 0xffff
    s_mov_b32 s14, 0x10000000
    s_mov_b32 s15, 0x20000
    v_and_b32 v7, 15, v2
    v_lshrrev_b32 v8, 4, v2
    s_mov_b32 s31, 0
    s_mov_b32 s76, 0
    s_sub_u32 s70, s68, 256
    s_mul_i32 s29, s16, 31744
    s_add_u32 s29, s29, 36864
    s_cmp_eq_u32 s16, 0
    s_cselect_b32 s4, 0xffff, 0
    s_mov_b32 s5, 0
    s_lshl_b32 s3, s2, 7
    v_mov_b32 v3, 1073741568
    v_lshl_add_u32 v254, v2, 3, s3
    v_cndmask_b32 v254, v3, v254, s[4:5]
    s_lshl_b32 s3, s16, 8
    s_add_u32 s3, s3, s2
    s_lshl_b32 s3, s3, 3
    s_add_u32 s3, s3, 32768
    v_mul_u32_u24 v26, 66048, v7
    v_lshl_add_u32 v26, v8, 4, v26
    v_writelane_b32 v254, s3, 16
    v_bfe_i32 v27, v2, 0, 1
    v_and_b32 v27, 0x80008000, v27
    v_mov_b32 v248, -1
    v_mov_b32 v249, -1
    v_mov_b32 v250, -1
    v_mov_b32 v251, -1
    s_cmp_lg_u32 s23, 0
    s_addc_u32 s25, s23, 0
    s_lshl_b32 s30, s17, 3
    s_add_u32 s30, s30, s25
    s_lshl_b32 s30, s30, 2
    s_add_u32 s30, s30, s19
    s_and_b32 s24, s25, 1
    s_lshr_b32 s25, s25, 1
    s_lshl_b32 s26, s19, 3
    s_add_u32 s26, s26, s17
    s_sub_u32 s75, 64, s26
    s_cmp_eq_u32 s26, 0
    s_cselect_b32 s75, 32, s75
    s_cmp_eq_u32 s24, 0
    s_cselect_b32 s27, s26, s75
    s_lshl_b32 s30, s30, 6
    s_lshl_b32 s3, s16, 14
    s_add_u32 s30, s30, s3
    s_add_u32 s30, s30, 4194304
    s_and_b32 s28, s17, 3
    s_mul_i32 s28, s28, 28
    s_add_u32 s28, s28, s18
    s_lshr_b32 s28, s28, 3
    s_lshl_b32 s28, s28, 2
    s_add_u32 s28, s28, s16
    s_lshl_b32 s28, s28, 6
    s_sub_u32 s0, 64, s27
    s_mul_i32 s1, s16, 112
    s_add_u32 s1, s1, s25
    s_sub_u32 s3, 448, s1
    s_cmp_ge_u32 s16, 2
    s_cselect_b32 s5, s27, s0
    s_cselect_b32 s1, s3, s1
    s_cselect_b32 s4, -14, 14
    s_cselect_b32 s6, 0, 31
    s_lshl_b32 s3, s1, 1
    s_add_u32 s7, s7, s3
    s_add_u32 s7, s7, s29
    v_mul_i32_i24 v15, s4, v7
    v_lshl_add_u32 v15, v8, 8, v15
    v_add_u32 v15, s7, v15
    v_and_b32 v3, 4, v7
    v_and_b32 v14, 3, v7
    v_add_u32 v3, v3, v8
    v_lshl_add_u32 v14, v3, 2, v14
    v_xor_b32 v14, s6, v14
    v_lshl_add_u32 v14, v14, 6, s5
    v_and_b32 v14, 0x7ff, v14
    v_mul_u32_u24 v14, 225, v14
    s_and_b32 s3, s16, 1
    s_or_b32 s3, s3, s25
    s_cmp_eq_u32 s3, 0
    s_cselect_b32 s1, s1, 0x1000000
    s_cselect_b32 s46, 0x00010001, 0
    v_add_lshl_u32 v14, v14, s1, 1
    v_mov_b32 v30, 0
    v_mov_b32 v31, 0
    s_and_b32 s4, s17, 3
    s_mul_i32 s4, s4, 896
    s_lshr_b32 s6, s17, 2
    s_mul_i32 s7, s6, 3584 - 512
    s_add_u32 s7, s7, 384
    s_lshl_b32 s6, s6, 9
    s_add_u32 s4, s4, s6
    s_add_u32 s5, s18, 4294967276
    s_and_b32 s3, s16, 2
    s_lshl_b32 s3, s3, 2
    s_add_u32 s5, s5, s3
    s_mul_i32 s5, s5, 57344
    s_add_u32 s4, s4, s5
    v_and_b32 v242, 7, v2
    v_cmp_lt_u32 vcc, 2, v242
    v_cmp_lt_u32 s[0:1], 5, v242
    v_lshlrev_b32 v242, 7, v242
    v_add_u32 v243, 3584 - 384, v242
    v_cndmask_b32 v242, v242, v243, vcc
    v_mov_b32 v243, s7
    v_cndmask_b32 v242, v242, v243, s[0:1]
    v_lshrrev_b32 v243, 3, v2
    v_mul_u32_u24 v243, 7168, v243
    v_add3_u32 v242, v242, v243, s4
    v_mov_b32 v36, v242
    s_mul_i32 s3, s16, 6144
    s_add_u32 s3, s3, L_ct-L_pc+4096
    s_add_u32 s72, s72, s3
    s_addc_u32 s73, s73, 0
    v_mov_b32 v1, s73
    v_add_co_u32 v0, vcc, s72, v9
    s_nop 1
    v_addc_co_u32 v1, vcc, 0, v1, vcc
    v_cvt_f32_u32 v213, v8
    v_mul_f32 v213, 4.0, v213
    v_lshl_add_u32 v208, v7, 6, s27
    v_cvt_f32_u32 v208, v208
    v_mul_f32 v208, 0x3a000000, v208
    v_mul_f32 v209, v213, v208
    s_mov_b32 s0, 0x80000000
    v_fmamk_f32 v210, v208, 0x0, v209
    v_cos_f32 v224, v210
    v_sin_f32 v226, v210
    v_fmamk_f32 v211, v208, 0x3f800000, v209
    v_cos_f32 v225, v211
    v_sin_f32 v227, v211
    v_cvt_pk_bf16_f32 v160, v224, v225
    v_cvt_pk_bf16_f32 v168, v226, v227
    v_xor_b32 v164, s0, v160
    v_xor_b32 v172, s0, v168
    v_fmamk_f32 v210, v208, 0x40000000, v209
    v_cos_f32 v224, v210
    v_sin_f32 v226, v210
    v_fmamk_f32 v211, v208, 0x40400000, v209
    v_cos_f32 v225, v211
    v_sin_f32 v227, v211
    v_cvt_pk_bf16_f32 v161, v224, v225
    v_cvt_pk_bf16_f32 v169, v226, v227
    v_xor_b32 v165, s0, v161
    v_xor_b32 v173, s0, v169
    v_fmamk_f32 v210, v208, 0x41800000, v209
    v_cos_f32 v224, v210
    v_sin_f32 v226, v210
    v_fmamk_f32 v211, v208, 0x41880000, v209
    v_cos_f32 v225, v211
    v_sin_f32 v227, v211
    v_cvt_pk_bf16_f32 v162, v224, v225
    v_cvt_pk_bf16_f32 v170, v226, v227
    v_xor_b32 v166, s0, v162
    v_xor_b32 v174, s0, v170
    v_fmamk_f32 v210, v208, 0x41900000, v209
    v_cos_f32 v224, v210
    v_sin_f32 v226, v210
    v_fmamk_f32 v211, v208, 0x41980000, v209
    v_cos_f32 v225, v211
    v_sin_f32 v227, v211
    v_cvt_pk_bf16_f32 v163, v224, v225
    v_cvt_pk_bf16_f32 v171, v226, v227
    v_xor_b32 v167, s0, v163
    v_xor_b32 v175, s0, v171
    v_cvt_f32_u32 v212, s27
    v_fmamk_f32 v212, v213, 0x42800000, v212
    v_add_u32 v208, 0, v7
    v_cvt_f32_u32 v208, v208
    v_mul_f32 v208, 0x3a000000, v208
    v_mul_f32 v209, v208, v212
    v_fmamk_f32 v210, v208, 0x0, v209
    v_cos_f32 v224, v210
    v_sin_f32 v226, v210
    v_fmamk_f32 v211, v208, 0x42800000, v209
    v_cos_f32 v225, v211
    v_sin_f32 v227, v211
    v_cvt_pk_bf16_f32 v176, v224, v225
    v_cvt_pk_bf16_f32 v184, v226, v227
    v_fmamk_f32 v210, v208, 0x43000000, v209
    v_cos_f32 v224, v210
    v_sin_f32 v226, v210
    v_fmamk_f32 v211, v208, 0x43400000, v209
    v_cos_f32 v225, v211
    v_sin_f32 v227, v211
    v_cvt_pk_bf16_f32 v177, v224, v225
    v_cvt_pk_bf16_f32 v185, v226, v227
    v_add_u32 v208, 16, v7
    v_cvt_f32_u32 v208, v208
    v_mul_f32 v208, 0x3a000000, v208
    v_mul_f32 v209, v208, v212
    v_fmamk_f32 v210, v208, 0x0, v209
    v_cos_f32 v224, v210
    v_sin_f32 v226, v210
    v_fmamk_f32 v211, v208, 0x42800000, v209
    v_cos_f32 v225, v211
    v_sin_f32 v227, v211
    v_cvt_pk_bf16_f32 v180, v224, v225
    v_cvt_pk_bf16_f32 v188, v226, v227
    v_fmamk_f32 v210, v208, 0x43000000, v209
    v_cos_f32 v224, v210
    v_sin_f32 v226, v210
    v_fmamk_f32 v211, v208, 0x43400000, v209
    v_cos_f32 v225, v211
    v_sin_f32 v227, v211
    v_cvt_pk_bf16_f32 v181, v224, v225
    v_cvt_pk_bf16_f32 v189, v226, v227
    v_lshrrev_b32 v210, 1, v7
    v_lshl_add_u32 v210, v8, 6, v210
    v_lshl_add_u32 v210, s16, 4, v210
    v_cvt_f32_u32 v208, s25
    v_mul_f32 v208, 0xbb124925, v208
    v_cvt_f32_u32 v209, v210
    v_and_b32 v210, 1, v7
    v_cvt_f32_u32 v210, v210
    v_mul_f32 v210, 0xbe800000, v210
    v_fma_f32 v209, v209, v208, v210
    s_cmp_eq_u32 s24, 0
    s_mov_b32 s4, 0x3e800000
    s_cselect_b32 s4, s4, 0xbe800000
    s_cmp_eq_u32 s27, 32
    s_cselect_b32 s4, 0, s4
    v_fmamk_f32 v210, v208, 0x0, v209
    v_add_f32 v211, s4, v210
    v_cos_f32 v216, v210
    v_cos_f32 v220, v211
    v_fmamk_f32 v210, v208, 0x41000000, v209
    v_add_f32 v211, s4, v210
    v_cos_f32 v217, v210
    v_cos_f32 v221, v211
    v_fmamk_f32 v210, v208, 0x43800000, v209
    v_add_f32 v211, s4, v210
    v_cos_f32 v218, v210
    v_cos_f32 v222, v211
    v_fmamk_f32 v210, v208, 0x43840000, v209
    v_add_f32 v211, s4, v210
    v_cos_f32 v219, v210
    v_cos_f32 v223, v211
    s_cmp_eq_u32 s25, 0
    s_cselect_b32 s4, 2.0, 1.0
    s_cmp_eq_u32 s26, 0
    s_cselect_b32 s4, 1.0, s4
    v_cmp_gt_u32 vcc, 3, v8
    v_mov_b32 v210, s4
    s_nop 0
    v_cndmask_b32 v211, 0, v210, vcc
    v_mul_f32 v216, v216, v210
    v_mul_f32 v217, v217, v210
    v_mul_f32 v218, v218, v211
    v_mul_f32 v219, v219, v211
    v_mul_f32 v220, v220, v210
    v_mul_f32 v221, v221, v210
    v_mul_f32 v222, v222, v211
    v_mul_f32 v223, v223, v211
    global_load_dwordx4 v[88:91], v[0:1], off offset:-4096
    v_min_u32 v253, 13, v2
    v_add_u32 v253, 128, v253
    v_lshlrev_b32 v253, 7, v253
    s_lshl_b32 s3, s16, 11
    s_add_u32 m0, s3, 0
    s_nop 0
    global_load_lds_dwordx4 v[0:1], off offset:0
    global_load_lds_dwordx4 v[0:1], off offset:1024
    global_load_dwordx4 v[128:131], v[0:1], off offset:-2048
    global_load_dwordx4 v[132:135], v[0:1], off offset:-1024
    s_mov_b32 s8, s32
    s_and_b32 s9, s33, 0xffff
    s_mov_b32 s10, 0x1c0000
    s_mov_b32 s11, 0x20000
    v_mul_u32_u24 v3, 28672, v2
    s_mul_i32 s54, s22, 896
    s_lshl_b32 s3, s16, 8
    s_add_u32 s54, s54, s3
    s_lshl_b32 s3, s23, 4
    s_add_u32 s54, s54, s3
    s_lshl_b32 s55, s16, 11
    s_add_u32 m0, s55, 28672
    s_nop 0
    buffer_load_dwordx4 v3, s[8:11], s54 offen lds
    s_add_u32 m0, s55, 29568
    s_cmp_eq_u32 s16, 3
    s_cselect_b32 s54, 2143289088, s54
    buffer_load_dwordx4 v3, s[8:11], s54 offen offset:128 lds
    s_mov_b32 s48, s50
    s_and_b32 s49, s51, 0xffff
    s_mov_b32 s50, 0x1c0000
    s_mov_b32 s51, 0x20000
    s_mul_i32 s68, s22, 57344
    s_lshl_b32 s3, s23, 8
    s_add_u32 s68, s68, s3
    s_cmp_eq_u32 s16, 3
    s_cselect_b32 s21, 0, -1
    s_mov_b32 s20, -1
    s_add_u32 s6, s68, 6553600
    s_add_u32 s7, s68, 6582272
    s_lshl_b32 s69, s22, 12
    s_lshl_b32 s5, s23, 7
    s_add_u32 s69, s69, s5
    s_mul_i32 s73, s22, 66048
    s_lshr_b32 s4, s23, 1
    s_lshl_b32 s4, s4, 14
    s_add_u32 s73, s73, s4
    s_and_b32 s4, s23, 1
    s_lshl_b32 s4, s4, 5
    s_add_u32 s73, s73, s4
    s_add_u32 s73, s73, 4194304
    s_cmp_eq_u32 s16, 0
    s_cselect_b64 s[52:53], -1, 0
    s_mul_i32 s72, s26, 65536
    s_lshl_b32 s3, s16, 14
    s_add_u32 s72, s72, s3
    s_add_u32 s72, s72, 1048576
    s_mov_b32 s32, 0x00030003
    s_mov_b32 s33, 0x00030003
    s_cmp_eq_u32 s27, 32
    s_cselect_b32 s74, 0xffff0000, -1
    s_cmp_eq_u32 s27, 0
    s_cselect_b32 s74, 0xffff, s74
    s_cselect_b32 s75, 0x42800000, 0
    v_mov_b32 v200, 0x3f803f80
    v_mov_b32 v201, 0x3f803f80
    v_mov_b32 v202, 0x3f803f80
    v_mov_b32 v203, 0x3f803f80
    v_mov_b32 v194, 0
    v_mov_b32 v195, 0
    v_mov_b32 v198, 0
    v_mov_b32 v199, 0
    v_xor_b32 v178, v176, v27
    v_xor_b32 v179, v177, v27
    v_xor_b32 v186, v184, v27
    v_xor_b32 v187, v185, v27
    v_xor_b32 v182, v180, v27
    v_xor_b32 v183, v181, v27
    v_xor_b32 v190, v188, v27
    v_xor_b32 v191, v189, v27
    s_cmp_eq_u32 s16, 0
    s_mov_b32 s3, 6422528
    s_cselect_b32 s3, s3, 2146434816
    s_cselect_b32 s4, 28672, s3
    v_lshl_add_u32 v5, v8, 10, s3
    v_min_u32 v6, 30, v2
    v_lshl_add_u32 v5, v7, 3, v5
    v_lshl_add_u32 v6, v6, 7, s4
    s_lshl_b32 s3, s16, 11
    s_add_u32 s3, s3, 16384
    v_add_u32 v24, s3, v9
    v_mov_b32 v232, 0
    v_mov_b32 v233, 0
    v_mov_b32 v234, 0
    v_mov_b32 v235, 0
    v_mov_b32 v236, 0
    v_mov_b32 v237, 0
    v_mov_b32 v238, 0
    v_mov_b32 v239, 0
    s_waitcnt vmcnt(7)
    v_mov_b32 v240, 0
    s_mul_i32 s77, s47, 16
    s_add_u32 s77, s77, s34
    s_add_u32 m0, s29, 23552
    s_nop 0
    buffer_load_dwordx4 v252, s[40:43], s77 offen  lds
    v_mov_b32 v241, 0
    v_mov_b32 v242, 0
    v_mov_b32 v243, 0
    v_mov_b32 v244, 0
    s_add_u32 m0, s29, 24576
    s_nop 0
    buffer_load_dwordx4 v252, s[36:39], s77 offen  lds
    v_mov_b32 v245, 0
    v_mov_b32 v246, 0
    v_mov_b32 v247, 0
    s_waitcnt vmcnt(8)
    v_mad_u32_u16 v10, v88, 16, 0
    v_mad_u32_u16 v12, v88, 8, 0 op_sel:[1,0,0,0]
    s_mul_i32 s77, s47, 17
    s_add_u32 s77, s77, s34
    s_add_u32 m0, s29, 25600
    s_nop 0
    buffer_load_dwordx4 v252, s[40:43], s77 offen  lds
    v_mad_u32_u16 v16, v89, 16, 0
    v_mad_u32_u16 v20, v89, 16, 0 op_sel:[1,0,0,0]
    v_mad_u32_u16 v25, v90, 8, 0
    v_mad_u32_u16 v28, v90, 16, 0 op_sel:[1,0,0,0]
    v_mad_u32_u16 v29, v91, 4, 0
    s_add_u32 m0, s29, 26624
    s_nop 0
    buffer_load_dwordx4 v252, s[36:39], s77 offen  lds
    v_mad_u32_u16 v4, v91, 16, 0 op_sel:[1,0,0,0]
    v_add_u32 v11, 56320, v10
    v_xor_b32 v13, 32, v12
    v_xor_b32 v17, 16, v16
    s_mul_i32 s77, s47, 18
    s_add_u32 s77, s77, s34
    s_add_u32 m0, s29, 27648
    s_nop 0
    buffer_load_dwordx4 v252, s[40:43], s77 offen  lds
    v_xor_b32 v18, 32, v16
    v_xor_b32 v19, 48, v16
    v_xor_b32 v21, 16, v20
    v_xor_b32 v22, 32, v20
    v_xor_b32 v23, 48, v20
    s_add_u32 m0, s29, 28672
    s_nop 0
    buffer_load_dwordx4 v252, s[36:39], s77 offen  lds
    s_waitcnt vmcnt(9)
    v_alignbit_b32 v144, v128, v128, 16
    v_xor_b32 v136, v128, v27
    v_alignbit_b32 v145, v129, v129, 16
    v_xor_b32 v137, v129, v27
    v_alignbit_b32 v146, v130, v130, 16
    s_mul_i32 s77, s47, 19
    s_add_u32 s77, s77, s34
    s_add_u32 m0, s29, 29696
    s_nop 0
    buffer_load_dwordx4 v252, s[40:43], s77 offen  lds
    v_xor_b32 v138, v130, v27
    v_alignbit_b32 v147, v131, v131, 16
    v_xor_b32 v139, v131, v27
    s_waitcnt vmcnt(9)
    v_alignbit_b32 v148, v132, v132, 16
    s_add_u32 m0, s29, 30720
    s_nop 0
    buffer_load_dwordx4 v252, s[36:39], s77 offen  lds
    v_xor_b32 v140, v132, v27
    v_alignbit_b32 v149, v133, v133, 16
    v_xor_b32 v141, v133, v27
    v_alignbit_b32 v150, v134, v134, 16
    v_xor_b32 v142, v134, v27
    s_mul_i32 s77, s47, 3
    s_add_u32 s77, s77, s34
    s_add_u32 m0, s29, 21504
    s_nop 0
    buffer_load_dwordx4 v252, s[40:43], s77 offen  lds
    v_alignbit_b32 v151, v135, v135, 16
    v_xor_b32 v143, v135, v27
    v_xor_b32 v144, 0x8000, v144
    v_xor_b32 v145, 0x8000, v145
    v_xor_b32 v146, 0x8000, v146
    s_add_u32 m0, s29, 22528
    s_nop 0
    buffer_load_dwordx4 v252, s[36:39], s77 offen  lds
    v_xor_b32 v147, 0x8000, v147
    v_xor_b32 v148, 0x8000, v148
    v_xor_b32 v149, 0x8000, v149
    v_xor_b32 v150, 0x8000, v150
    buffer_load_short_d16_hi v30, v14, s[40:43], 0 offen
    v_xor_b32 v151, 0x8000, v151
    v_xor_b32 v152, v144, v27
    v_xor_b32 v153, v145, v27
    v_xor_b32 v154, v146, v27
    v_xor_b32 v155, v147, v27
    buffer_load_short_d16_hi v31, v14, s[36:39], 0 offen
    v_xor_b32 v156, v148, v27
    v_xor_b32 v157, v149, v27
    v_xor_b32 v158, v150, v27
    v_xor_b32 v159, v151, v27
    s_bitcmp1_b32 s16, 0
    s_cselect_b32 s8, s60, s56
    s_cselect_b32 s9, s61, s57
    s_mov_b32 s10, s62
    s_memrealtime s[0:1]
    s_waitcnt lgkmcnt(0)
    s_sub_u32 s1, s0, s70
L_gatew:
    s_cmp_ge_i32 s1, 456
    s_cbranch_scc1 L_openw
    s_add_u32 s1, s1, 4
    s_nop 15
    s_branch L_gatew
L_openw:
    buffer_load_dwordx2 v[92:93], v253, s[12:15], 0 offen sc1
    buffer_load_dword v36, v36, s[8:11], 0 offen
    s_waitcnt vmcnt(1)
    s_branch L_join
L_free:
    s_sub_u32 s3, s2, 144
    s_cmp_lt_u32 s3, 14
    s_cselect_b32 s10, 2408448, 0
    s_lshl_b32 s3, s3, 7
    s_add_u32 s3, s3, 32256
    v_mul_u32_u24 v3, 5376, v127
    v_mul_u32_u24 v4, 75264, v126
    v_add_u32 v3, v3, v4
    s_waitcnt lgkmcnt(0)
    s_mov_b32 s8, s48
    s_and_b32 s9, s49, 0xffff
    buffer_load_dword v32, v3, s[8:11], s3 offen
    s_mov_b32 s12, s54
    s_and_b32 s13, s55, 0xffff
    s_mov_b32 s14, 0x10000000
    s_mov_b32 s15, 0x20000
    v_and_b32 v7, 15, v2
    v_lshrrev_b32 v8, 4, v2
    s_mov_b32 s31, 0
    s_mov_b32 s76, 0
    s_sub_u32 s70, s68, 256
    s_mul_i32 s29, s16, 31744
    s_add_u32 s29, s29, 36864
    s_cmp_eq_u32 s16, 0
    s_cselect_b32 s4, 0xffff, 0
    s_mov_b32 s5, 0
    s_lshl_b32 s3, s2, 7
    v_mov_b32 v3, 1073741568
    v_lshl_add_u32 v254, v2, 3, s3
    v_cndmask_b32 v254, v3, v254, s[4:5]
    s_lshl_b32 s3, s16, 8
    s_add_u32 s3, s3, s2
    s_lshl_b32 s3, s3, 3
    s_add_u32 s3, s3, 32768
    v_mul_u32_u24 v26, 66048, v7
    v_lshl_add_u32 v26, v8, 4, v26
    v_writelane_b32 v254, s3, 16
    v_bfe_i32 v27, v2, 0, 1
    v_and_b32 v27, 0x80008000, v27
    v_mov_b32 v248, -1
    v_mov_b32 v249, -1
    v_mov_b32 v250, -1
    v_mov_b32 v251, -1
    s_cmp_lg_u32 s23, 0
    s_addc_u32 s25, s23, 0
    s_lshl_b32 s30, s17, 3
    s_add_u32 s30, s30, s25
    s_lshl_b32 s30, s30, 2
    s_add_u32 s30, s30, s19
    s_and_b32 s24, s25, 1
    s_lshr_b32 s25, s25, 1
    s_lshl_b32 s26, s19, 3
    s_add_u32 s26, s26, s17
    s_sub_u32 s75, 64, s26
    s_cmp_eq_u32 s26, 0
    s_cselect_b32 s75, 32, s75
    s_cmp_eq_u32 s24, 0
    s_cselect_b32 s27, s26, s75
    s_lshl_b32 s30, s30, 6
    s_lshl_b32 s3, s16, 14
    s_add_u32 s30, s30, s3
    s_add_u32 s30, s30, 4194304
    s_and_b32 s28, s17, 3
    s_mul_i32 s28, s28, 28
    s_add_u32 s28, s28, s18
    s_lshr_b32 s28, s28, 3
    s_lshl_b32 s28, s28, 2
    s_add_u32 s28, s28, s16
    s_lshl_b32 s28, s28, 6
    s_mul_i32 s3, s16, 6144
    s_add_u32 s3, s3, L_ct-L_pc+4096
    s_add_u32 s72, s72, s3
    s_addc_u32 s73, s73, 0
    v_mov_b32 v1, s73
    v_add_co_u32 v0, vcc, s72, v9
    s_nop 1
    v_addc_co_u32 v1, vcc, 0, v1, vcc
L_tabs:
    v_cvt_f32_u32 v213, v8
    v_mul_f32 v213, 4.0, v213
    v_lshl_add_u32 v208, v7, 6, s27
    v_cvt_f32_u32 v208, v208
    v_mul_f32 v208, 0x3a000000, v208
    v_mul_f32 v209, v213, v208
    s_mov_b32 s0, 0x80000000
    v_fmamk_f32 v210, v208, 0x0, v209
    v_cos_f32 v224, v210
    v_sin_f32 v226, v210
    v_fmamk_f32 v211, v208, 0x3f800000, v209
    v_cos_f32 v225, v211
    v_sin_f32 v227, v211
    v_cvt_pk_bf16_f32 v160, v224, v225
    v_cvt_pk_bf16_f32 v168, v226, v227
    v_xor_b32 v164, s0, v160
    v_xor_b32 v172, s0, v168
    v_fmamk_f32 v210, v208, 0x40000000, v209
    v_cos_f32 v224, v210
    v_sin_f32 v226, v210
    v_fmamk_f32 v211, v208, 0x40400000, v209
    v_cos_f32 v225, v211
    v_sin_f32 v227, v211
    v_cvt_pk_bf16_f32 v161, v224, v225
    v_cvt_pk_bf16_f32 v169, v226, v227
    v_xor_b32 v165, s0, v161
    v_xor_b32 v173, s0, v169
    v_fmamk_f32 v210, v208, 0x41800000, v209
    v_cos_f32 v224, v210
    v_sin_f32 v226, v210
    v_fmamk_f32 v211, v208, 0x41880000, v209
    v_cos_f32 v225, v211
    v_sin_f32 v227, v211
    v_cvt_pk_bf16_f32 v162, v224, v225
    v_cvt_pk_bf16_f32 v170, v226, v227
    v_xor_b32 v166, s0, v162
    v_xor_b32 v174, s0, v170
    v_fmamk_f32 v210, v208, 0x41900000, v209
    v_cos_f32 v224, v210
    v_sin_f32 v226, v210
    v_fmamk_f32 v211, v208, 0x41980000, v209
    v_cos_f32 v225, v211
    v_sin_f32 v227, v211
    v_cvt_pk_bf16_f32 v163, v224, v225
    v_cvt_pk_bf16_f32 v171, v226, v227
    v_xor_b32 v167, s0, v163
    v_xor_b32 v175, s0, v171
    v_cvt_f32_u32 v212, s27
    v_fmamk_f32 v212, v213, 0x42800000, v212
    v_add_u32 v208, 0, v7
    v_cvt_f32_u32 v208, v208
    v_mul_f32 v208, 0x3a000000, v208
    v_mul_f32 v209, v208, v212
    v_fmamk_f32 v210, v208, 0x0, v209
    v_cos_f32 v224, v210
    v_sin_f32 v226, v210
    v_fmamk_f32 v211, v208, 0x42800000, v209
    v_cos_f32 v225, v211
    v_sin_f32 v227, v211
    v_cvt_pk_bf16_f32 v176, v224, v225
    v_cvt_pk_bf16_f32 v184, v226, v227
    v_fmamk_f32 v210, v208, 0x43000000, v209
    v_cos_f32 v224, v210
    v_sin_f32 v226, v210
    v_fmamk_f32 v211, v208, 0x43400000, v209
    v_cos_f32 v225, v211
    v_sin_f32 v227, v211
    v_cvt_pk_bf16_f32 v177, v224, v225
    v_cvt_pk_bf16_f32 v185, v226, v227
    v_add_u32 v208, 16, v7
    v_cvt_f32_u32 v208, v208
    v_mul_f32 v208, 0x3a000000, v208
    v_mul_f32 v209, v208, v212
    v_fmamk_f32 v210, v208, 0x0, v209
    v_cos_f32 v224, v210
    v_sin_f32 v226, v210
    v_fmamk_f32 v211, v208, 0x42800000, v209
    v_cos_f32 v225, v211
    v_sin_f32 v227, v211
    v_cvt_pk_bf16_f32 v180, v224, v225
    v_cvt_pk_bf16_f32 v188, v226, v227
    v_fmamk_f32 v210, v208, 0x43000000, v209
    v_cos_f32 v224, v210
    v_sin_f32 v226, v210
    v_fmamk_f32 v211, v208, 0x43400000, v209
    v_cos_f32 v225, v211
    v_sin_f32 v227, v211
    v_cvt_pk_bf16_f32 v181, v224, v225
    v_cvt_pk_bf16_f32 v189, v226, v227
    v_lshrrev_b32 v210, 1, v7
    v_lshl_add_u32 v210, v8, 6, v210
    v_lshl_add_u32 v210, s16, 4, v210
    v_cvt_f32_u32 v208, s25
    v_mul_f32 v208, 0xbb124925, v208
    v_cvt_f32_u32 v209, v210
    v_and_b32 v210, 1, v7
    v_cvt_f32_u32 v210, v210
    v_mul_f32 v210, 0xbe800000, v210
    v_fma_f32 v209, v209, v208, v210
    s_cmp_eq_u32 s24, 0
    s_mov_b32 s4, 0x3e800000
    s_cselect_b32 s4, s4, 0xbe800000
    s_cmp_eq_u32 s27, 32
    s_cselect_b32 s4, 0, s4
    v_fmamk_f32 v210, v208, 0x0, v209
    v_add_f32 v211, s4, v210
    v_cos_f32 v216, v210
    v_cos_f32 v220, v211
    v_fmamk_f32 v210, v208, 0x41000000, v209
    v_add_f32 v211, s4, v210
    v_cos_f32 v217, v210
    v_cos_f32 v221, v211
    v_fmamk_f32 v210, v208, 0x43800000, v209
    v_add_f32 v211, s4, v210
    v_cos_f32 v218, v210
    v_cos_f32 v222, v211
    v_fmamk_f32 v210, v208, 0x43840000, v209
    v_add_f32 v211, s4, v210
    v_cos_f32 v219, v210
    v_cos_f32 v223, v211
    s_cmp_eq_u32 s25, 0
    s_cselect_b32 s4, 2.0, 1.0
    s_cmp_eq_u32 s26, 0
    s_cselect_b32 s4, 1.0, s4
    v_cmp_gt_u32 vcc, 3, v8
    v_mov_b32 v210, s4
    s_nop 0
    v_cndmask_b32 v211, 0, v210, vcc
    v_mul_f32 v216, v216, v210
    v_mul_f32 v217, v217, v210
    v_mul_f32 v218, v218, v211
    v_mul_f32 v219, v219, v211
    v_mul_f32 v220, v220, v210
    v_mul_f32 v221, v221, v210
    v_mul_f32 v222, v222, v211
    v_mul_f32 v223, v223, v211
    global_load_dwordx4 v[88:91], v[0:1], off offset:-4096
    v_min_u32 v253, 13, v2
    v_add_u32 v253, 128, v253
    v_lshlrev_b32 v253, 7, v253
    s_lshl_b32 s3, s16, 11
    s_add_u32 m0, s3, 0
    s_nop 0
    global_load_lds_dwordx4 v[0:1], off offset:0
    global_load_lds_dwordx4 v[0:1], off offset:1024
    global_load_dwordx4 v[128:131], v[0:1], off offset:-2048
    global_load_dwordx4 v[132:135], v[0:1], off offset:-1024
    s_mov_b32 s8, s32
    s_and_b32 s9, s33, 0xffff
    s_mov_b32 s10, 0x1c0000
    s_mov_b32 s11, 0x20000
    v_mul_u32_u24 v3, 28672, v2
    s_mul_i32 s54, s22, 896
    s_lshl_b32 s3, s16, 8
    s_add_u32 s54, s54, s3
    s_lshl_b32 s3, s23, 4
    s_add_u32 s54, s54, s3
    s_lshl_b32 s55, s16, 11
    s_add_u32 m0, s55, 28672
    s_nop 0
    buffer_load_dwordx4 v3, s[8:11], s54 offen lds
    s_add_u32 m0, s55, 29568
    s_cmp_eq_u32 s16, 3
    s_cselect_b32 s54, 2143289088, s54
    buffer_load_dwordx4 v3, s[8:11], s54 offen offset:128 lds
    s_memrealtime s[0:1]
    s_waitcnt lgkmcnt(0)
    s_sub_u32 s1, s0, s70
L_gatef:
    s_cmp_ge_i32 s1, 456
    s_cbranch_scc1 L_openf
    s_add_u32 s1, s1, 4
    s_nop 15
    s_branch L_gatef
L_openf:
    buffer_load_dwordx2 v[92:93], v253, s[12:15], 0 offen sc1
    s_waitcnt vmcnt(0)
    s_branch L_join0
L_spare:
    s_lshl_b32 s26, s19, 3
    s_add_u32 s26, s26, s17
    s_sub_u32 s27, 64, s26
    s_cmp_eq_u32 s26, 0
    s_cselect_b32 s27, 32, s27
    s_cmp_lt_u32 s16, 2
    s_cselect_b32 s27, s26, s27
    s_cmp_eq_u32 s27, 0
    s_cselect_b32 s4, 1, 0
    s_mul_i32 s3, s27, 450
    s_and_b32 s3, s3, -4
    v_lshrrev_b32 v3, 3, v2
    v_and_b32 v4, 7, v2
    v_cmp_gt_u32 vcc, 4, v3
    v_mov_b32 v5, s4
    s_nop 0
    v_cndmask_b32 v5, v5, 3, vcc
    v_lshl_add_u32 v5, v3, 2, v5
    v_cmp_lt_u32 vcc, 4, v4
    v_min_u32 v3, 4, v3
    s_nop 0
    v_cndmask_b32 v5, v5, 16, vcc
    v_cndmask_b32 v4, v4, v3, vcc
    v_mul_u32_u24 v5, 28800, v5
    v_mul_u32_u24 v4, 112, v4
    v_add_u32 v4, v4, v5
    s_mov_b32 s10, 921600
    s_bitcmp1_b32 s16, 0
    s_waitcnt lgkmcnt(0)
    s_cselect_b32 s8, s36, s34
    s_cselect_b32 s9, s37, s35
    s_and_b32 s9, s9, 0xffff
    buffer_load_dword v16, v4, s[8:11], s3 offen
    s_mul_i32 s3, s19, 10752
    s_add_u32 s3, s3, 32768-(L_pc-L_mt)
    v_mul_u32_u24 v4, 84, v0
    v_lshrrev_b32 v4, 8, v4
    v_lshl_add_u32 v4, v4, 7, s3
    v_min_u32 v4, L_last-L_pc, v4
    v_mov_b32 v5, s73
    v_add_co_u32 v4, vcc, s72, v4
    s_nop 1
    v_addc_co_u32 v5, vcc, 0, v5, vcc
    global_load_dword v245, v[4:5], off
    s_sub_u32 s20, s2, 210
    s_lshl_b32 s4, s20, 7
    v_mul_u32_u24 v124, 75264, v126
    v_lshl_add_u32 v124, v127, 4, v124
    v_add_u32 v124, s4, v124
    v_add_u32 v125, 37632, v124
    v_mul_u32_u24 v201, 28, v126
    s_movk_i32 s60, 0
    s_movk_i32 s61, 5376
    s_movk_i32 s62, 10752
    s_movk_i32 s63, 16128
    s_movk_i32 s64, 21504
    s_movk_i32 s65, 26880
    s_movk_i32 s66, 32256
    s_mul_i32 s77, s20, 37
    s_lshr_b32 s77, s77, 8
    s_lshl_b32 s3, s20, 8
    s_add_u32 s3, s3, 49152
    s_add_u32 s5, s4, 58240
    s_add_u32 s6, s4, 56320
    s_cmp_eq_u32 s77, 3
    s_cselect_b32 s4, s5, 2147483392
    s_cmp_eq_u32 s77, 4
    s_cselect_b32 s4, s6, s4
    s_cmp_lt_u32 s20, 42
    s_cselect_b32 s3, s3, 2147483392
    s_cselect_b32 s21, 2408448, 0
    s_cmp_eq_u32 s16, 0
    s_cselect_b32 s3, s3, 2147483392
    s_cselect_b32 s4, s4, 2147483392
    v_lshl_add_u32 v202, v2, 2, s3
    v_lshl_add_u32 v203, v2, 1, s4
    v_lshrrev_b32 v200, 1, v126
    v_lshlrev_b32 v200, 8, v200
    v_lshl_add_u32 v200, v127, 5, v200
    s_mov_b32 s12, s54
    s_and_b32 s13, s55, 0xffff
    s_mov_b32 s14, 0x10000000
    s_mov_b32 s15, 0x20000
    v_and_b32 v7, 15, v2
    v_lshrrev_b32 v8, 4, v2
    s_mov_b32 s31, 0
    s_mov_b32 s76, 0
    s_sub_u32 s70, s68, 256
    s_mul_i32 s29, s16, 31744
    s_add_u32 s29, s29, 36864
    s_cmp_eq_u32 s16, 0
    s_cselect_b32 s4, 0xffff, 0
    s_mov_b32 s5, 0
    s_lshl_b32 s3, s2, 7
    v_mov_b32 v3, 1073741568
    v_lshl_add_u32 v254, v2, 3, s3
    v_cndmask_b32 v254, v3, v254, s[4:5]
    s_lshl_b32 s3, s16, 8
    s_add_u32 s3, s3, s2
    s_lshl_b32 s3, s3, 3
    s_add_u32 s3, s3, 32768
    v_mul_u32_u24 v26, 66048, v7
    v_lshl_add_u32 v26, v8, 4, v26
    v_writelane_b32 v254, s3, 16
    v_bfe_i32 v27, v2, 0, 1
    v_and_b32 v27, 0x80008000, v27
    v_mov_b32 v248, -1
    v_mov_b32 v249, -1
    v_mov_b32 v250, -1
    v_mov_b32 v251, -1
    s_mov_b32 s53, s21
    buffer_store_dword v248, v202, s[12:15], 0 offen sc1
    buffer_store_short v248, v203, s[12:15], 0 offen sc1
    s_mov_b32 s56, s46
    s_and_b32 s57, s47, 0xffff
    s_mov_b32 s58, 0x380
    s_mov_b32 s59, 0x20000
    buffer_load_dwordx4 v[88:91], v201, s[56:59], 0 offen
    buffer_load_dwordx3 v[92:94], v201, s[56:59], 0 offen offset:16
    s_and_b32 s4, s17, 3
    s_mul_i32 s4, s4, 896
    s_lshr_b32 s6, s17, 2
    s_mul_i32 s7, s6, 3584 - 512
    s_add_u32 s7, s7, 384
    s_lshl_b32 s6, s6, 9
    s_add_u32 s4, s4, s6
    s_add_u32 s5, s19, 16
    s_and_b32 s3, s16, 2
    s_lshl_b32 s3, s3, 1
    s_add_u32 s5, s5, s3
    s_mul_i32 s5, s5, 57344
    s_add_u32 s4, s4, s5
    v_and_b32 v242, 7, v2
    v_cmp_lt_u32 vcc, 2, v242
    v_cmp_lt_u32 s[0:1], 5, v242
    v_lshlrev_b32 v242, 7, v242
    v_add_u32 v243, 3584 - 384, v242
    v_cndmask_b32 v242, v242, v243, vcc
    v_mov_b32 v243, s7
    v_cndmask_b32 v242, v242, v243, s[0:1]
    v_lshrrev_b32 v243, 3, v2
    v_mul_u32_u24 v243, 7168, v243
    v_add3_u32 v242, v242, v243, s4
    s_mov_b32 s58, 1605632
    s_bitcmp1_b32 s16, 0
    s_cselect_b32 s56, s42, s40
    s_cselect_b32 s57, s43, s41
    s_and_b32 s57, s57, 0xffff
    s_mov_b32 s59, 0x20000
    v_mov_b32 v204, v242
    v_add_u32 v242, 458752, v242
    v_mov_b32 v205, v242
    s_mul_i32 s3, s16, 6144
    s_add_u32 s3, s3, L_ct-L_pc+4096
    s_add_u32 s72, s72, s3
    s_addc_u32 s73, s73, 0
    v_mov_b32 v1, s73
    v_add_co_u32 v0, vcc, s72, v9
    s_nop 1
    v_addc_co_u32 v1, vcc, 0, v1, vcc
    s_mul_i32 s68, s22, 57344
    s_lshl_b32 s3, s23, 8
    s_add_u32 s68, s68, s3
    s_cmp_eq_u32 s16, 3
    s_cselect_b32 s21, 0, -1
    s_mov_b32 s20, -1
    s_add_u32 s6, s68, 6553600
    s_add_u32 s7, s68, 6582272
    s_lshl_b32 s69, s22, 12
    s_lshl_b32 s5, s23, 7
    s_add_u32 s69, s69, s5
    s_mul_i32 s73, s22, 66048
    s_lshr_b32 s4, s23, 1
    s_lshl_b32 s4, s4, 14
    s_add_u32 s73, s73, s4
    s_and_b32 s4, s23, 1
    s_lshl_b32 s4, s4, 5
    s_add_u32 s73, s73, s4
    s_add_u32 s73, s73, 4194304
    s_cmp_eq_u32 s16, 0
    s_mov_b32 s3, 6422528
    s_cselect_b32 s3, s3, 2146434816
    s_cselect_b32 s4, 28672, s3
    v_lshl_add_u32 v5, v8, 10, s3
    v_min_u32 v6, 30, v2
    v_lshl_add_u32 v5, v7, 3, v5
    v_lshl_add_u32 v6, v6, 7, s4
    v_lshrrev_b32 v3, 1, v8
    v_lshl_add_u32 v3, s16, 1, v3
    v_and_b32 v4, 1, v8
    v_mul_u32_u24 v4, 14336, v4
    v_lshl_add_u32 v4, v3, 11, v4
    v_lshl_add_u32 v4, v7, 4, v4
    s_sub_u32 s71, s2, 224
    s_lshl_b32 s71, s71, 2
    s_add_u32 s71, s71, s16
    s_mul_i32 s71, s71, 17408
    s_add_u32 s71, s71, 4194304
    s_cmp_eq_u32 s2, 255
    s_cbranch_scc1 L_xtra
    s_memrealtime s[0:1]
    s_waitcnt lgkmcnt(0)
    s_sub_u32 s1, s0, s70
L_gatesp:
    s_cmp_ge_i32 s1, 356
    s_cbranch_scc1 L_opensp
    s_add_u32 s1, s1, 4
    s_nop 15
    s_branch L_gatesp
L_opensp:
    buffer_store_dwordx4 v[248:251], v9, s[12:15], s71 offen offset:0 sc1
    buffer_store_dwordx4 v[248:251], v9, s[12:15], s71 offen offset:1024 sc1
    buffer_store_dwordx4 v[248:251], v9, s[12:15], s71 offen offset:2048 sc1
    buffer_store_dwordx4 v[248:251], v9, s[12:15], s71 offen offset:3072 sc1
    s_add_u32 s71, s71, 4096
    buffer_store_dwordx4 v[248:251], v9, s[12:15], s71 offen offset:0 sc1
    buffer_store_dwordx4 v[248:251], v9, s[12:15], s71 offen offset:1024 sc1
    buffer_store_dwordx4 v[248:251], v9, s[12:15], s71 offen offset:2048 sc1
    buffer_store_dwordx4 v[248:251], v9, s[12:15], s71 offen offset:3072 sc1
    s_add_u32 s71, s71, 4096
    buffer_store_dwordx4 v[248:251], v9, s[12:15], s71 offen offset:0 sc1
    buffer_store_dwordx4 v[248:251], v9, s[12:15], s71 offen offset:1024 sc1
    buffer_store_dwordx4 v[248:251], v9, s[12:15], s71 offen offset:2048 sc1
    buffer_store_dwordx4 v[248:251], v9, s[12:15], s71 offen offset:3072 sc1
    s_add_u32 s71, s71, 4096
    buffer_store_dwordx4 v[248:251], v9, s[12:15], s71 offen offset:0 sc1
    buffer_store_dwordx4 v[248:251], v9, s[12:15], s71 offen offset:1024 sc1
    buffer_store_dwordx4 v[248:251], v9, s[12:15], s71 offen offset:2048 sc1
    buffer_store_dwordx4 v[248:251], v9, s[12:15], s71 offen offset:3072 sc1
    s_add_u32 s71, s71, 4096
    buffer_store_dwordx4 v[248:251], v9, s[12:15], s71 offen offset:0 sc1
    s_mov_b64 exec, s[20:21]
    buffer_store_dwordx4 v[248:251], v4, s[12:15], s6 offen sc1
    buffer_store_dwordx4 v[248:251], v4, s[12:15], s7 offen sc1
    s_mov_b64 exec, -1
    buffer_store_dwordx2 v[248:249], v5, s[12:15], s69 offen sc1
    s_barrier
    s_mov_b32 s10, s53
    s_mov_b32 s8, s48
    s_and_b32 s9, s49, 0xffff
    buffer_load_dwordx4 v[32:35], v124, s[8:11], s60 offen
    buffer_load_dwordx4 v[36:39], v124, s[8:11], s61 offen
    buffer_load_dwordx4 v[40:43], v124, s[8:11], s62 offen
    buffer_load_dwordx4 v[44:47], v124, s[8:11], s63 offen
    buffer_load_dwordx4 v[48:51], v124, s[8:11], s64 offen
    buffer_load_dwordx4 v[52:55], v124, s[8:11], s65 offen
    buffer_load_dwordx4 v[56:59], v124, s[8:11], s66 offen
    buffer_load_dwordx4 v[60:63], v125, s[8:11], s60 offen
    buffer_load_dwordx4 v[64:67], v125, s[8:11], s61 offen
    buffer_load_dwordx4 v[68:71], v125, s[8:11], s62 offen
    buffer_load_dwordx4 v[72:75], v125, s[8:11], s63 offen
    buffer_load_dwordx4 v[76:79], v125, s[8:11], s64 offen
    buffer_load_dwordx4 v[80:83], v125, s[8:11], s65 offen
    buffer_load_dwordx4 v[84:87], v125, s[8:11], s66 offen
    v_mov_b32 v192, 0
    v_mov_b32 v193, 0
    v_mov_b32 v194, 0
    v_mov_b32 v195, 0
    v_mov_b32 v196, 0
    v_mov_b32 v197, 0
    v_mov_b32 v198, 0
    v_mov_b32 v199, 0
    s_lshl_b32 s3, s16, 11
    s_add_u32 m0, s3, 0
    s_nop 0
    global_load_lds_dwordx4 v[0:1], off offset:0
    global_load_lds_dwordx4 v[0:1], off offset:1024
    s_memrealtime s[0:1]
    s_waitcnt vmcnt(16)
    s_barrier
    s_waitcnt lgkmcnt(0)
    v_mov_b32 v240, s0
    v_xor_b32 v241, 0x5bd1e995, v240
    buffer_store_dwordx2 v[240:241], v254, s[12:15], 0 offen sc1
    v_lshlrev_b32 v96, 16, v88
    v_mul_f32 v110, 0xbfb8aa3b, v96
    v_and_b32 v97, 0xffff0000, v88
    v_mul_f32 v111, 0xbfb8aa3b, v97
    v_lshlrev_b32 v98, 16, v89
    v_mul_f32 v112, 0xbfb8aa3b, v98
    v_and_b32 v99, 0xffff0000, v89
    v_mul_f32 v113, 0xbfb8aa3b, v99
    v_lshlrev_b32 v100, 16, v90
    v_mul_f32 v114, 0xbfb8aa3b, v100
    v_and_b32 v101, 0xffff0000, v90
    v_mul_f32 v115, 0xbfb8aa3b, v101
    v_lshlrev_b32 v102, 16, v91
    v_mul_f32 v116, 0xbfb8aa3b, v102
    v_and_b32 v103, 0xffff0000, v91
    v_mul_f32 v117, 0xbfb8aa3b, v103
    v_lshlrev_b32 v104, 16, v92
    v_mul_f32 v118, 0xbfb8aa3b, v104
    v_and_b32 v105, 0xffff0000, v92
    v_mul_f32 v119, 0xbfb8aa3b, v105
    v_lshlrev_b32 v106, 16, v93
    v_mul_f32 v120, 0xbfb8aa3b, v106
    v_and_b32 v107, 0xffff0000, v93
    v_mul_f32 v121, 0xbfb8aa3b, v107
    v_lshlrev_b32 v108, 16, v94
    v_mul_f32 v122, 0xbfb8aa3b, v108
    v_and_b32 v109, 0xffff0000, v94
    v_mul_f32 v123, 0xbfb8aa3b, v109
    v_exp_f32 v110, v110
    v_exp_f32 v111, v111
    v_exp_f32 v112, v112
    v_exp_f32 v113, v113
    v_exp_f32 v114, v114
    v_exp_f32 v115, v115
    v_exp_f32 v116, v116
    v_exp_f32 v117, v117
    v_exp_f32 v118, v118
    v_exp_f32 v119, v119
    v_exp_f32 v120, v120
    v_exp_f32 v121, v121
    v_exp_f32 v122, v122
    v_exp_f32 v123, v123
    v_add_f32 v110, 1.0, v110
    v_add_f32 v111, 1.0, v111
    v_add_f32 v112, 1.0, v112
    v_add_f32 v113, 1.0, v113
    v_add_f32 v114, 1.0, v114
    v_add_f32 v115, 1.0, v115
    v_add_f32 v116, 1.0, v116
    v_add_f32 v117, 1.0, v117
    v_add_f32 v118, 1.0, v118
    v_add_f32 v119, 1.0, v119
    v_add_f32 v120, 1.0, v120
    v_add_f32 v121, 1.0, v121
    v_add_f32 v122, 1.0, v122
    v_add_f32 v123, 1.0, v123
    v_rcp_f32 v110, v110
    v_rcp_f32 v111, v111
    v_rcp_f32 v112, v112
    v_rcp_f32 v113, v113
    v_rcp_f32 v114, v114
    v_rcp_f32 v115, v115
    v_rcp_f32 v116, v116
    v_rcp_f32 v117, v117
    v_rcp_f32 v118, v118
    v_rcp_f32 v119, v119
    v_rcp_f32 v120, v120
    v_rcp_f32 v121, v121
    v_rcp_f32 v122, v122
    v_rcp_f32 v123, v123
    v_mul_f32 v110, v110, v96
    v_mul_f32 v111, v111, v97
    v_mul_f32 v112, v112, v98
    v_mul_f32 v113, v113, v99
    v_mul_f32 v114, v114, v100
    v_mul_f32 v115, v115, v101
    v_mul_f32 v116, v116, v102
    v_mul_f32 v117, v117, v103
    v_mul_f32 v118, v118, v104
    v_mul_f32 v119, v119, v105
    v_mul_f32 v120, v120, v106
    v_mul_f32 v121, v121, v107
    v_mul_f32 v122, v122, v108
    v_mul_f32 v123, v123, v109
    v_cvt_pk_bf16_f32 v96, v110, 0
    v_cvt_pk_bf16_f32 v97, v111, 0
    v_cvt_pk_bf16_f32 v98, v112, 0
    v_cvt_pk_bf16_f32 v99, v113, 0
    v_cvt_pk_bf16_f32 v100, v114, 0
    v_cvt_pk_bf16_f32 v101, v115, 0
    v_cvt_pk_bf16_f32 v102, v116, 0
    v_cvt_pk_bf16_f32 v103, v117, 0
    v_cvt_pk_bf16_f32 v104, v118, 0
    v_cvt_pk_bf16_f32 v105, v119, 0
    v_cvt_pk_bf16_f32 v106, v120, 0
    v_cvt_pk_bf16_f32 v107, v121, 0
    v_cvt_pk_bf16_f32 v108, v122, 0
    v_cvt_pk_bf16_f32 v109, v123, 0
    v_lshlrev_b32 v110, 16, v96
    v_lshlrev_b32 v111, 16, v97
    v_lshlrev_b32 v112, 16, v98
    v_lshlrev_b32 v113, 16, v99
    v_lshlrev_b32 v114, 16, v100
    v_lshlrev_b32 v115, 16, v101
    v_lshlrev_b32 v116, 16, v102
    v_lshlrev_b32 v117, 16, v103
    v_lshlrev_b32 v118, 16, v104
    v_lshlrev_b32 v119, 16, v105
    v_lshlrev_b32 v120, 16, v106
    v_lshlrev_b32 v121, 16, v107
    v_lshlrev_b32 v122, 16, v108
    v_lshlrev_b32 v123, 16, v109
    s_waitcnt vmcnt(16)
    v_dot2c_f32_bf16 v192, v96, v32
    v_dot2c_f32_bf16 v193, v110, v32
    v_dot2c_f32_bf16 v194, v96, v33
    v_dot2c_f32_bf16 v195, v110, v33
    v_dot2c_f32_bf16 v196, v96, v34
    v_dot2c_f32_bf16 v197, v110, v34
    v_dot2c_f32_bf16 v198, v96, v35
    v_dot2c_f32_bf16 v199, v110, v35
    s_waitcnt vmcnt(15)
    v_dot2c_f32_bf16 v192, v97, v36
    v_dot2c_f32_bf16 v193, v111, v36
    v_dot2c_f32_bf16 v194, v97, v37
    v_dot2c_f32_bf16 v195, v111, v37
    v_dot2c_f32_bf16 v196, v97, v38
    v_dot2c_f32_bf16 v197, v111, v38
    v_dot2c_f32_bf16 v198, v97, v39
    v_dot2c_f32_bf16 v199, v111, v39
    s_waitcnt vmcnt(14)
    v_dot2c_f32_bf16 v192, v98, v40
    v_dot2c_f32_bf16 v193, v112, v40
    v_dot2c_f32_bf16 v194, v98, v41
    v_dot2c_f32_bf16 v195, v112, v41
    v_dot2c_f32_bf16 v196, v98, v42
    v_dot2c_f32_bf16 v197, v112, v42
    v_dot2c_f32_bf16 v198, v98, v43
    v_dot2c_f32_bf16 v199, v112, v43
    s_waitcnt vmcnt(13)
    v_dot2c_f32_bf16 v192, v99, v44
    v_dot2c_f32_bf16 v193, v113, v44
    v_dot2c_f32_bf16 v194, v99, v45
    v_dot2c_f32_bf16 v195, v113, v45
    v_dot2c_f32_bf16 v196, v99, v46
    v_dot2c_f32_bf16 v197, v113, v46
    v_dot2c_f32_bf16 v198, v99, v47
    v_dot2c_f32_bf16 v199, v113, v47
    s_waitcnt vmcnt(12)
    v_dot2c_f32_bf16 v192, v100, v48
    v_dot2c_f32_bf16 v193, v114, v48
    v_dot2c_f32_bf16 v194, v100, v49
    v_dot2c_f32_bf16 v195, v114, v49
    v_dot2c_f32_bf16 v196, v100, v50
    v_dot2c_f32_bf16 v197, v114, v50
    v_dot2c_f32_bf16 v198, v100, v51
    v_dot2c_f32_bf16 v199, v114, v51
    s_waitcnt vmcnt(11)
    v_dot2c_f32_bf16 v192, v101, v52
    v_dot2c_f32_bf16 v193, v115, v52
    v_dot2c_f32_bf16 v194, v101, v53
    v_dot2c_f32_bf16 v195, v115, v53
    v_dot2c_f32_bf16 v196, v101, v54
    v_dot2c_f32_bf16 v197, v115, v54
    v_dot2c_f32_bf16 v198, v101, v55
    v_dot2c_f32_bf16 v199, v115, v55
    s_waitcnt vmcnt(10)
    v_dot2c_f32_bf16 v192, v102, v56
    v_dot2c_f32_bf16 v193, v116, v56
    v_dot2c_f32_bf16 v194, v102, v57
    v_dot2c_f32_bf16 v195, v116, v57
    v_dot2c_f32_bf16 v196, v102, v58
    v_dot2c_f32_bf16 v197, v116, v58
    v_dot2c_f32_bf16 v198, v102, v59
    v_dot2c_f32_bf16 v199, v116, v59
    s_waitcnt vmcnt(9)
    v_dot2c_f32_bf16 v192, v103, v60
    v_dot2c_f32_bf16 v193, v117, v60
    v_dot2c_f32_bf16 v194, v103, v61
    v_dot2c_f32_bf16 v195, v117, v61
    v_dot2c_f32_bf16 v196, v103, v62
    v_dot2c_f32_bf16 v197, v117, v62
    v_dot2c_f32_bf16 v198, v103, v63
    v_dot2c_f32_bf16 v199, v117, v63
    s_waitcnt vmcnt(8)
    v_dot2c_f32_bf16 v192, v104, v64
    v_dot2c_f32_bf16 v193, v118, v64
    v_dot2c_f32_bf16 v194, v104, v65
    v_dot2c_f32_bf16 v195, v118, v65
    v_dot2c_f32_bf16 v196, v104, v66
    v_dot2c_f32_bf16 v197, v118, v66
    v_dot2c_f32_bf16 v198, v104, v67
    v_dot2c_f32_bf16 v199, v118, v67
    s_waitcnt vmcnt(7)
    v_dot2c_f32_bf16 v192, v105, v68
    v_dot2c_f32_bf16 v193, v119, v68
    v_dot2c_f32_bf16 v194, v105, v69
    v_dot2c_f32_bf16 v195, v119, v69
    v_dot2c_f32_bf16 v196, v105, v70
    v_dot2c_f32_bf16 v197, v119, v70
    v_dot2c_f32_bf16 v198, v105, v71
    v_dot2c_f32_bf16 v199, v119, v71
    s_waitcnt vmcnt(6)
    v_dot2c_f32_bf16 v192, v106, v72
    v_dot2c_f32_bf16 v193, v120, v72
    v_dot2c_f32_bf16 v194, v106, v73
    v_dot2c_f32_bf16 v195, v120, v73
    v_dot2c_f32_bf16 v196, v106, v74
    v_dot2c_f32_bf16 v197, v120, v74
    v_dot2c_f32_bf16 v198, v106, v75
    v_dot2c_f32_bf16 v199, v120, v75
    s_waitcnt vmcnt(5)
    v_dot2c_f32_bf16 v192, v107, v76
    v_dot2c_f32_bf16 v193, v121, v76
    v_dot2c_f32_bf16 v194, v107, v77
    v_dot2c_f32_bf16 v195, v121, v77
    v_dot2c_f32_bf16 v196, v107, v78
    v_dot2c_f32_bf16 v197, v121, v78
    v_dot2c_f32_bf16 v198, v107, v79
    v_dot2c_f32_bf16 v199, v121, v79
    s_waitcnt vmcnt(4)
    v_dot2c_f32_bf16 v192, v108, v80
    v_dot2c_f32_bf16 v193, v122, v80
    v_dot2c_f32_bf16 v194, v108, v81
    v_dot2c_f32_bf16 v195, v122, v81
    v_dot2c_f32_bf16 v196, v108, v82
    v_dot2c_f32_bf16 v197, v122, v82
    v_dot2c_f32_bf16 v198, v108, v83
    v_dot2c_f32_bf16 v199, v122, v83
    s_waitcnt vmcnt(3)
    v_dot2c_f32_bf16 v192, v109, v84
    v_dot2c_f32_bf16 v193, v123, v84
    v_dot2c_f32_bf16 v194, v109, v85
    v_dot2c_f32_bf16 v195, v123, v85
    v_dot2c_f32_bf16 v196, v109, v86
    v_dot2c_f32_bf16 v197, v123, v86
    v_dot2c_f32_bf16 v198, v109, v87
    v_dot2c_f32_bf16 v199, v123, v87
    v_add_f32_dpp v192, v192, v192 row_ror:8 row_mask:0xf bank_mask:0xf
    v_add_f32_dpp v193, v193, v193 row_ror:8 row_mask:0xf bank_mask:0xf
    v_add_f32_dpp v194, v194, v194 row_ror:8 row_mask:0xf bank_mask:0xf
    v_add_f32_dpp v195, v195, v195 row_ror:8 row_mask:0xf bank_mask:0xf
    v_add_f32_dpp v196, v196, v196 row_ror:8 row_mask:0xf bank_mask:0xf
    v_add_f32_dpp v197, v197, v197 row_ror:8 row_mask:0xf bank_mask:0xf
    v_add_f32_dpp v198, v198, v198 row_ror:8 row_mask:0xf bank_mask:0xf
    v_add_f32_dpp v199, v199, v199 row_ror:8 row_mask:0xf bank_mask:0xf
    s_mov_b32 exec_lo, 0x00ff00ff
    s_mov_b32 exec_hi, 0x00ff00ff
    ds_write_b128 v200, v[192:195] offset:8192
    ds_write_b128 v200, v[196:199] offset:8208
    s_mov_b64 exec, -1
    s_waitcnt vmcnt(1)
    s_waitcnt lgkmcnt(0)
    s_barrier
    s_cmp_lg_u32 s16, 0
    s_cbranch_scc1 L_g2
    v_lshlrev_b32 v3, 2, v2
    ds_read2st64_b32 v[32:33], v3 offset0:32 offset1:33
    ds_read2st64_b32 v[34:35], v3 offset0:34 offset1:35
    ds_read2st64_b32 v[36:37], v3 offset0:36 offset1:37
    ds_read2st64_b32 v[38:39], v3 offset0:38 offset1:39
    ds_read2st64_b32 v[40:41], v3 offset0:40 offset1:41
    ds_read2st64_b32 v[42:43], v3 offset0:42 offset1:43
    ds_read2st64_b32 v[44:45], v3 offset0:44 offset1:45
    ds_read2st64_b32 v[46:47], v3 offset0:46 offset1:47
    s_cmp_eq_u32 s77, 1
    s_cselect_b64 s[4:5], -1, 0
    s_cmp_eq_u32 s77, 4
    s_cselect_b64 s[4:5], -1, s[4:5]
    s_cmp_eq_u32 s77, 2
    s_cselect_b32 s3, 0x35924925, 1.0
    s_waitcnt lgkmcnt(0)
    v_add_f32 v32, v32, v40
    v_add_f32 v33, v33, v41
    v_add_f32 v34, v34, v42
    v_add_f32 v35, v35, v43
    v_add_f32 v36, v36, v44
    v_add_f32 v37, v37, v45
    v_add_f32 v38, v38, v46
    v_add_f32 v39, v39, v47
    v_add_f32 v32, v32, v36
    v_add_f32 v33, v33, v37
    v_add_f32 v34, v34, v38
    v_add_f32 v35, v35, v39
    v_add_f32 v32, v32, v34
    v_add_f32 v33, v33, v35
    v_add_f32 v32, v32, v33
    v_cvt_pk_bf16_f32 v32, 0, v32
    v_add_f32 v33, 1.0, v32
    v_mul_f32 v32, s3, v32
    v_cvt_pk_bf16_f32 v33, 0, v33
    v_cndmask_b32 v32, v32, v33, s[4:5]
    buffer_store_dword v32, v202, s[12:15], 0 offen sc1
    buffer_store_short_d16_hi v32, v203, s[12:15], 0 offen sc1
L_g2:
    s_barrier
    buffer_load_dword v204, v204, s[56:59], 0 offen
    buffer_load_dword v205, v205, s[56:59], 0 offen
    global_load_dwordx4 v[248:251], v[0:1], off offset:-3072
    s_mov_b32 s8, s32
    s_and_b32 s9, s33, 0xffff
    s_mov_b32 s10, 0x1c0000
    s_mov_b32 s11, 0x20000
    v_mul_u32_u24 v3, 28672, v2
    s_mul_i32 s54, s22, 896
    s_lshl_b32 s3, s16, 8
    s_add_u32 s54, s54, s3
    s_lshl_b32 s3, s23, 4
    s_add_u32 s54, s54, s3
    s_lshl_b32 s55, s16, 11
    s_add_u32 m0, s55, 28672
    s_nop 0
    buffer_load_dwordx4 v3, s[8:11], s54 offen lds
    s_add_u32 m0, s55, 29568
    s_cmp_eq_u32 s16, 3
    s_cselect_b32 s54, 2143289088, s54
    buffer_load_dwordx4 v3, s[8:11], s54 offen offset:128 lds
    s_add_u32 s26, s68, 1048576
    s_add_u32 s27, s68, 1077248
    s_mov_b32 s25, 0x3f803f80
    s_mov_b32 s64, s44
    s_and_b32 s65, s45, 0xffff
    s_mov_b32 s66, 0x188000
    s_mov_b32 s67, 0x20000
    v_min_u32 v14, 55, v2
    v_lshlrev_b32 v14, 7, v14
    s_mul_i32 s71, s16, 401408
    s_mul_i32 s3, s19, 7168
    s_add_u32 s71, s71, s3
    s_sub_u32 s3, s2, 224
    s_lshl_b32 s3, s3, 2
    s_add_u32 s3, s3, s16
    s_mul_i32 s3, s3, 102
    v_min_u32 v15, 50, v2
    v_add_lshl_u32 v15, s3, v15, 7
    ds_read_b128 a[224:227], v9 offset:0
    ds_read_b128 a[228:231], v9 offset:1024
    ds_read_b128 a[232:235], v9 offset:2048
    ds_read_b128 a[236:239], v9 offset:3072
    ds_read_b128 a[240:243], v9 offset:4096
    ds_read_b128 a[244:247], v9 offset:5120
    ds_read_b128 a[248:251], v9 offset:6144
    ds_read_b128 a[252:255], v9 offset:7168
    s_cmp_eq_u32 s16, 0
    s_cselect_b64 s[52:53], -1, 0
    v_min_u32 v253, 13, v2
    v_add_u32 v253, 128, v253
    v_lshlrev_b32 v253, 7, v253
    buffer_load_dwordx2 v[92:93], v253, s[12:15], 0 offen sc1
    buffer_load_dwordx2 v[30:31], v6, s[12:15], 0 offen sc1
    s_waitcnt vmcnt(1)
    v_xor_b32 v93, v92, v93
    v_subrev_u32 v94, s70, v92
    v_xor_b32 v93, 0x5bd1e995, v93
    v_lshrrev_b32 v92, 14, v94
    v_or_b32 v92, v92, v93
    v_cmp_ne_u32 vcc, 0, v92
    s_nop 0
    s_and_b64 vcc, vcc, exec
    s_cbranch_scc1 L_slow_s2gm
L_back_s2gm:
    v_max_u32_dpp v94, v94, v94 row_ror:8 row_mask:0xf bank_mask:0xf
    s_nop 1
    v_max_u32_dpp v94, v94, v94 row_ror:4 row_mask:0xf bank_mask:0xf
    s_nop 1
    v_max_u32_dpp v94, v94, v94 row_ror:2 row_mask:0xf bank_mask:0xf
    s_nop 1
    v_max_u32_dpp v94, v94, v94 row_ror:1 row_mask:0xf bank_mask:0xf
    s_nop 0
    v_readfirstlane_b32 s35, v94
    s_nop 0
    s_min_u32 s35, s35, 512
    s_add_u32 s35, s35, s70
    s_waitcnt vmcnt(0)
    v_xor_b32 v31, v30, v31
    v_subrev_u32 v30, s70, v30
    v_xor_b32 v31, 0x5bd1e995, v31
    v_lshrrev_b32 v30, 14, v30
    v_or_b32 v30, v30, v31
    v_cmp_ne_u32 vcc, 0, v30
    s_nop 0
    s_and_b64 vcc, vcc, s[52:53]
    s_cbranch_scc1 L_slow_s2m
L_back_s2m:
    s_waitcnt lgkmcnt(0)
    s_barrier
    s_lshl_b32 s5, s23, 5
    s_min_u32 s4, s16, 1
    s_sub_u32 s4, s4, 1
    s_and_b32 s5, s5, s4
    v_lshrrev_b32 v23, 1, v8
    v_mul_u32_u24 v23, 3, v23
    v_mad_u32_u16 v16, v248, 16, 0
    v_lshlrev_b32 v23, v23, s5
    v_add_u32 v16, v16, v23
    buffer_load_dwordx4 v[28:31], v16, s[12:15], 0 offen sc1
    v_mad_i32_i16 v20, v248, 16, 0 op_sel:[1,0,0,0]
    v_mad_i32_i16 v21, v249, 16, 0
    v_mad_u32_u16 v22, v249, 16, 0 op_sel:[1,0,0,0]
    v_mad_u32_u16 v248, v250, 16, 0
    v_mad_u32_u16 v249, v250, 16, 0 op_sel:[1,0,0,0]
    v_mad_u32_u16 v250, v251, 8, 0
    v_mad_u32_u16 v251, v251, 16, 0 op_sel:[1,0,0,0]
    ds_read_b128 v[208:211], v251 offset:0
    ds_read_b128 v[212:215], v251 offset:512
    s_min_u32 s3, s16, 2
    s_lshl_b32 s3, s3, 10
    s_add_u32 s3, s3, 0
    v_add_u32 v17, s3, v9
    v_and_b32 v20, 0x7fffffff, v20
    v_and_b32 v21, 0x7fffffff, v21
    v_and_b32 v32, 7, v7
    v_lshrrev_b32 v33, 3, v7
    v_lshl_add_u32 v33, s16, 1, v33
    v_lshl_add_u32 v34, v33, 6, v32
    v_lshl_add_u32 v34, s23, 3, v34
    v_mul_u32_u24 v34, v34, v8
    v_cvt_f32_u32 v34, v34
    v_mul_f32 v34, 0x3b124925, v34
    v_cos_f32 v35, v34
    v_sin_f32 v36, v34
    v_cmp_eq_u32 vcc, 0, v8
    v_cmp_gt_u32 s[4:5], 7, v33
    s_mov_b32 s0, 0x01010101
    s_mov_b32 s1, 0x01010101
    v_cndmask_b32 v37, 2.0, 1.0, vcc
    v_cndmask_b32 v37, 0, v37, s[4:5]
    v_mul_f32 v35, v35, v37
    v_mul_f32 v36, v36, v37
    v_cvt_pk_bf16_f32 v38, v35, -v36
    v_cvt_pk_bf16_f32 v39, v36, v35
    v_cndmask_b32 v96, 0, v38, s[0:1]
    v_cndmask_b32 v100, 0, v39, s[0:1]
    s_lshl_b64 s[0:1], s[0:1], 1
    v_cndmask_b32 v97, 0, v38, s[0:1]
    v_cndmask_b32 v101, 0, v39, s[0:1]
    s_lshl_b64 s[0:1], s[0:1], 1
    v_cndmask_b32 v98, 0, v38, s[0:1]
    v_cndmask_b32 v102, 0, v39, s[0:1]
    s_lshl_b64 s[0:1], s[0:1], 1
    v_cndmask_b32 v99, 0, v38, s[0:1]
    v_cndmask_b32 v103, 0, v39, s[0:1]
    s_lshl_b64 s[0:1], s[0:1], 1
    v_cndmask_b32 v104, 0, v38, s[0:1]
    v_cndmask_b32 v108, 0, v39, s[0:1]
    s_lshl_b64 s[0:1], s[0:1], 1
    v_cndmask_b32 v105, 0, v38, s[0:1]
    v_cndmask_b32 v109, 0, v39, s[0:1]
    s_lshl_b64 s[0:1], s[0:1], 1
    v_cndmask_b32 v106, 0, v38, s[0:1]
    v_cndmask_b32 v110, 0, v39, s[0:1]
    s_lshl_b64 s[0:1], s[0:1], 1
    v_cndmask_b32 v107, 0, v38, s[0:1]
    v_cndmask_b32 v111, 0, v39, s[0:1]
    v_lshrrev_b32 v19, 1, v9
    s_waitcnt lgkmcnt(1)
    v_cndmask_b32 v208, 0, v208, s[20:21]
    v_cndmask_b32 v209, 0, v209, s[20:21]
    v_cndmask_b32 v210, 0, v210, s[20:21]
    v_cndmask_b32 v211, 0, v211, s[20:21]
    s_waitcnt lgkmcnt(0)
    v_cndmask_b32 v212, 0, v212, s[20:21]
    v_cndmask_b32 v213, 0, v213, s[20:21]
    v_cndmask_b32 v214, 0, v214, s[20:21]
    v_cndmask_b32 v215, 0, v215, s[20:21]
    v_lshlrev_b32 v232, 16, v208
    v_and_b32 v233, 0xffff0000, v208
    v_lshlrev_b32 v234, 16, v209
    v_and_b32 v235, 0xffff0000, v209
    v_lshlrev_b32 v236, 16, v210
    v_and_b32 v237, 0xffff0000, v210
    v_lshlrev_b32 v238, 16, v211
    v_and_b32 v239, 0xffff0000, v211
    v_lshlrev_b32 v240, 16, v212
    v_and_b32 v241, 0xffff0000, v212
    v_lshlrev_b32 v242, 16, v213
    v_and_b32 v243, 0xffff0000, v213
    v_lshlrev_b32 v244, 16, v214
    v_and_b32 v245, 0xffff0000, v214
    v_lshlrev_b32 v246, 16, v215
    v_and_b32 v247, 0xffff0000, v215
    s_waitcnt vmcnt(0)
    v_max3_u32 v27, v28, v29, v30
    v_max_u32 v27, v27, v31
    v_cmp_eq_u32 vcc, -1, v27
    s_cbranch_vccnz L_slow_mpm
L_back_mpm:
    ds_write_b128 v17, v[28:31]
    s_memrealtime s[0:1]
    s_waitcnt lgkmcnt(0)
    s_sub_u32 s1, s0, s35
L_gatez:
    s_cmp_ge_i32 s1, 620
    s_cbranch_scc1 L_openz
    s_add_u32 s1, s1, 4
    s_nop 15
    s_branch L_gatez
L_openz:
    buffer_load_dwordx4 v[48:51], v20, s[12:15], s73 offen sc1
    buffer_load_dwordx4 v[52:55], v21, s[12:15], s73 offen sc1
    s_lshr_b32 s4, s22, 1
    s_lshl_b32 s4, s4, 11
    s_add_u32 s4, s4, 6307968
    v_lshl_add_u32 v30, v2, 9, s4
    v_mov_b32 v31, 1
    s_cmp_eq_u32 s16, 0
    s_cselect_b64 vcc, 15, 0
    v_mov_b32 v16, 2147483392
    v_cndmask_b32 v16, v16, v30, vcc
    s_waitcnt lgkmcnt(0)
    s_barrier
    ds_read_b128 v[216:219], v249 offset:0
    ds_read_b128 v[224:227], v249 offset:256
    ds_read_b128 v[220:223], v249 offset:16
    ds_read_b128 v[228:231], v249 offset:272
    s_waitcnt lgkmcnt(2)
    v_mul_f32 v208, v216, v224
    v_mul_f32 v209, v217, v225
    v_mul_f32 v210, v218, v226
    v_mul_f32 v211, v219, v227
    s_waitcnt lgkmcnt(0)
    v_mul_f32 v212, v220, v228
    v_mul_f32 v213, v221, v229
    v_mul_f32 v214, v222, v230
    v_mul_f32 v215, v223, v231
    v_mul_f32 v32, v232, v224
    v_mul_f32 v33, v233, v225
    v_mul_f32 v34, v234, v226
    v_mul_f32 v35, v235, v227
    v_mul_f32 v36, v236, v228
    v_mul_f32 v37, v237, v229
    v_mul_f32 v38, v238, v230
    v_mul_f32 v39, v239, v231
    v_mul_f32 v40, v240, v224
    v_mul_f32 v41, v241, v225
    v_mul_f32 v42, v242, v226
    v_mul_f32 v43, v243, v227
    v_mul_f32 v44, v244, v228
    v_mul_f32 v45, v245, v229
    v_mul_f32 v46, v246, v230
    v_mul_f32 v47, v247, v231
    s_waitcnt vmcnt(1)
    v_max3_u32 v27, v48, v49, v50
    s_waitcnt vmcnt(0)
    v_max3_u32 v27, v27, v51, v52
    v_max3_u32 v27, v27, v53, v54
    v_max_u32 v27, v27, v55
    v_cmp_eq_u32 vcc, -1, v27
    s_cbranch_vccnz L_slow_zm
L_back_zm:
    s_memrealtime s[0:1]
    ds_write_b128 v22, v[48:51] offset:0
    ds_write_b128 v22, v[52:55] offset:512
    s_waitcnt lgkmcnt(0)
    s_barrier
    ds_read_b128 v[64:67], v248 offset:0
    ds_read_b128 v[80:83], v248 offset:4112
    ds_read_b128 v[68:71], v248 offset:2048
    ds_read_b128 v[84:87], v248 offset:6160
    ds_read_b128 v[72:75], v248 offset:512
    ds_read_b128 v[88:91], v248 offset:4624
    ds_read_b128 v[76:79], v248 offset:2560
    ds_read_b128 v[92:95], v248 offset:6672
    v_mov_b32 v56, s0
    v_xor_b32 v57, 0x5bd1e995, v56
    buffer_store_dwordx2 v[56:57], v254, s[12:15], 0 offen sc1
    s_waitcnt lgkmcnt(7)
    v_mfma_f32_16x16x32_bf16 v[112:115], v[64:67], v[96:99], 0
    v_mfma_f32_16x16x32_bf16 v[116:119], v[64:67], v[100:103], 0
    s_waitcnt lgkmcnt(6)
    v_mfma_f32_16x16x32_bf16 v[112:115], v[80:83], v[104:107], v[112:115]
    v_mfma_f32_16x16x32_bf16 v[116:119], v[80:83], v[108:111], v[116:119]
    s_waitcnt lgkmcnt(5)
    v_mfma_f32_16x16x32_bf16 v[120:123], v[68:71], v[96:99], 0
    v_mfma_f32_16x16x32_bf16 v[124:127], v[68:71], v[100:103], 0
    s_waitcnt lgkmcnt(4)
    v_mfma_f32_16x16x32_bf16 v[120:123], v[84:87], v[104:107], v[120:123]
    v_cvt_pk_bf16_f32 v144, v112, v113
    v_cvt_pk_bf16_f32 v148, v116, v117
    v_mfma_f32_16x16x32_bf16 v[124:127], v[84:87], v[108:111], v[124:127]
    v_cvt_pk_bf16_f32 v145, v114, v115
    v_cvt_pk_bf16_f32 v149, v118, v119
    s_waitcnt lgkmcnt(3)
    v_mfma_f32_16x16x32_bf16 v[128:131], v[72:75], v[96:99], 0
    v_mfma_f32_16x16x32_bf16 v[132:135], v[72:75], v[100:103], 0
    s_waitcnt lgkmcnt(2)
    v_mfma_f32_16x16x32_bf16 v[128:131], v[88:91], v[104:107], v[128:131]
    v_cvt_pk_bf16_f32 v146, v120, v121
    v_cvt_pk_bf16_f32 v147, v122, v123
    v_mfma_f32_16x16x32_bf16 v[132:135], v[88:91], v[108:111], v[132:135]
    v_cvt_pk_bf16_f32 v150, v124, v125
    v_cvt_pk_bf16_f32 v151, v126, v127
    s_waitcnt lgkmcnt(1)
    v_mfma_f32_16x16x32_bf16 v[136:139], v[76:79], v[96:99], 0
    v_mfma_f32_16x16x32_bf16 v[140:143], v[76:79], v[100:103], 0
    s_waitcnt lgkmcnt(0)
    v_mfma_f32_16x16x32_bf16 v[136:139], v[92:95], v[104:107], v[136:139]
    v_cvt_pk_bf16_f32 v152, v128, v129
    v_cvt_pk_bf16_f32 v156, v132, v133
    v_mfma_f32_16x16x32_bf16 v[140:143], v[92:95], v[108:111], v[140:143]
    v_cvt_pk_bf16_f32 v153, v130, v131
    v_cvt_pk_bf16_f32 v157, v134, v135
    v_mfma_f32_16x16x32_bf16 v[192:195], v[144:147], a[224:227], 0
    v_mov_b32 v100, 0
    v_mov_b32 v101, 0
    v_mfma_f32_16x16x32_bf16 v[200:203], v[144:147], a[240:243], 0
    v_cvt_pk_bf16_f32 v154, v136, v137
    v_cvt_pk_bf16_f32 v155, v138, v139
    v_mfma_f32_16x16x32_bf16 v[192:195], v[148:151], a[228:231], v[192:195]
    v_cvt_pk_bf16_f32 v158, v140, v141
    v_cvt_pk_bf16_f32 v159, v142, v143
    v_mfma_f32_16x16x32_bf16 v[200:203], v[148:151], a[244:247], v[200:203]
    v_mov_b32 v102, 0
    v_mov_b32 v103, 0
    v_mfma_f32_16x16x32_bf16 v[196:199], v[152:155], a[232:235], 0
    v_mfma_f32_16x16x32_bf16 v[204:207], v[152:155], a[248:251], 0
    v_mfma_f32_16x16x32_bf16 v[196:199], v[156:159], a[236:239], v[196:199]
    v_mfma_f32_16x16x32_bf16 v[204:207], v[156:159], a[252:255], v[204:207]
    s_nop 4
    v_add_f32 v64, v192, v196
    v_add_f32 v65, v193, v197
    v_add_f32 v66, v194, v198
    v_add_f32 v67, v195, v199
    v_add_f32 v68, v200, v204
    v_add_f32 v69, v201, v205
    v_add_f32 v70, v202, v206
    v_add_f32 v71, v203, v207
    v_permlane16_swap_b32 v64, v68
    v_permlane16_swap_b32 v65, v69
    v_permlane16_swap_b32 v66, v70
    v_permlane16_swap_b32 v67, v71
    v_fmac_f32 v32, v64, v208
    v_fmac_f32 v33, v65, v209
    v_fmac_f32 v34, v66, v210
    v_fmac_f32 v35, v67, v211
    v_fmac_f32 v36, v68, v212
    v_fmac_f32 v37, v69, v213
    v_fmac_f32 v38, v70, v214
    v_fmac_f32 v39, v71, v215
    v_cvt_pk_bf16_f32 v88, v32, v33
    v_cvt_pk_bf16_f32 v89, v34, v35
    v_cvt_pk_bf16_f32 v90, v36, v37
    v_cvt_pk_bf16_f32 v91, v38, v39
    s_mov_b64 exec, s[20:21]
    buffer_store_dwordx4 v[88:91], v4, s[12:15], s6 offen sc1
    s_mov_b64 exec, -1
    v_sub_f32 v72, v192, v196
    v_sub_f32 v73, v193, v197
    v_sub_f32 v74, v194, v198
    v_sub_f32 v75, v195, v199
    v_sub_f32 v76, v200, v204
    v_sub_f32 v77, v201, v205
    v_sub_f32 v78, v202, v206
    v_sub_f32 v79, v203, v207
    v_permlane16_swap_b32 v72, v76
    v_permlane16_swap_b32 v73, v77
    v_permlane16_swap_b32 v74, v78
    v_permlane16_swap_b32 v75, v79
    v_fmac_f32 v40, v72, v208
    v_fmac_f32 v41, v73, v209
    v_fmac_f32 v42, v74, v210
    v_fmac_f32 v43, v75, v211
    v_fmac_f32 v44, v76, v212
    v_fmac_f32 v45, v77, v213
    v_fmac_f32 v46, v78, v214
    v_fmac_f32 v47, v79, v215
    v_cvt_pk_bf16_f32 v92, v40, v41
    v_cvt_pk_bf16_f32 v93, v42, v43
    v_cvt_pk_bf16_f32 v94, v44, v45
    v_cvt_pk_bf16_f32 v95, v46, v47
    s_mov_b64 exec, s[20:21]
    buffer_store_dwordx4 v[92:95], v4, s[12:15], s7 offen sc1
    v_fma_f32 v64, v64, v216, v232
    v_fma_f32 v65, v65, v217, v233
    v_fma_f32 v66, v66, v218, v234
    v_fma_f32 v67, v67, v219, v235
    v_fma_f32 v68, v68, v220, v236
    v_fma_f32 v69, v69, v221, v237
    v_fma_f32 v70, v70, v222, v238
    v_fma_f32 v71, v71, v223, v239
    v_cvt_pk_bf16_f32 v80, v64, v65
    v_cvt_pk_bf16_f32 v81, v66, v67
    v_cvt_pk_bf16_f32 v82, v68, v69
    v_cvt_pk_bf16_f32 v83, v70, v71
    v_fma_f32 v72, v72, v216, v240
    v_fma_f32 v73, v73, v217, v241
    v_fma_f32 v74, v74, v218, v242
    v_fma_f32 v75, v75, v219, v243
    v_fma_f32 v76, v76, v220, v244
    v_fma_f32 v77, v77, v221, v245
    v_fma_f32 v78, v78, v222, v246
    v_fma_f32 v79, v79, v223, v247
    v_cvt_pk_bf16_f32 v84, v72, v73
    v_cvt_pk_bf16_f32 v85, v74, v75
    v_cvt_pk_bf16_f32 v86, v76, v77
    v_cvt_pk_bf16_f32 v87, v78, v79
    v_dot2c_f32_bf16 v100, s25, v80
    v_dot2c_f32_bf16 v101, v80, v80
    v_dot2c_f32_bf16 v102, s25, v84
    v_dot2c_f32_bf16 v103, v84, v84
    v_dot2c_f32_bf16 v100, s25, v81
    v_dot2c_f32_bf16 v101, v81, v81
    v_dot2c_f32_bf16 v102, s25, v85
    v_dot2c_f32_bf16 v103, v85, v85
    v_dot2c_f32_bf16 v100, s25, v82
    v_dot2c_f32_bf16 v101, v82, v82
    v_dot2c_f32_bf16 v102, s25, v86
    v_dot2c_f32_bf16 v103, v86, v86
    v_dot2c_f32_bf16 v100, s25, v83
    v_dot2c_f32_bf16 v101, v83, v83
    v_dot2c_f32_bf16 v102, s25, v87
    v_dot2c_f32_bf16 v103, v87, v87
    s_mov_b64 exec, -1
    ds_write_b64 v250, v[100:101] offset:0
    s_nop 0
    ds_write_b64 v250, v[102:103] offset:256
    s_mov_b64 exec, s[20:21]
    buffer_store_dwordx4 v[80:83], v4, s[12:15], s26 offen sc1
    buffer_store_dwordx4 v[84:87], v4, s[12:15], s27 offen sc1
    s_mov_b64 exec, -1
    s_waitcnt lgkmcnt(0)
    s_barrier
    ds_read_b64 v[64:65], v19 offset:3072
    ds_read_b64 v[66:67], v19 offset:3584
    ds_read_b64 v[68:69], v19 offset:4096
    ds_read_b64 v[70:71], v19 offset:4608
    ds_read_b64 v[72:73], v19 offset:5120
    ds_read_b64 v[74:75], v19 offset:5632
    ds_read_b64 v[76:77], v19 offset:6144
    ds_read_b64 v[78:79], v19 offset:6656
    s_waitcnt lgkmcnt(3)
    v_add_f32 v64, v64, v72
    v_add_f32 v65, v65, v73
    s_waitcnt lgkmcnt(2)
    v_add_f32 v66, v66, v74
    v_add_f32 v67, v67, v75
    s_waitcnt lgkmcnt(1)
    v_add_f32 v68, v68, v76
    v_add_f32 v69, v69, v77
    s_waitcnt lgkmcnt(0)
    v_add_f32 v70, v70, v78
    v_add_f32 v71, v71, v79
    v_add_f32 v64, v64, v68
    v_add_f32 v65, v65, v69
    v_add_f32 v66, v66, v70
    v_add_f32 v67, v67, v71
    v_add_f32 v64, v64, v66
    v_add_f32 v65, v65, v67
    buffer_store_dwordx2 v[64:65], v5, s[12:15], s69 offen sc1
    s_waitcnt vmcnt(0) lgkmcnt(0)
    s_barrier
    buffer_atomic_add v31, v16, s[12:15], 0 offen sc1
    buffer_load_dword v140, v15, s[64:67], 0 offen
    s_movk_i32 s3, 6528
    buffer_load_dword v141, v15, s[64:67], s3 offen
    s_branch L_fin
L_xtra:
    buffer_load_dword v204, v204, s[56:59], 0 offen
    buffer_load_dword v205, v205, s[56:59], 0 offen
    s_mov_b32 s26, 0
    s_mov_b32 s24, 1
    s_mov_b32 s25, 0
    s_mov_b32 s30, 4
    s_mov_b32 s28, 0
    s_sub_u32 s75, 64, s26
    s_cmp_eq_u32 s26, 0
    s_cselect_b32 s75, 32, s75
    s_cmp_eq_u32 s24, 0
    s_cselect_b32 s27, s26, s75
    s_lshl_b32 s30, s30, 6
    s_lshl_b32 s3, s16, 14
    s_add_u32 s30, s30, s3
    s_add_u32 s30, s30, 4194304
    s_branch L_tabs
L_join:
    v_xor_b32 v93, v92, v93
    v_subrev_u32 v94, s70, v92
    v_xor_b32 v93, 0x5bd1e995, v93
    v_lshrrev_b32 v92, 14, v94
    v_or_b32 v92, v92, v93
    v_cmp_ne_u32 vcc, 0, v92
    s_nop 0
    s_and_b64 vcc, vcc, exec
    s_cbranch_scc1 L_slow_s2g
L_back_s2g:
    v_max_u32_dpp v94, v94, v94 row_ror:8 row_mask:0xf bank_mask:0xf
    s_nop 1
    v_max_u32_dpp v94, v94, v94 row_ror:4 row_mask:0xf bank_mask:0xf
    s_nop 1
    v_max_u32_dpp v94, v94, v94 row_ror:2 row_mask:0xf bank_mask:0xf
    s_nop 1
    v_max_u32_dpp v94, v94, v94 row_ror:1 row_mask:0xf bank_mask:0xf
    s_nop 0
    v_readfirstlane_b32 s35, v94
    s_nop 0
    s_min_u32 s35, s35, 512
    s_add_u32 s35, s35, s70
    s_add_u32 m0, s29, 14336
    s_waitcnt lgkmcnt(0)
    s_barrier
L_gates1:
    s_memrealtime s[44:45]
    s_waitcnt lgkmcnt(0)
    s_sub_u32 s1, s44, s35
    s_cmp_lt_i32 s1, 334
    s_cbranch_scc1 L_gates1
    buffer_load_dwordx4 v28, s[12:15], 0 offen sc1 lds
    s_add_u32 m0, s29, 0
    s_add_u32 s3, s72, 0
    buffer_load_dwordx4 v9, s[12:15], s3 offen offset:0 sc1 lds
    buffer_load_dwordx4 v9, s[12:15], s3 offen offset:1024 sc1 lds
    buffer_load_dwordx4 v9, s[12:15], s3 offen offset:2048 sc1 lds
    buffer_load_dwordx4 v9, s[12:15], s3 offen offset:3072 sc1 lds
    s_add_u32 m0, s29, 4096
    s_add_u32 s3, s72, 4096
    buffer_load_dwordx4 v9, s[12:15], s3 offen offset:0 sc1 lds
    buffer_load_dwordx4 v9, s[12:15], s3 offen offset:1024 sc1 lds
    buffer_load_dwordx4 v9, s[12:15], s3 offen offset:2048 sc1 lds
    buffer_load_dwordx4 v9, s[12:15], s3 offen offset:3072 sc1 lds
    s_add_u32 m0, s29, 8192
    s_add_u32 s3, s72, 8192
    buffer_load_dwordx4 v9, s[12:15], s3 offen offset:0 sc1 lds
    buffer_load_dwordx4 v9, s[12:15], s3 offen offset:1024 sc1 lds
    buffer_load_dwordx4 v9, s[12:15], s3 offen offset:2048 sc1 lds
    buffer_load_dwordx4 v9, s[12:15], s3 offen offset:3072 sc1 lds
    s_waitcnt vmcnt(13)
    ds_read_u16_d16_hi v232, v15 offset:15360
    ds_read_u16_d16_hi v240, v15 offset:16384
    ds_read_u16_d16_hi v233, v15 offset:17408
    ds_read_u16_d16_hi v241, v15 offset:18432
    ds_read_u16_d16_hi v234, v15 offset:19456
    ds_read_u16_d16_hi v242, v15 offset:20480
    ds_read_u16_d16_hi v235, v15 offset:21504
    ds_read_u16_d16_hi v243, v15 offset:22528
    ds_read_u16_d16_hi v236, v15 offset:23552
    ds_read_u16_d16_hi v244, v15 offset:24576
    ds_read_u16_d16_hi v237, v15 offset:25600
    ds_read_u16_d16_hi v245, v15 offset:26624
    ds_read_u16_d16_hi v238, v15 offset:27648
    ds_read_u16_d16_hi v246, v15 offset:28672
    ds_read_u16_d16_hi v239, v15 offset:29696
    ds_read_u16_d16_hi v247, v15 offset:30720
    s_mov_b32 s47, s46
    s_cmp_ge_u32 s16, 2
    s_cselect_b32 s4, -1.0, 1.0
    v_cndmask_b32 v76, 1.0, 0.5, s[46:47]
    v_cndmask_b32 v77, 0, 0.5, s[46:47]
    v_mul_f32 v78, s4, v76
    v_mul_f32 v79, s4, -v77
    s_sub_u32 s44, s44, s70
    s_sub_u32 s44, s44, 6
    s_min_u32 s44, s44, 0x3fff
    s_add_u32 s26, s68, 1048576
    s_add_u32 s27, s68, 1077248
    s_mov_b32 s25, 0x3f803f80
    ds_read_b128 a[224:227], v9 offset:0
    s_waitcnt lgkmcnt(15)
    v_mul_f32 v232, v76, v232
    v_mul_f32 v240, v78, v240
    ds_read_b128 a[228:231], v9 offset:1024
    s_waitcnt lgkmcnt(15)
    v_mul_f32 v233, v76, v233
    s_waitcnt lgkmcnt(14)
    v_mul_f32 v241, v78, v241
    v_fmac_f32_dpp v232, v30, v77 quad_perm:[0,1,2,3] row_mask:0xf bank_mask:0xf
    ds_read_b128 a[232:235], v9 offset:2048
    v_fmac_f32_dpp v240, v31, v79 quad_perm:[0,1,2,3] row_mask:0xf bank_mask:0xf
    s_waitcnt lgkmcnt(14)
    v_mul_f32 v234, v76, v234
    s_waitcnt lgkmcnt(13)
    v_mul_f32 v242, v78, v242
    ds_read_b128 a[236:239], v9 offset:3072
    v_fmac_f32_dpp v233, v30, v77 row_shl:1 row_mask:0xf bank_mask:0xf bound_ctrl:0
    v_fmac_f32_dpp v241, v31, v79 row_shl:1 row_mask:0xf bank_mask:0xf bound_ctrl:0
    s_waitcnt lgkmcnt(13)
    v_mul_f32 v235, v76, v235
    s_add_u32 m0, s29, 12288
    s_waitcnt lgkmcnt(12)
    v_mul_f32 v243, v78, v243
    v_fmac_f32_dpp v234, v30, v77 row_shl:2 row_mask:0xf bank_mask:0xf bound_ctrl:0
    s_add_u32 s3, s72, 12288
    v_fmac_f32_dpp v242, v31, v79 row_shl:2 row_mask:0xf bank_mask:0xf bound_ctrl:0
    s_waitcnt lgkmcnt(11)
    v_mul_f32 v236, v76, v236
    s_waitcnt lgkmcnt(10)
    v_mul_f32 v244, v78, v244
    buffer_load_dwordx4 v9, s[12:15], s3 offen offset:0 sc1 lds
    v_fmac_f32_dpp v235, v30, v77 row_shl:3 row_mask:0xf bank_mask:0xf bound_ctrl:0
    v_fmac_f32_dpp v243, v31, v79 row_shl:3 row_mask:0xf bank_mask:0xf bound_ctrl:0
    s_waitcnt lgkmcnt(9)
    v_mul_f32 v237, v76, v237
    buffer_load_dwordx4 v9, s[12:15], s3 offen offset:1024 sc1 lds
    s_waitcnt lgkmcnt(8)
    v_mul_f32 v245, v78, v245
    v_fmac_f32_dpp v236, v30, v77 row_shl:4 row_mask:0xf bank_mask:0xf bound_ctrl:0
    v_fmac_f32_dpp v244, v31, v79 row_shl:4 row_mask:0xf bank_mask:0xf bound_ctrl:0
    ds_read_b128 a[240:243], v9 offset:4096
    s_waitcnt lgkmcnt(8)
    v_mul_f32 v238, v76, v238
    s_waitcnt lgkmcnt(7)
    v_mul_f32 v246, v78, v246
    ds_read_b128 a[244:247], v9 offset:5120
    v_fmac_f32_dpp v237, v30, v77 row_shl:5 row_mask:0xf bank_mask:0xf bound_ctrl:0
    v_fmac_f32_dpp v245, v31, v79 row_shl:5 row_mask:0xf bank_mask:0xf bound_ctrl:0
    s_waitcnt lgkmcnt(7)
    v_mul_f32 v239, v76, v239
    ds_read_b128 a[248:251], v9 offset:6144
    s_waitcnt lgkmcnt(7)
    v_mul_f32 v247, v78, v247
    v_fmac_f32_dpp v238, v30, v77 row_shl:6 row_mask:0xf bank_mask:0xf bound_ctrl:0
    v_fmac_f32_dpp v246, v31, v79 row_shl:6 row_mask:0xf bank_mask:0xf bound_ctrl:0
    ds_read_b128 a[252:255], v9 offset:7168
    v_fmac_f32_dpp v239, v30, v77 row_shl:7 row_mask:0xf bank_mask:0xf bound_ctrl:0
    v_fmac_f32_dpp v247, v31, v79 row_shl:7 row_mask:0xf bank_mask:0xf bound_ctrl:0
    s_waitcnt vmcnt(14)
    ds_read2_b32 v[208:209], v29 offset0:128 offset1:136
    ds_read2_b32 v[210:211], v29 offset0:192 offset1:200
    ds_read2_b32 v[212:213], v29 offset0:0 offset1:8
    ds_read2_b32 v[214:215], v29 offset0:64 offset1:72
    s_lshl_b32 s3, s16, 11
    s_add_u32 s3, s3, 32768
    buffer_load_dwordx4 a[220:223], v9, s[12:15], s3 offen sc1
    s_mov_b64 exec, s[20:21]
    buffer_store_dwordx4 v[248:251], v4, s[12:15], s6 offen sc1
    s_mov_b64 exec, -1
    buffer_store_dwordx2 v[248:249], v5, s[12:15], s69 offen sc1
    s_waitcnt lgkmcnt(2)
    v_max3_u32 v27, v208, v209, v210
    s_waitcnt lgkmcnt(1)
    v_max3_u32 v27, v27, v211, v212
    s_waitcnt lgkmcnt(0)
    v_max3_u32 v27, v27, v213, v214
    v_max_u32 v27, v27, v215
    v_cmp_eq_u32 vcc, -1, v27
    s_cbranch_vccnz L_slow_ca
L_back_ca:
    v_mul_f32 v68, v208, v216
    v_mul_f32 v69, v208, v220
    v_mul_f32 v70, v209, v217
    v_mul_f32 v71, v209, v221
    v_mul_f32 v72, v210, v218
    v_mul_f32 v73, v210, v222
    v_mul_f32 v74, v211, v219
    v_mul_f32 v75, v211, v223
    v_mul_f32 v212, v212, v216
    v_cvt_pk_bf16_f32 v224, v68, v69
    v_mul_f32 v213, v213, v217
    v_cvt_pk_bf16_f32 v225, v70, v71
    v_mul_f32 v214, v214, v218
    v_cvt_pk_bf16_f32 v226, v72, v73
    v_mul_f32 v215, v215, v219
    v_cvt_pk_bf16_f32 v227, v74, v75
    v_mul_f32 v212, s75, v212
    v_and_b32 v224, s74, v224
    v_mul_f32 v213, s75, v213
    v_and_b32 v225, s74, v225
    v_mul_f32 v214, s75, v214
    v_and_b32 v226, s74, v226
    v_mul_f32 v215, s75, v215
    v_and_b32 v227, s74, v227
    v_cvt_pk_bf16_f32 v192, v212, v214
    v_cvt_pk_bf16_f32 v196, v213, v215
    v_lshlrev_b32 v68, 16, v192
    v_and_b32 v69, 0xffff0000, v192
    v_lshlrev_b32 v70, 16, v196
    v_and_b32 v71, 0xffff0000, v196
    v_sub_f32 v68, v212, v68
    v_sub_f32 v69, v214, v69
    v_sub_f32 v70, v213, v70
    v_sub_f32 v71, v215, v71
    v_cvt_pk_bf16_f32 v193, v68, v69
    v_cvt_pk_bf16_f32 v197, v70, v71
    v_cndmask_b32 v32, 0, v224, s[32:33]
    v_cndmask_b32 v48, 0, v225, s[32:33]
    v_cndmask_b32 v36, 0, v226, s[32:33]
    v_cndmask_b32 v52, 0, v227, s[32:33]
    s_lshl_b64 s[32:33], s[32:33], 2
    v_mfma_f32_16x16x32_bf16 v[204:207], v[192:195], v[200:203], 0
    v_cndmask_b32 v33, 0, v224, s[32:33]
    v_cndmask_b32 v49, 0, v225, s[32:33]
    v_cndmask_b32 v37, 0, v226, s[32:33]
    v_cndmask_b32 v53, 0, v227, s[32:33]
    s_lshl_b64 s[32:33], s[32:33], 2
    v_mfma_f32_16x16x32_bf16 v[228:231], v[196:199], v[200:203], 0
    v_cndmask_b32 v34, 0, v224, s[32:33]
    v_cndmask_b32 v50, 0, v225, s[32:33]
    v_cndmask_b32 v38, 0, v226, s[32:33]
    v_cndmask_b32 v54, 0, v227, s[32:33]
    s_lshl_b64 s[32:33], s[32:33], 2
    v_cndmask_b32 v35, 0, v224, s[32:33]
    v_cndmask_b32 v51, 0, v225, s[32:33]
    v_cndmask_b32 v39, 0, v226, s[32:33]
    v_cndmask_b32 v55, 0, v227, s[32:33]
    s_lshl_b64 s[32:33], s[32:33], 2
    v_cndmask_b32 v40, 0, v224, s[32:33]
    v_cndmask_b32 v56, 0, v225, s[32:33]
    v_cndmask_b32 v44, 0, v226, s[32:33]
    v_cndmask_b32 v60, 0, v227, s[32:33]
    s_lshl_b64 s[32:33], s[32:33], 2
    v_cndmask_b32 v41, 0, v224, s[32:33]
    v_cndmask_b32 v57, 0, v225, s[32:33]
    v_cndmask_b32 v45, 0, v226, s[32:33]
    v_cndmask_b32 v61, 0, v227, s[32:33]
    s_lshl_b64 s[32:33], s[32:33], 2
    v_cndmask_b32 v42, 0, v224, s[32:33]
    v_cndmask_b32 v58, 0, v225, s[32:33]
    v_cndmask_b32 v46, 0, v226, s[32:33]
    v_cndmask_b32 v62, 0, v227, s[32:33]
    s_lshl_b64 s[32:33], s[32:33], 2
    v_cndmask_b32 v43, 0, v224, s[32:33]
    v_cndmask_b32 v59, 0, v225, s[32:33]
    v_cndmask_b32 v47, 0, v226, s[32:33]
    v_cndmask_b32 v63, 0, v227, s[32:33]
    buffer_load_dwordx2 v[28:29], v6, s[12:15], 0 offen sc1
    global_load_dwordx4 v[248:251], v[0:1], off offset:-3072
    s_waitcnt lgkmcnt(0)
    s_add_u32 m0, s29, 15360
    s_add_u32 s71, s28, 0
    buffer_load_dwordx4 v10, s[56:59], s71 offen lds
    buffer_load_dwordx4 v11, s[56:59], s71 offen offset:1024 lds
    s_add_u32 m0, s29, 17408
    s_nop 0
    buffer_load_dwordx4 v10, s[60:63], s71 offen lds
    buffer_load_dwordx4 v11, s[60:63], s71 offen offset:1024 lds
    s_waitcnt vmcnt(16)
    ds_read_b128 v[64:67], v16 offset:0
    ds_read_b128 v[80:83], v18 offset:0
    ds_read_b128 v[68:71], v20 offset:0
    ds_read_b128 v[84:87], v22 offset:0
    ds_read_b128 v[72:75], v17 offset:0
    ds_read_b128 v[88:91], v19 offset:0
    ds_read_b128 v[76:79], v21 offset:0
    ds_read_b128 v[92:95], v23 offset:0
    s_waitcnt lgkmcnt(7)
    v_mfma_f32_16x16x32_bf16 v[208:211], v[32:35], v[64:67], v[204:207]
    s_add_u32 m0, s29, 19456
    s_add_u32 s71, s28, 114688
    s_waitcnt lgkmcnt(6)
    v_mfma_f32_16x16x32_bf16 v[216:219], v[48:51], v[80:83], v[228:231]
    s_waitcnt lgkmcnt(5)
    v_mfma_f32_16x16x32_bf16 v[208:211], v[36:39], v[68:71], v[208:211]
    s_waitcnt lgkmcnt(4)
    v_mfma_f32_16x16x32_bf16 v[216:219], v[52:55], v[84:87], v[216:219]
    s_waitcnt lgkmcnt(3)
    v_mfma_f32_16x16x32_bf16 v[208:211], v[40:43], v[72:75], v[208:211]
    s_waitcnt lgkmcnt(2)
    v_mfma_f32_16x16x32_bf16 v[216:219], v[56:59], v[88:91], v[216:219]
    s_waitcnt lgkmcnt(1)
    v_mfma_f32_16x16x32_bf16 v[208:211], v[44:47], v[76:79], v[208:211]
    s_waitcnt lgkmcnt(0)
    v_mfma_f32_16x16x32_bf16 v[216:219], v[60:63], v[92:95], v[216:219]
    s_waitcnt vmcnt(9)
    ds_read_b128 v[96:99], v16 offset:7168
    ds_read_b128 v[112:115], v18 offset:7168
    ds_read_b128 v[100:103], v20 offset:7168
    ds_read_b128 v[116:119], v22 offset:7168
    ds_read_b128 v[104:107], v17 offset:7168
    ds_read_b128 v[120:123], v19 offset:7168
    ds_read_b128 v[108:111], v21 offset:7168
    ds_read_b128 v[124:127], v23 offset:7168
    v_cvt_pk_bf16_f32 v200, v208, v209
    v_cvt_pk_bf16_f32 v201, v210, v211
    v_cvt_pk_bf16_f32 v202, v216, v217
    v_cvt_pk_bf16_f32 v203, v218, v219
    ds_write_b64 v25, v[200:201] offset:0
    ds_write_b64 v25, v[202:203] offset:512
    s_waitcnt vmcnt(8)
    v_accvgpr_read_b32 v14, a220
    v_accvgpr_read_b32 v15, a221
    v_accvgpr_read_b32 v252, a222
    v_accvgpr_read_b32 v253, a223
    v_xor_b32 v15, v15, v14
    v_xor_b32 v253, v253, v252
    v_subrev_u32 v14, s70, v14
    v_subrev_u32 v252, s70, v252
    v_xor_b32 v15, 0x5bd1e995, v15
    v_xor_b32 v253, 0x5bd1e995, v253
    v_max_u32 v14, v14, v252
    v_or_b32 v15, v15, v253
    v_cmp_lt_u32 vcc, s44, v14
    v_cmp_ne_u32 s[4:5], 0, v15
    s_nop 0
    s_or_b64 vcc, vcc, s[4:5]
    s_cbranch_scc1 L_slow_n
L_back_n:
    s_waitcnt lgkmcnt(9)
    v_mfma_f32_16x16x32_bf16 v[212:215], v[32:35], v[96:99], v[204:207]
    buffer_load_dwordx4 v10, s[56:59], s71 offen lds
    s_waitcnt lgkmcnt(8)
    v_mfma_f32_16x16x32_bf16 v[220:223], v[48:51], v[112:115], v[228:231]
    s_waitcnt lgkmcnt(7)
    v_mfma_f32_16x16x32_bf16 v[212:215], v[36:39], v[100:103], v[212:215]
    buffer_load_dwordx4 v11, s[56:59], s71 offen offset:1024 lds
    s_waitcnt lgkmcnt(6)
    v_mfma_f32_16x16x32_bf16 v[220:223], v[52:55], v[116:119], v[220:223]
    s_add_u32 m0, s29, 21504
    s_waitcnt lgkmcnt(5)
    v_mfma_f32_16x16x32_bf16 v[212:215], v[40:43], v[104:107], v[212:215]
    s_waitcnt lgkmcnt(4)
    v_mfma_f32_16x16x32_bf16 v[220:223], v[56:59], v[120:123], v[220:223]
    s_waitcnt lgkmcnt(3)
    v_mfma_f32_16x16x32_bf16 v[212:215], v[44:47], v[108:111], v[212:215]
    buffer_load_dwordx4 v10, s[60:63], s71 offen lds
    s_waitcnt lgkmcnt(2)
    v_mfma_f32_16x16x32_bf16 v[220:223], v[60:63], v[124:127], v[220:223]
    buffer_load_dwordx4 v11, s[60:63], s71 offen offset:1024 lds
    s_nop 3
    v_cvt_pk_bf16_f32 v112, v212, v213
    v_cvt_pk_bf16_f32 v113, v214, v215
    s_nop 0
    v_cvt_pk_bf16_f32 v114, v220, v221
    v_cvt_pk_bf16_f32 v115, v222, v223
    ds_write_b64 v25, v[112:113] offset:1024
    ds_write_b64 v25, v[114:115] offset:1536
    s_add_u32 m0, s29, 23552
    s_add_u32 s71, s28, 229376
    buffer_load_dwordx4 v10, s[56:59], s71 offen lds
    s_waitcnt lgkmcnt(0)
    s_barrier
    ds_read_b128 v[64:67], v9 offset:8192
    ds_read_b128 v[68:71], v9 offset:9216
    ds_read_b128 v[72:75], v9 offset:10240
    ds_read_b128 v[76:79], v9 offset:11264
    ds_read_b128 v[80:83], v9 offset:12288
    ds_read_b128 v[84:87], v9 offset:13312
    ds_read_b128 v[88:91], v9 offset:14336
    ds_read_b128 v[92:95], v9 offset:15360
    buffer_load_dwordx4 v11, s[56:59], s71 offen offset:1024 lds
    s_waitcnt lgkmcnt(7)
    v_mfma_f32_16x16x32_bf16 v[96:99], v[64:67], v[128:131], 0
    s_waitcnt vmcnt(6)
    ds_read_b64_tr_b16 a[0:1], v12 offset:15360
    s_add_u32 m0, s29, 25600
    s_waitcnt lgkmcnt(7)
    v_mfma_f32_16x16x32_bf16 v[100:103], v[68:71], v[128:131], 0
    buffer_load_dwordx4 v10, s[60:63], s71 offen lds
    s_waitcnt lgkmcnt(6)
    v_mfma_f32_16x16x32_bf16 v[96:99], v[72:75], v[132:135], v[96:99]
    s_lshl_b32 s5, s23, 5
    ds_read_b64_tr_b16 a[2:3], v12 offset:15616
    s_min_u32 s4, s16, 1
    s_waitcnt lgkmcnt(6)
    v_mfma_f32_16x16x32_bf16 v[100:103], v[76:79], v[132:135], v[100:103]
    buffer_load_dwordx4 v11, s[60:63], s71 offen offset:1024 lds
    s_waitcnt lgkmcnt(5)
    v_mfma_f32_16x16x32_bf16 v[96:99], v[80:83], v[136:139], v[96:99]
    s_add_u32 m0, s29, 27648
    ds_read_b64_tr_b16 a[4:5], v13 offset:15360
    s_add_u32 s71, s28, 344064
    s_waitcnt lgkmcnt(5)
    v_mfma_f32_16x16x32_bf16 v[100:103], v[84:87], v[136:139], v[100:103]
    s_sub_u32 s4, s4, 1
    ds_read_b64_tr_b16 a[6:7], v13 offset:15616
    s_and_b32 s5, s5, s4
    s_waitcnt lgkmcnt(5)
    v_mfma_f32_16x16x32_bf16 v[96:99], v[88:91], v[140:143], v[96:99]
    buffer_load_dwordx4 v10, s[56:59], s71 offen lds
    s_waitcnt lgkmcnt(4)
    v_mfma_f32_16x16x32_bf16 v[100:103], v[92:95], v[140:143], v[100:103]
    ds_read_b64_tr_b16 a[8:9], v12 offset:17408
    v_lshrrev_b32 v23, 1, v8
    v_mfma_f32_16x16x32_bf16 v[104:107], v[64:67], v[144:147], 0
    ds_read_b64_tr_b16 a[10:11], v12 offset:17664
    v_mul_u32_u24 v23, 3, v23
    v_mfma_f32_16x16x32_bf16 v[108:111], v[68:71], v[144:147], 0
    ds_read_b64_tr_b16 a[12:13], v13 offset:17408
    v_mad_u32_u16 v16, v248, 16, 0
    v_mfma_f32_16x16x32_bf16 v[104:107], v[72:75], v[148:151], v[104:107]
    buffer_load_dwordx4 v11, s[56:59], s71 offen offset:1024 lds
    v_mfma_f32_16x16x32_bf16 v[108:111], v[76:79], v[148:151], v[108:111]
    s_add_u32 m0, s29, 29696
    ds_read_b64_tr_b16 a[14:15], v13 offset:17664
    v_lshlrev_b32 v23, v23, s5
    v_mfma_f32_16x16x32_bf16 v[104:107], v[80:83], v[152:155], v[104:107]
    v_cvt_pk_bf16_f32 v112, v96, v97
    v_cvt_pk_bf16_f32 v113, v98, v99
    v_mfma_f32_16x16x32_bf16 v[108:111], v[84:87], v[152:155], v[108:111]
    v_cvt_pk_bf16_f32 v114, v100, v101
    v_cvt_pk_bf16_f32 v115, v102, v103
    v_mfma_f32_16x16x32_bf16 v[104:107], v[88:91], v[156:159], v[104:107]
    v_cvt_pk_bf16_f32 v120, -v96, -v97
    v_cvt_pk_bf16_f32 v121, -v98, -v99
    v_mfma_f32_16x16x32_bf16 v[108:111], v[92:95], v[156:159], v[108:111]
    s_waitcnt vmcnt(6)
    v_cvt_pk_bf16_f32 v122, -v100, -v101
    v_cvt_pk_bf16_f32 v123, -v102, -v103
    v_mfma_f32_16x16x32_bf16 v[32:35], v[160:163], v[112:115], 0
    buffer_load_dwordx4 v10, s[60:63], s71 offen lds
    v_mfma_f32_16x16x32_bf16 v[40:43], v[168:171], v[120:123], 0
    ds_read_b64_tr_b16 a[16:17], v12 offset:19456
    v_add_u32 v16, v16, v23
    v_mfma_f32_16x16x32_bf16 v[36:39], v[164:167], v[112:115], 0
    v_cvt_pk_bf16_f32 v116, v104, v105
    v_cvt_pk_bf16_f32 v117, v106, v107
    v_mfma_f32_16x16x32_bf16 v[44:47], v[172:175], v[120:123], 0
    v_cvt_pk_bf16_f32 v118, v108, v109
    v_cvt_pk_bf16_f32 v119, v110, v111
    s_nop 1
    v_mfma_f32_16x16x32_bf16 v[32:35], v[168:171], v[116:119], v[32:35]
    buffer_load_dwordx4 v11, s[60:63], s71 offen offset:1024 lds
    v_mfma_f32_16x16x32_bf16 v[40:43], v[160:163], v[116:119], v[40:43]
    s_add_u32 m0, s29, 0
    ds_read_b64_tr_b16 a[18:19], v12 offset:19712
    s_add_u32 s71, s28, 458752
    v_mfma_f32_16x16x32_bf16 v[36:39], v[172:175], v[116:119], v[36:39]
    buffer_load_dwordx4 v10, s[56:59], s71 offen lds
    v_mfma_f32_16x16x32_bf16 v[44:47], v[164:167], v[116:119], v[44:47]
    ds_read_b64_tr_b16 a[20:21], v13 offset:19456
    v_mul_f32 v48, v32, v232
    v_mul_f32 v49, v33, v233
    v_mul_f32 v50, v34, v234
    v_mul_f32 v51, v35, v235
    v_fma_f32 v48, -v40, v240, v48
    v_fma_f32 v49, -v41, v241, v49
    v_fma_f32 v50, -v42, v242, v50
    v_fma_f32 v51, -v43, v243, v51
    v_cvt_pk_bf16_f32 v112, v48, v49
    v_cvt_pk_bf16_f32 v113, v50, v51
    v_mul_f32 v52, v36, v236
    v_mul_f32 v53, v37, v237
    v_mul_f32 v54, v38, v238
    v_mul_f32 v55, v39, v239
    v_fma_f32 v52, -v44, v244, v52
    v_fma_f32 v53, -v45, v245, v53
    v_fma_f32 v54, -v46, v246, v54
    v_fma_f32 v55, -v47, v247, v55
    v_cvt_pk_bf16_f32 v114, v52, v53
    v_cvt_pk_bf16_f32 v115, v54, v55
    v_mul_f32 v56, v32, v240
    v_mul_f32 v57, v33, v241
    v_mul_f32 v58, v34, v242
    v_mul_f32 v59, v35, v243
    v_mul_f32 v60, v36, v244
    v_mul_f32 v61, v37, v245
    v_mul_f32 v62, v38, v246
    v_mul_f32 v63, v39, v247
    v_mfma_f32_16x16x32_bf16 v[96:99], v[112:115], v[176:179], 0
    v_fmac_f32 v56, v40, v232
    v_fmac_f32 v57, v41, v233
    v_mfma_f32_16x16x32_bf16 v[104:107], v[112:115], v[184:187], 0
    v_fmac_f32 v58, v42, v234
    v_fmac_f32 v59, v43, v235
    v_mfma_f32_16x16x32_bf16 v[100:103], v[112:115], v[180:183], 0
    v_fmac_f32 v60, v44, v236
    v_fmac_f32 v61, v45, v237
    v_mfma_f32_16x16x32_bf16 v[108:111], v[112:115], v[188:191], 0
    v_fmac_f32 v62, v46, v238
    v_fmac_f32 v63, v47, v239
    v_cvt_pk_bf16_f32 v116, v56, v57
    v_cvt_pk_bf16_f32 v117, v58, v59
    v_cvt_pk_bf16_f32 v118, v60, v61
    v_cvt_pk_bf16_f32 v119, v62, v63
    s_mov_b32 s47, 0x80008000
    s_add_u32 s3, s30, 1056768
    v_mfma_f32_16x16x32_bf16 v[104:107], v[116:119], v[176:179], v[104:107]
    v_xor_b32 v120, s47, v116
    v_xor_b32 v121, s47, v117
    v_mfma_f32_16x16x32_bf16 v[108:111], v[116:119], v[180:183], v[108:111]
    v_xor_b32 v122, s47, v118
    v_xor_b32 v123, s47, v119
    v_xor_b32 v29, v28, v29
    v_subrev_u32 v28, s70, v28
    v_mfma_f32_16x16x32_bf16 v[96:99], v[120:123], v[184:187], v[96:99]
    v_xor_b32 v29, 0x5bd1e995, v29
    v_lshrrev_b32 v28, 14, v28
    v_mfma_f32_16x16x32_bf16 v[100:103], v[120:123], v[188:191], v[100:103]
    v_or_b32 v28, v28, v29
    v_cmp_ne_u32 vcc, 0, v28
    s_nop 0
    s_and_b64 vcc, vcc, s[52:53]
    s_cbranch_scc1 L_slow_s2
L_back_s2:
    v_cvt_pk_bf16_f32 v224, v96, -v104
    v_cvt_pk_bf16_f32 v225, v97, -v105
    v_cvt_pk_bf16_f32 v226, v98, -v106
    v_cvt_pk_bf16_f32 v227, v99, -v107
    v_cvt_pk_bf16_f32 v228, v100, -v108
    v_cvt_pk_bf16_f32 v229, v101, -v109
    v_cvt_pk_bf16_f32 v230, v102, -v110
    v_cvt_pk_bf16_f32 v231, v103, -v111
    ds_write_b128 v24, v[224:227] offset:0
    ds_write_b128 v24, v[228:231] offset:1024
    buffer_load_dwordx4 v11, s[56:59], s71 offen offset:1024 lds
    s_waitcnt lgkmcnt(0)
    s_barrier
    ds_read_b128 v[64:67], v9 offset:16384
    ds_read_b128 v[72:75], v9 offset:18432
    ds_read_b128 v[80:83], v9 offset:20480
    ds_read_b128 v[88:91], v9 offset:22528
    ds_read_b128 v[68:71], v9 offset:17408
    ds_read_b128 v[76:79], v9 offset:19456
    ds_read_b128 v[84:87], v9 offset:21504
    ds_read_b128 v[92:95], v9 offset:23552
    buffer_load_dwordx4 v[28:31], v16, s[12:15], 0 offen sc1
    s_waitcnt lgkmcnt(7)
    v_mfma_f32_16x16x32_bf16 v[32:35], v[128:131], v[64:67], 0
    s_add_u32 m0, s29, 2048
    ds_read_b64_tr_b16 a[22:23], v13 offset:19712
    v_mfma_f32_16x16x32_bf16 v[40:43], v[144:147], v[64:67], 0
    buffer_load_dwordx4 v10, s[60:63], s71 offen lds
    s_waitcnt lgkmcnt(7)
    v_mfma_f32_16x16x32_bf16 v[32:35], v[132:135], v[72:75], v[32:35]
    ds_read_b64_tr_b16 a[24:25], v12 offset:21504
    v_mfma_f32_16x16x32_bf16 v[40:43], v[148:151], v[72:75], v[40:43]
    buffer_load_dwordx4 v11, s[60:63], s71 offen offset:1024 lds
    s_waitcnt lgkmcnt(7)
    v_mfma_f32_16x16x32_bf16 v[32:35], v[136:139], v[80:83], v[32:35]
    s_add_u32 m0, s29, 4096
    ds_read_b64_tr_b16 a[26:27], v12 offset:21760
    s_add_u32 s71, s28, 573440
    v_mfma_f32_16x16x32_bf16 v[40:43], v[152:155], v[80:83], v[40:43]
    ds_read_b64_tr_b16 a[28:29], v13 offset:21504
    s_waitcnt lgkmcnt(8)
    v_mfma_f32_16x16x32_bf16 v[32:35], v[140:143], v[88:91], v[32:35]
    buffer_load_dwordx4 v10, s[56:59], s71 offen lds
    v_mfma_f32_16x16x32_bf16 v[40:43], v[156:159], v[88:91], v[40:43]
    ds_read_b64_tr_b16 a[30:31], v13 offset:21760
    s_waitcnt lgkmcnt(8)
    v_mfma_f32_16x16x32_bf16 v[36:39], v[128:131], v[68:71], 0
    s_waitcnt vmcnt(10)
    ds_read_b64_tr_b16 a[32:33], v12 offset:23552
    v_mfma_f32_16x16x32_bf16 v[44:47], v[144:147], v[68:71], 0
    ds_read_b64_tr_b16 a[34:35], v12 offset:23808
    s_waitcnt lgkmcnt(9)
    v_mfma_f32_16x16x32_bf16 v[36:39], v[132:135], v[76:79], v[36:39]
    ds_read_b64_tr_b16 a[36:37], v13 offset:23552
    v_mfma_f32_16x16x32_bf16 v[44:47], v[148:151], v[76:79], v[44:47]
    v_cvt_pk_bf16_f32 v224, v32, -v40
    v_cvt_pk_bf16_f32 v225, v33, -v41
    s_waitcnt lgkmcnt(9)
    v_mfma_f32_16x16x32_bf16 v[36:39], v[136:139], v[84:87], v[36:39]
    v_cvt_pk_bf16_f32 v226, v34, -v42
    v_cvt_pk_bf16_f32 v227, v35, -v43
    v_mfma_f32_16x16x32_bf16 v[44:47], v[152:155], v[84:87], v[44:47]
    buffer_store_dwordx4 v[224:227], v26, s[12:15], s30 offen sc1
    s_waitcnt lgkmcnt(8)
    v_mfma_f32_16x16x32_bf16 v[36:39], v[140:143], v[92:95], v[36:39]
    ds_read_b64_tr_b16 a[38:39], v13 offset:23808
    v_mfma_f32_16x16x32_bf16 v[44:47], v[156:159], v[92:95], v[44:47]
    ds_read_b64_tr_b16 a[40:41], v12 offset:25600
    ds_read_b64_tr_b16 a[42:43], v12 offset:25856
    ds_read_b64_tr_b16 a[44:45], v13 offset:25600
    ds_read_b64_tr_b16 a[46:47], v13 offset:25856
    s_waitcnt vmcnt(7)
    ds_read_b64_tr_b16 a[48:49], v12 offset:27648
    s_nop 1
    v_cvt_pk_bf16_f32 v228, v36, -v44
    v_cvt_pk_bf16_f32 v229, v37, -v45
    v_cvt_pk_bf16_f32 v230, v38, -v46
    v_cvt_pk_bf16_f32 v231, v39, -v47
    buffer_store_dwordx4 v[228:231], v26, s[12:15], s3 offen sc1
    v_mad_i32_i16 v20, v248, 16, 0 op_sel:[1,0,0,0]
    v_mad_i32_i16 v21, v249, 16, 0
    v_mad_u32_u16 v22, v249, 16, 0 op_sel:[1,0,0,0]
    v_mad_u32_u16 v248, v250, 16, 0
    v_mad_u32_u16 v249, v250, 16, 0 op_sel:[1,0,0,0]
    v_mad_u32_u16 v250, v251, 8, 0
    v_mad_u32_u16 v251, v251, 16, 0 op_sel:[1,0,0,0]
    ds_read_b128 v[208:211], v251 offset:0
    ds_read_b128 v[212:215], v251 offset:512
    s_min_u32 s3, s16, 2
    s_lshl_b32 s3, s3, 10
    s_add_u32 s3, s3, 0
    v_add_u32 v17, s3, v9
    v_min_u32 v63, 1, v7
    v_lshlrev_b32 v63, 10, v63
    v_lshl_add_u32 v63, v8, 4, v63
    v_and_b32 v20, 0x7fffffff, v20
    v_and_b32 v21, 0x7fffffff, v21
    s_waitcnt vmcnt(5)
    v_max3_u32 v27, v28, v29, v30
    v_max_u32 v27, v27, v31
    v_cmp_eq_u32 vcc, -1, v27
    s_cbranch_vccnz L_slow_mp
L_back_mp:
    ds_write_b128 v17, v[28:31]
    ds_read_b64_tr_b16 a[50:51], v12 offset:27904
    ds_read_b64_tr_b16 a[52:53], v13 offset:27648
    ds_read_b64_tr_b16 a[54:55], v13 offset:27904
    ds_read_b64_tr_b16 a[56:57], v12 offset:29696
    ds_read_b64_tr_b16 a[58:59], v12 offset:29952
    ds_read_b64_tr_b16 a[60:61], v13 offset:29696
    ds_read_b64_tr_b16 a[62:63], v13 offset:29952
    buffer_load_dwordx4 v11, s[56:59], s71 offen offset:1024 lds
    s_lshr_b32 s4, s22, 1
    s_lshl_b32 s4, s4, 11
    s_add_u32 s4, s4, 6307968
    v_lshl_add_u32 v30, v2, 9, s4
    v_mov_b32 v31, 1
    s_cmp_eq_u32 s16, 0
    s_cselect_b64 vcc, 15, 0
    v_mov_b32 v16, 2147483392
    v_cndmask_b32 v16, v16, v30, vcc
    s_waitcnt lgkmcnt(0)
    s_barrier
    ds_read_b128 v[176:179], v63 offset:1024
    ds_read_b128 v[180:183], v63 offset:1088
    ds_read_b128 v[184:187], v63 offset:1152
    ds_read_b128 v[188:191], v63 offset:1216
    ds_read_b128 v[216:219], v249 offset:0
    ds_read_b128 v[224:227], v249 offset:256
    ds_read_b128 v[220:223], v249 offset:16
    ds_read_b128 v[228:231], v249 offset:272
    s_add_u32 m0, s29, 6144
    s_nop 0
    buffer_load_dwordx4 v10, s[60:63], s71 offen lds
    s_waitcnt lgkmcnt(7)
    v_mfma_f32_16x16x32_bf16 v[160:163], v[176:179], a[0:3], 0
    v_and_b32 v32, 7, v7
    v_lshrrev_b32 v33, 3, v7
    v_mfma_f32_16x16x32_bf16 v[164:167], v[176:179], a[4:7], 0
    buffer_load_dwordx4 v11, s[60:63], s71 offen offset:1024 lds
    v_mfma_f32_16x16x32_bf16 v[168:171], v[176:179], a[8:11], 0
    s_add_u32 m0, s29, 8192
    s_add_u32 s71, s28, 688128
    v_lshl_add_u32 v33, s16, 1, v33
    v_mfma_f32_16x16x32_bf16 v[172:175], v[176:179], a[12:15], 0
    v_lshl_add_u32 v34, v33, 6, v32
    v_lshl_add_u32 v34, s23, 3, v34
    s_waitcnt lgkmcnt(6)
    v_mfma_f32_16x16x32_bf16 v[160:163], v[180:183], a[16:19], v[160:163]
    ds_read_b128 v[176:179], v63 offset:1280
    v_mul_u32_u24 v34, v34, v8
    v_mfma_f32_16x16x32_bf16 v[164:167], v[180:183], a[20:23], v[164:167]
    buffer_load_dwordx4 v10, s[56:59], s71 offen lds
    v_mfma_f32_16x16x32_bf16 v[168:171], v[180:183], a[24:27], v[168:171]
    v_cvt_f32_u32 v34, v34
    v_mul_f32 v34, 0x3b124925, v34
    v_mfma_f32_16x16x32_bf16 v[172:175], v[180:183], a[28:31], v[172:175]
    v_cos_f32 v35, v34
    s_waitcnt lgkmcnt(6)
    v_mfma_f32_16x16x32_bf16 v[160:163], v[184:187], a[32:35], v[160:163]
    ds_read_b128 v[180:183], v63 offset:1344
    v_mfma_f32_16x16x32_bf16 v[164:167], v[184:187], a[36:39], v[164:167]
    buffer_load_dwordx4 v11, s[56:59], s71 offen offset:1024 lds
    v_mfma_f32_16x16x32_bf16 v[168:171], v[184:187], a[40:43], v[168:171]
    s_add_u32 m0, s29, 10240
    v_mfma_f32_16x16x32_bf16 v[172:175], v[184:187], a[44:47], v[172:175]
    v_sin_f32 v36, v34
    s_waitcnt lgkmcnt(6)
    v_mfma_f32_16x16x32_bf16 v[160:163], v[188:191], a[48:51], v[160:163]
    ds_read_b128 v[184:187], v63 offset:1408
    v_cmp_eq_u32 vcc, 0, v8
    v_mfma_f32_16x16x32_bf16 v[164:167], v[188:191], a[52:55], v[164:167]
    s_waitcnt vmcnt(8)
    buffer_load_dwordx4 v10, s[60:63], s71 offen lds
    v_mfma_f32_16x16x32_bf16 v[168:171], v[188:191], a[56:59], v[168:171]
    v_cmp_gt_u32 s[4:5], 7, v33
    s_mov_b32 s0, 0x01010101
    v_mfma_f32_16x16x32_bf16 v[172:175], v[188:191], a[60:63], v[172:175]
    s_mov_b32 s1, 0x01010101
    v_cndmask_b32 v37, 2.0, 1.0, vcc
    v_cndmask_b32 v37, 0, v37, s[4:5]
    v_mul_f32 v35, v35, v37
    v_mul_f32 v36, v36, v37
    v_cvt_pk_bf16_f32 v38, v35, -v36
    v_cvt_pk_bf16_f32 v39, v36, v35
    v_cndmask_b32 v96, 0, v38, s[0:1]
    v_cndmask_b32 v100, 0, v39, s[0:1]
    s_lshl_b64 s[0:1], s[0:1], 1
    v_cndmask_b32 v97, 0, v38, s[0:1]
    v_cndmask_b32 v101, 0, v39, s[0:1]
    s_lshl_b64 s[0:1], s[0:1], 1
    v_cndmask_b32 v98, 0, v38, s[0:1]
    v_cndmask_b32 v102, 0, v39, s[0:1]
    ds_read_b64_tr_b16 a[64:65], v12 offset:0
    ds_read_b64_tr_b16 a[66:67], v12 offset:256
    ds_read_b64_tr_b16 a[68:69], v13 offset:0
    ds_read_b64_tr_b16 a[70:71], v13 offset:256
    ds_read_b64_tr_b16 a[72:73], v12 offset:2048
    ds_read_b64_tr_b16 a[74:75], v12 offset:2304
    ds_read_b64_tr_b16 a[76:77], v13 offset:2048
    ds_read_b64_tr_b16 a[78:79], v13 offset:2304
    buffer_load_dwordx4 v11, s[60:63], s71 offen offset:1024 lds
    s_lshl_b64 s[0:1], s[0:1], 1
    v_cndmask_b32 v99, 0, v38, s[0:1]
    v_cndmask_b32 v103, 0, v39, s[0:1]
    s_lshl_b64 s[0:1], s[0:1], 1
    v_cndmask_b32 v104, 0, v38, s[0:1]
    v_cndmask_b32 v108, 0, v39, s[0:1]
    s_lshl_b64 s[0:1], s[0:1], 1
    v_cndmask_b32 v105, 0, v38, s[0:1]
    v_cndmask_b32 v109, 0, v39, s[0:1]
    s_lshl_b64 s[0:1], s[0:1], 1
    v_cndmask_b32 v106, 0, v38, s[0:1]
    v_cndmask_b32 v110, 0, v39, s[0:1]
    s_add_u32 m0, s29, 15360
    s_add_u32 s71, s28, 802816
    buffer_load_dwordx4 v10, s[56:59], s71 offen lds
    s_lshl_b64 s[0:1], s[0:1], 1
    v_cndmask_b32 v107, 0, v38, s[0:1]
    v_cndmask_b32 v111, 0, v39, s[0:1]
    v_lshrrev_b32 v19, 1, v9
    v_cndmask_b32 v208, 0, v208, s[20:21]
    v_cndmask_b32 v209, 0, v209, s[20:21]
    v_cndmask_b32 v210, 0, v210, s[20:21]
    v_cndmask_b32 v211, 0, v211, s[20:21]
    v_cndmask_b32 v212, 0, v212, s[20:21]
    v_cndmask_b32 v213, 0, v213, s[20:21]
    v_cndmask_b32 v214, 0, v214, s[20:21]
    v_cndmask_b32 v215, 0, v215, s[20:21]
    buffer_load_dwordx4 v11, s[56:59], s71 offen offset:1024 lds
    v_lshlrev_b32 v232, 16, v208
    v_and_b32 v233, 0xffff0000, v208
    v_lshlrev_b32 v234, 16, v209
    v_and_b32 v235, 0xffff0000, v209
    v_lshlrev_b32 v236, 16, v210
    v_and_b32 v237, 0xffff0000, v210
    v_lshlrev_b32 v238, 16, v211
    v_and_b32 v239, 0xffff0000, v211
    v_lshlrev_b32 v240, 16, v212
    v_and_b32 v241, 0xffff0000, v212
    v_lshlrev_b32 v242, 16, v213
    v_and_b32 v243, 0xffff0000, v213
    s_add_u32 m0, s29, 17408
    s_nop 0
    buffer_load_dwordx4 v10, s[60:63], s71 offen lds
    v_lshlrev_b32 v244, 16, v214
    v_and_b32 v245, 0xffff0000, v214
    v_lshlrev_b32 v246, 16, v215
    v_and_b32 v247, 0xffff0000, v215
    s_waitcnt lgkmcnt(13)
    v_mul_f32 v208, v216, v224
    v_mul_f32 v209, v217, v225
    v_mul_f32 v210, v218, v226
    v_mul_f32 v211, v219, v227
    s_waitcnt lgkmcnt(11)
    v_mul_f32 v212, v220, v228
    v_mul_f32 v213, v221, v229
    v_mul_f32 v214, v222, v230
    v_mul_f32 v215, v223, v231
    s_waitcnt vmcnt(7)
    ds_read_b64_tr_b16 a[80:81], v12 offset:4096
    ds_read_b64_tr_b16 a[82:83], v12 offset:4352
    ds_read_b64_tr_b16 a[84:85], v13 offset:4096
    ds_read_b64_tr_b16 a[86:87], v13 offset:4352
    ds_read_b64_tr_b16 a[88:89], v12 offset:6144
    ds_read_b64_tr_b16 a[90:91], v12 offset:6400
    ds_read_b64_tr_b16 a[92:93], v13 offset:6144
    ds_read_b64_tr_b16 a[94:95], v13 offset:6400
    buffer_load_dwordx4 v11, s[60:63], s71 offen offset:1024 lds
    v_mul_f32 v32, v232, v224
    v_mul_f32 v33, v233, v225
    v_mul_f32 v34, v234, v226
    v_mul_f32 v35, v235, v227
    v_mul_f32 v36, v236, v228
    v_mul_f32 v37, v237, v229
    v_mul_f32 v38, v238, v230
    v_mul_f32 v39, v239, v231
    v_mul_f32 v40, v240, v224
    v_mul_f32 v41, v241, v225
    v_mul_f32 v42, v242, v226
    v_mul_f32 v43, v243, v227
    s_add_u32 m0, s29, 19456
    s_add_u32 s71, s28, 917504
    buffer_load_dwordx4 v10, s[56:59], s71 offen lds
    v_mul_f32 v44, v244, v228
    v_mul_f32 v45, v245, v229
    v_mul_f32 v46, v246, v230
    v_mul_f32 v47, v247, v231
    s_and_b32 s41, s17, 3
    s_mul_i32 s41, s41, 28
    s_add_u32 s41, s41, s18
    s_lshr_b32 s24, s17, 2
    s_lshl_b32 s24, s24, 3
    s_and_b32 s4, s41, 7
    s_add_u32 s24, s24, s4
    s_lshr_b32 s41, s41, 3
    buffer_load_dwordx4 v11, s[56:59], s71 offen offset:1024 lds
    buffer_load_dwordx4 v[48:51], v20, s[12:15], s73 offen sc1
    buffer_load_dwordx4 v[52:55], v21, s[12:15], s73 offen sc1
    s_lshl_b32 s41, s41, 2
    s_add_u32 s41, s41, s16
    s_mul_i32 s42, s24, 114688
    s_add_u32 s42, s42, 6553600
    s_lshl_b32 s32, s16, 12
    s_min_u32 s32, s32, 10240
    s_add_u32 s33, s42, s32
    s_add_u32 s32, s32, 8192
    s_lshr_b32 s4, s16, 1
    s_mul_i32 s39, s4, 17408
    s_mul_i32 s4, s4, 43008
    s_add_u32 s42, s42, s4
    s_mul_i32 s38, s16, 7168
    s_add_u32 s42, s42, s38
    s_add_u32 s38, s38, 8192
    s_add_u32 s39, s39, 28672
    s_add_u32 s39, s39, s38
    s_lshl_b32 s34, s24, 3
    s_add_u32 s34, s34, s16
    s_lshl_b32 s34, s34, 10
    s_add_u32 s34, s34, 6422528
    s_mul_i32 s72, s24, 448
    s_add_u32 s72, s72, s41
    s_lshl_b32 s72, s72, 10
    s_waitcnt vmcnt(8)
    ds_read_b64_tr_b16 a[96:97], v12 offset:8192
    ds_read_b64_tr_b16 a[98:99], v12 offset:8448
    ds_read_b64_tr_b16 a[100:101], v13 offset:8192
    ds_read_b64_tr_b16 a[102:103], v13 offset:8448
    ds_read_b64_tr_b16 a[104:105], v12 offset:10240
    ds_read_b64_tr_b16 a[106:107], v12 offset:10496
    ds_read_b64_tr_b16 a[108:109], v13 offset:10240
    ds_read_b64_tr_b16 a[110:111], v13 offset:10496
    s_add_u32 s72, s72, 8388608
    s_mul_i32 s74, s22, 224
    s_mul_i32 s4, s16, 14
    s_add_u32 s74, s74, s4
    s_lshl_b32 s74, s74, 10
    s_add_u32 s74, s74, 8388608
    s_mul_i32 s40, s16, 401408
    s_lshl_b32 s4, s23, 7
    s_add_u32 s40, s40, s4
    s_mul_i32 s43, s41, 37
    s_lshr_b32 s43, s43, 9
    s_lshl_b32 s4, s24, 2
    s_add_u32 s43, s43, s4
    s_lshl_b32 s43, s43, 9
    s_add_u32 s43, s43, 6307840
    s_lshr_b32 s36, s22, 1
    s_lshl_b32 s36, s36, 2
    s_add_u32 s36, s36, s16
    s_lshl_b32 s36, s36, 9
    s_add_u32 s36, s36, 6307840
    s_add_u32 m0, s29, 21504
    s_nop 0
    buffer_load_dwordx4 v10, s[60:63], s71 offen lds
    buffer_load_dwordx4 v11, s[60:63], s71 offen offset:1024 lds
    s_add_u32 m0, s29, 23552
    s_add_u32 s71, s28, 1032192
    buffer_load_dwordx4 v10, s[56:59], s71 offen lds
    buffer_load_dwordx4 v11, s[56:59], s71 offen offset:1024 lds
    s_waitcnt vmcnt(8)
    ds_read_b64_tr_b16 a[112:113], v12 offset:15360
    ds_read_b64_tr_b16 a[114:115], v12 offset:15616
    ds_read_b64_tr_b16 a[116:117], v13 offset:15360
    ds_read_b64_tr_b16 a[118:119], v13 offset:15616
    ds_read_b64_tr_b16 a[120:121], v12 offset:17408
    ds_read_b64_tr_b16 a[122:123], v12 offset:17664
    ds_read_b64_tr_b16 a[124:125], v13 offset:17408
    ds_read_b64_tr_b16 a[126:127], v13 offset:17664
    s_add_u32 m0, s29, 25600
    s_nop 0
    buffer_load_dwordx4 v10, s[60:63], s71 offen lds
    buffer_load_dwordx4 v11, s[60:63], s71 offen offset:1024 lds
    v_mov_b32 v56, -1
    v_mov_b32 v57, -1
    v_mov_b32 v58, -1
    v_mov_b32 v59, -1
    s_mov_b64 exec, s[20:21]
    buffer_store_dwordx4 v[56:59], v4, s[12:15], s7 offen sc1
    s_mov_b64 exec, -1
    s_waitcnt vmcnt(8)
    v_max3_u32 v27, v48, v49, v50
    s_waitcnt vmcnt(7)
    v_max3_u32 v27, v27, v51, v52
    v_max3_u32 v27, v27, v53, v54
    v_max_u32 v27, v27, v55
    v_cmp_eq_u32 vcc, -1, v27
    s_cbranch_vccnz L_slow_z
L_back_z:
    s_memrealtime s[0:1]
    ds_write_b128 v22, v[48:51] offset:0
    ds_write_b128 v22, v[52:55] offset:512
    s_waitcnt lgkmcnt(0)
    s_barrier
    ds_read_b128 v[64:67], v248 offset:0
    ds_read_b128 v[80:83], v248 offset:4112
    ds_read_b128 v[68:71], v248 offset:2048
    ds_read_b128 v[84:87], v248 offset:6160
    ds_read_b128 v[72:75], v248 offset:512
    ds_read_b128 v[88:91], v248 offset:4624
    ds_read_b128 v[76:79], v248 offset:2560
    ds_read_b128 v[92:95], v248 offset:6672
    s_add_u32 m0, s29, 27648
    s_add_u32 s71, s28, 1146880
    buffer_load_dwordx4 v10, s[56:59], s71 offen lds
    v_mov_b32 v56, s0
    v_xor_b32 v57, 0x5bd1e995, v56
    buffer_store_dwordx2 v[56:57], v254, s[12:15], 0 offen sc1
    s_waitcnt lgkmcnt(7)
    v_mfma_f32_16x16x32_bf16 v[112:115], v[64:67], v[96:99], 0
    buffer_load_dwordx4 v11, s[56:59], s71 offen offset:1024 lds
    v_mfma_f32_16x16x32_bf16 v[116:119], v[64:67], v[100:103], 0
    s_add_u32 m0, s29, 29696
    s_waitcnt lgkmcnt(6)
    v_mfma_f32_16x16x32_bf16 v[112:115], v[80:83], v[104:107], v[112:115]
    buffer_load_dwordx4 v10, s[60:63], s71 offen lds
    v_mfma_f32_16x16x32_bf16 v[116:119], v[80:83], v[108:111], v[116:119]
    s_waitcnt vmcnt(9)
    ds_read_b64_tr_b16 a[128:129], v12 offset:19456
    s_waitcnt lgkmcnt(6)
    v_mfma_f32_16x16x32_bf16 v[120:123], v[68:71], v[96:99], 0
    ds_read_b64_tr_b16 a[130:131], v12 offset:19712
    v_mfma_f32_16x16x32_bf16 v[124:127], v[68:71], v[100:103], 0
    buffer_load_dwordx4 v11, s[60:63], s71 offen offset:1024 lds
    s_waitcnt lgkmcnt(6)
    v_mfma_f32_16x16x32_bf16 v[120:123], v[84:87], v[104:107], v[120:123]
    v_cvt_pk_bf16_f32 v144, v112, v113
    v_cvt_pk_bf16_f32 v148, v116, v117
    v_mfma_f32_16x16x32_bf16 v[124:127], v[84:87], v[108:111], v[124:127]
    s_add_u32 m0, s29, 0
    v_cvt_pk_bf16_f32 v145, v114, v115
    v_cvt_pk_bf16_f32 v149, v118, v119
    s_waitcnt lgkmcnt(5)
    v_mfma_f32_16x16x32_bf16 v[128:131], v[72:75], v[96:99], 0
    s_add_u32 s71, s28, 1261568
    ds_read_b64_tr_b16 a[132:133], v13 offset:19456
    v_mfma_f32_16x16x32_bf16 v[132:135], v[72:75], v[100:103], 0
    buffer_load_dwordx4 v10, s[56:59], s71 offen lds
    s_waitcnt lgkmcnt(5)
    v_mfma_f32_16x16x32_bf16 v[128:131], v[88:91], v[104:107], v[128:131]
    v_cvt_pk_bf16_f32 v146, v120, v121
    v_cvt_pk_bf16_f32 v147, v122, v123
    v_mfma_f32_16x16x32_bf16 v[132:135], v[88:91], v[108:111], v[132:135]
    v_cvt_pk_bf16_f32 v150, v124, v125
    v_cvt_pk_bf16_f32 v151, v126, v127
    s_waitcnt lgkmcnt(4)
    v_mfma_f32_16x16x32_bf16 v[136:139], v[76:79], v[96:99], 0
    ds_read_b64_tr_b16 a[134:135], v13 offset:19712
    v_mfma_f32_16x16x32_bf16 v[140:143], v[76:79], v[100:103], 0
    buffer_load_dwordx4 v11, s[56:59], s71 offen offset:1024 lds
    s_waitcnt lgkmcnt(4)
    v_mfma_f32_16x16x32_bf16 v[136:139], v[92:95], v[104:107], v[136:139]
    s_add_u32 m0, s29, 2048
    v_cvt_pk_bf16_f32 v152, v128, v129
    v_cvt_pk_bf16_f32 v156, v132, v133
    v_mfma_f32_16x16x32_bf16 v[140:143], v[92:95], v[108:111], v[140:143]
    v_cvt_pk_bf16_f32 v153, v130, v131
    v_cvt_pk_bf16_f32 v157, v134, v135
    v_mfma_f32_16x16x32_bf16 v[192:195], v[144:147], a[224:227], 0
    v_mov_b32 v100, 0
    v_mov_b32 v101, 0
    v_mfma_f32_16x16x32_bf16 v[200:203], v[144:147], a[240:243], 0
    v_cvt_pk_bf16_f32 v154, v136, v137
    v_cvt_pk_bf16_f32 v155, v138, v139
    v_mfma_f32_16x16x32_bf16 v[192:195], v[148:151], a[228:231], v[192:195]
    v_cvt_pk_bf16_f32 v158, v140, v141
    v_cvt_pk_bf16_f32 v159, v142, v143
    v_mfma_f32_16x16x32_bf16 v[200:203], v[148:151], a[244:247], v[200:203]
    v_mov_b32 v102, 0
    v_mov_b32 v103, 0
    v_mfma_f32_16x16x32_bf16 v[196:199], v[152:155], a[232:235], 0
    buffer_load_dwordx4 v10, s[60:63], s71 offen lds
    v_mfma_f32_16x16x32_bf16 v[204:207], v[152:155], a[248:251], 0
    ds_read_b64_tr_b16 a[136:137], v12 offset:21504
    v_mfma_f32_16x16x32_bf16 v[196:199], v[156:159], a[236:239], v[196:199]
    buffer_load_dwordx4 v11, s[60:63], s71 offen offset:1024 lds
    v_mfma_f32_16x16x32_bf16 v[204:207], v[156:159], a[252:255], v[204:207]
    s_add_u32 m0, s29, 4096
    s_add_u32 s71, s28, 1376256
    ds_read_b64_tr_b16 a[138:139], v12 offset:21760
    ds_read_b64_tr_b16 a[140:141], v13 offset:21504
    ds_read_b64_tr_b16 a[142:143], v13 offset:21760
    s_waitcnt vmcnt(10)
    ds_read_b64_tr_b16 a[144:145], v12 offset:23552
    ds_read_b64_tr_b16 a[146:147], v12 offset:23808
    ds_read_b64_tr_b16 a[148:149], v13 offset:23552
    v_add_f32 v64, v192, v196
    v_add_f32 v65, v193, v197
    v_add_f32 v66, v194, v198
    v_add_f32 v67, v195, v199
    v_add_f32 v68, v200, v204
    v_add_f32 v69, v201, v205
    v_add_f32 v70, v202, v206
    v_add_f32 v71, v203, v207
    v_permlane16_swap_b32 v64, v68
    v_permlane16_swap_b32 v65, v69
    v_permlane16_swap_b32 v66, v70
    v_permlane16_swap_b32 v67, v71
    v_fmac_f32 v32, v64, v208
    v_fmac_f32 v33, v65, v209
    v_fmac_f32 v34, v66, v210
    v_fmac_f32 v35, v67, v211
    v_fmac_f32 v36, v68, v212
    v_fmac_f32 v37, v69, v213
    v_fmac_f32 v38, v70, v214
    v_fmac_f32 v39, v71, v215
    v_cvt_pk_bf16_f32 v88, v32, v33
    v_cvt_pk_bf16_f32 v89, v34, v35
    v_cvt_pk_bf16_f32 v90, v36, v37
    v_cvt_pk_bf16_f32 v91, v38, v39
    s_mov_b64 exec, s[20:21]
    s_waitcnt vmcnt(9)
    buffer_store_dwordx4 v[88:91], v4, s[12:15], s6 offen sc1
    s_mov_b64 exec, -1
    v_sub_f32 v72, v192, v196
    v_sub_f32 v73, v193, v197
    v_sub_f32 v74, v194, v198
    v_sub_f32 v75, v195, v199
    v_sub_f32 v76, v200, v204
    v_sub_f32 v77, v201, v205
    v_sub_f32 v78, v202, v206
    v_sub_f32 v79, v203, v207
    v_permlane16_swap_b32 v72, v76
    v_permlane16_swap_b32 v73, v77
    v_permlane16_swap_b32 v74, v78
    v_permlane16_swap_b32 v75, v79
    v_fmac_f32 v40, v72, v208
    v_fmac_f32 v41, v73, v209
    v_fmac_f32 v42, v74, v210
    v_fmac_f32 v43, v75, v211
    v_fmac_f32 v44, v76, v212
    v_fmac_f32 v45, v77, v213
    v_fmac_f32 v46, v78, v214
    v_fmac_f32 v47, v79, v215
    v_cvt_pk_bf16_f32 v92, v40, v41
    v_cvt_pk_bf16_f32 v93, v42, v43
    v_cvt_pk_bf16_f32 v94, v44, v45
    v_cvt_pk_bf16_f32 v95, v46, v47
    s_mov_b64 exec, s[20:21]
    buffer_store_dwordx4 v[92:95], v4, s[12:15], s7 offen sc1
    v_fma_f32 v64, v64, v216, v232
    v_fma_f32 v65, v65, v217, v233
    v_fma_f32 v66, v66, v218, v234
    v_fma_f32 v67, v67, v219, v235
    v_fma_f32 v68, v68, v220, v236
    v_fma_f32 v69, v69, v221, v237
    v_fma_f32 v70, v70, v222, v238
    v_fma_f32 v71, v71, v223, v239
    v_cvt_pk_bf16_f32 v80, v64, v65
    v_cvt_pk_bf16_f32 v81, v66, v67
    v_cvt_pk_bf16_f32 v82, v68, v69
    v_cvt_pk_bf16_f32 v83, v70, v71
    v_fma_f32 v72, v72, v216, v240
    v_fma_f32 v73, v73, v217, v241
    v_fma_f32 v74, v74, v218, v242
    v_fma_f32 v75, v75, v219, v243
    v_fma_f32 v76, v76, v220, v244
    v_fma_f32 v77, v77, v221, v245
    v_fma_f32 v78, v78, v222, v246
    v_fma_f32 v79, v79, v223, v247
    v_cvt_pk_bf16_f32 v84, v72, v73
    v_cvt_pk_bf16_f32 v85, v74, v75
    v_cvt_pk_bf16_f32 v86, v76, v77
    v_cvt_pk_bf16_f32 v87, v78, v79
    v_dot2c_f32_bf16 v100, s25, v80
    v_dot2c_f32_bf16 v101, v80, v80
    v_dot2c_f32_bf16 v102, s25, v84
    v_dot2c_f32_bf16 v103, v84, v84
    v_dot2c_f32_bf16 v100, s25, v81
    v_dot2c_f32_bf16 v101, v81, v81
    v_dot2c_f32_bf16 v102, s25, v85
    v_dot2c_f32_bf16 v103, v85, v85
    v_dot2c_f32_bf16 v100, s25, v82
    v_dot2c_f32_bf16 v101, v82, v82
    v_dot2c_f32_bf16 v102, s25, v86
    v_dot2c_f32_bf16 v103, v86, v86
    v_dot2c_f32_bf16 v100, s25, v83
    v_dot2c_f32_bf16 v101, v83, v83
    v_dot2c_f32_bf16 v102, s25, v87
    v_dot2c_f32_bf16 v103, v87, v87
    s_mov_b64 exec, -1
    ds_write_b64 v250, v[100:101] offset:0
    s_nop 0
    ds_write_b64 v250, v[102:103] offset:256
    s_mov_b64 exec, s[20:21]
    buffer_store_dwordx4 v[80:83], v4, s[12:15], s26 offen sc1
    buffer_store_dwordx4 v[84:87], v4, s[12:15], s27 offen sc1
    s_mov_b64 exec, -1
    s_waitcnt lgkmcnt(0)
    s_barrier
    ds_read_b64 v[64:65], v19 offset:3072
    ds_read_b64 v[66:67], v19 offset:3584
    ds_read_b64 v[68:69], v19 offset:4096
    ds_read_b64 v[70:71], v19 offset:4608
    ds_read_b64 v[72:73], v19 offset:5120
    ds_read_b64 v[74:75], v19 offset:5632
    ds_read_b64 v[76:77], v19 offset:6144
    ds_read_b64 v[78:79], v19 offset:6656
    ds_read_b64_tr_b16 a[150:151], v13 offset:23808
    ds_read_b64_tr_b16 a[152:153], v12 offset:25600
    ds_read_b64_tr_b16 a[154:155], v12 offset:25856
    ds_read_b64_tr_b16 a[156:157], v13 offset:25600
    ds_read_b64_tr_b16 a[158:159], v13 offset:25856
    s_waitcnt vmcnt(8)
    ds_read_b64_tr_b16 a[160:161], v12 offset:27648
    ds_read_b64_tr_b16 a[162:163], v12 offset:27904
    ds_read_b64_tr_b16 a[164:165], v13 offset:27648
    s_waitcnt lgkmcnt(11)
    v_add_f32 v64, v64, v72
    v_add_f32 v65, v65, v73
    s_waitcnt lgkmcnt(10)
    v_add_f32 v66, v66, v74
    v_add_f32 v67, v67, v75
    s_waitcnt lgkmcnt(9)
    v_add_f32 v68, v68, v76
    v_add_f32 v69, v69, v77
    s_waitcnt lgkmcnt(8)
    v_add_f32 v70, v70, v78
    v_add_f32 v71, v71, v79
    v_add_f32 v64, v64, v68
    v_add_f32 v65, v65, v69
    v_add_f32 v66, v66, v70
    v_add_f32 v67, v67, v71
    v_add_f32 v64, v64, v66
    v_add_f32 v65, v65, v67
    buffer_store_dwordx2 v[64:65], v5, s[12:15], s69 offen sc1
    s_cmp_ge_u32 s18, 28
    s_cbranch_scc1 L_early
    v_mfma_f32_16x16x32_bf16 v[160:163], v[176:179], a[64:67], v[160:163]
    ds_read_b128 v[188:191], v63 offset:1472
    v_lshrrev_b32 v17, 1, v8
    v_mfma_f32_16x16x32_bf16 v[164:167], v[176:179], a[68:71], v[164:167]
    ds_read_b64_tr_b16 a[166:167], v13 offset:27904
    v_lshlrev_b32 v17, 12, v17
    v_mfma_f32_16x16x32_bf16 v[168:171], v[176:179], a[72:75], v[168:171]
    ds_read_b64_tr_b16 a[168:169], v12 offset:29696
    v_and_b32 v6, 1, v8
    v_mfma_f32_16x16x32_bf16 v[172:175], v[176:179], a[76:79], v[172:175]
    ds_read_b64_tr_b16 a[170:171], v12 offset:29952
    v_lshl_add_u32 v17, v6, 9, v17
    v_mfma_f32_16x16x32_bf16 v[160:163], v[180:183], a[80:83], v[160:163]
    ds_read_b128 v[176:179], v63 offset:1536
    v_lshl_add_u32 v17, v7, 3, v17
    v_mfma_f32_16x16x32_bf16 v[164:167], v[180:183], a[84:87], v[164:167]
    ds_read_b64_tr_b16 a[172:173], v13 offset:29696
    v_bfe_u32 v30, v2, 3, 2
    v_mfma_f32_16x16x32_bf16 v[168:171], v[180:183], a[88:91], v[168:171]
    ds_read_b64_tr_b16 a[174:175], v13 offset:29952
    v_lshl_add_u32 v30, v30, 2, v9
    v_mfma_f32_16x16x32_bf16 v[172:175], v[180:183], a[92:95], v[172:175]
    s_waitcnt vmcnt(5)
    ds_read_b64_tr_b16 a[176:177], v12 offset:0
    v_add_u32 v14, s32, v30
    v_mfma_f32_16x16x32_bf16 v[160:163], v[184:187], a[96:99], v[160:163]
    ds_read_b128 v[180:183], v63 offset:1600
    v_lshrrev_b32 v34, 3, v2
    v_mfma_f32_16x16x32_bf16 v[164:167], v[184:187], a[100:103], v[164:167]
    buffer_load_dwordx4 v10, s[56:59], s71 offen lds
    v_mfma_f32_16x16x32_bf16 v[168:171], v[184:187], a[104:107], v[168:171]
    ds_read_b64_tr_b16 a[178:179], v12 offset:256
    v_mul_u32_u24 v35, 896, v34
    v_mfma_f32_16x16x32_bf16 v[172:175], v[184:187], a[108:111], v[172:175]
    ds_read_b64_tr_b16 a[180:181], v13 offset:0
    v_and_b32 v34, 6, v34
    s_waitcnt lgkmcnt(10)
    v_mfma_f32_16x16x32_bf16 v[160:163], v[188:191], a[112:115], v[160:163]
    ds_read_b128 v[184:187], v63 offset:1664
    v_and_b32 v36, 7, v2
    v_mfma_f32_16x16x32_bf16 v[164:167], v[188:191], a[116:119], v[164:167]
    buffer_load_dwordx4 v11, s[56:59], s71 offen offset:1024 lds
    v_mfma_f32_16x16x32_bf16 v[168:171], v[188:191], a[120:123], v[168:171]
    s_add_u32 m0, s29, 6144
    ds_read_b64_tr_b16 a[182:183], v13 offset:256
    v_xor_b32 v34, v34, v36
    v_mfma_f32_16x16x32_bf16 v[172:175], v[188:191], a[124:127], v[172:175]
    ds_read_b64_tr_b16 a[184:185], v12 offset:2048
    v_lshl_add_u32 v18, v34, 4, v35
    s_waitcnt lgkmcnt(9)
    v_mfma_f32_16x16x32_bf16 v[160:163], v[176:179], a[128:131], v[160:163]
    ds_read_b128 v[188:191], v63 offset:1728
    v_add_u32 v19, 6144, v18
    v_mfma_f32_16x16x32_bf16 v[164:167], v[176:179], a[132:135], v[164:167]
    buffer_load_dwordx4 v10, s[60:63], s71 offen lds
    v_mfma_f32_16x16x32_bf16 v[168:171], v[176:179], a[136:139], v[168:171]
    ds_read_b64_tr_b16 a[186:187], v12 offset:2304
    v_add_u32 v20, 12288, v18
    v_mfma_f32_16x16x32_bf16 v[172:175], v[176:179], a[140:143], v[172:175]
    ds_read_b64_tr_b16 a[188:189], v13 offset:2048
    v_add_u32 v21, 18432, v18
    buffer_load_dwordx4 v11, s[60:63], s71 offen offset:1024 lds
    s_add_u32 m0, s29, 8192
    s_add_u32 s71, s28, 1490944
    buffer_load_dwordx4 v10, s[56:59], s71 offen lds
    buffer_load_dwordx4 v11, s[56:59], s71 offen offset:1024 lds
    s_add_u32 m0, s29, 10240
    s_nop 0
    buffer_load_dwordx4 v10, s[60:63], s71 offen lds
    buffer_load_dwordx4 v11, s[60:63], s71 offen offset:1024 lds
    s_waitcnt vmcnt(11)
    s_add_u32 m0, s32, 0
    s_add_u32 s37, s33, 0
    buffer_load_dwordx4 v9, s[12:15], s37 offen offset:0 sc1 lds
    buffer_load_dwordx4 v9, s[12:15], s37 offen offset:1024 sc1 lds
    buffer_load_dwordx4 v9, s[12:15], s37 offen offset:2048 sc1 lds
    buffer_load_dwordx4 v9, s[12:15], s37 offen offset:3072 sc1 lds
    s_waitcnt lgkmcnt(8)
    v_mfma_f32_16x16x32_bf16 v[160:163], v[180:183], a[144:147], v[160:163]
    s_add_u32 m0, s32, 14336
    ds_read_b128 v[176:179], v63 offset:1792
    s_add_u32 s37, s33, 57344
    v_mfma_f32_16x16x32_bf16 v[164:167], v[180:183], a[148:151], v[164:167]
    ds_read_b64_tr_b16 a[190:191], v13 offset:2304
    v_bfe_u32 v32, v2, 2, 2
    v_mfma_f32_16x16x32_bf16 v[168:171], v[180:183], a[152:155], v[168:171]
    v_and_b32 v33, 3, v2
    v_lshl_add_u32 v34, v8, 2, v32
    v_mfma_f32_16x16x32_bf16 v[172:175], v[180:183], a[156:159], v[172:175]
    v_lshlrev_b32 v35, 7, v34
    v_lshl_add_u32 v35, v33, 3, v35
    s_waitcnt lgkmcnt(7)
    v_mfma_f32_16x16x32_bf16 v[160:163], v[184:187], a[160:163], v[160:163]
    s_add_u32 s35, s29, 15360
    ds_read_b128 v[180:183], v63 offset:1856
    v_add_u32 v35, s35, v35
    v_mfma_f32_16x16x32_bf16 v[164:167], v[184:187], a[164:167], v[164:167]
    v_bfe_u32 v34, v34, 1, 2
    v_lshl_add_u32 v22, v34, 5, v35
    v_mfma_f32_16x16x32_bf16 v[168:171], v[184:187], a[168:171], v[168:171]
    v_xor_b32 v23, 32, v22
    v_xor_b32 v24, 64, v22
    v_mfma_f32_16x16x32_bf16 v[172:175], v[184:187], a[172:175], v[172:175]
    v_xor_b32 v25, 96, v22
    v_add_u32 v26, 68608, v9
    s_waitcnt vmcnt(8)
    ds_read_b64_tr_b16 a[192:193], v12 offset:4096
    ds_read_b64_tr_b16 a[194:195], v12 offset:4352
    ds_read_b64_tr_b16 a[196:197], v13 offset:4096
    ds_read_b64_tr_b16 a[198:199], v13 offset:4352
    ds_read_b64_tr_b16 a[200:201], v12 offset:6144
    ds_read_b64_tr_b16 a[202:203], v12 offset:6400
    ds_read_b64_tr_b16 a[204:205], v13 offset:6144
    ds_read_b64_tr_b16 a[206:207], v13 offset:6400
    s_waitcnt lgkmcnt(13)
    v_mfma_f32_16x16x32_bf16 v[160:163], v[188:191], a[176:179], v[160:163]
    v_add_u32 v27, 132096, v9
    v_lshlrev_b32 v28, 4, v7
    v_mfma_f32_16x16x32_bf16 v[164:167], v[188:191], a[180:183], v[164:167]
    v_min_u32 v34, 1, v2
    v_lshlrev_b32 v34, 30, v34
    s_waitcnt lgkmcnt(12)
    v_mfma_f32_16x16x32_bf16 v[168:171], v[188:191], a[184:187], v[168:171]
    v_add_u32 v29, s43, v34
    v_add_u32 v5, s36, v34
    s_waitcnt lgkmcnt(9)
    v_mfma_f32_16x16x32_bf16 v[172:175], v[188:191], a[188:191], v[172:175]
    v_add_u32 v1, s38, v30
    v_add_u32 v15, s39, v30
    s_waitcnt vmcnt(4)
    ds_read_b64_tr_b16 a[208:209], v12 offset:8192
    ds_read_b64_tr_b16 a[210:211], v12 offset:8448
    ds_read_b64_tr_b16 a[212:213], v13 offset:8192
    ds_read_b64_tr_b16 a[214:215], v13 offset:8448
    ds_read_b64_tr_b16 a[216:217], v12 offset:10240
    ds_read_b64_tr_b16 a[218:219], v12 offset:10496
    ds_read_b64_tr_b16 a[220:221], v13 offset:10240
    ds_read_b64_tr_b16 a[222:223], v13 offset:10496
    s_waitcnt lgkmcnt(14)
    v_mfma_f32_16x16x32_bf16 v[160:163], v[176:179], a[192:195], v[160:163]
    v_lshrrev_b32 v6, 1, v8
    v_lshl_add_u32 v6, s16, 1, v6
    s_waitcnt lgkmcnt(12)
    v_mfma_f32_16x16x32_bf16 v[164:167], v[176:179], a[196:199], v[164:167]
    v_lshl_add_u32 v6, v6, 8, v28
    s_mov_b32 s44, 0xffff
    s_waitcnt lgkmcnt(10)
    v_mfma_f32_16x16x32_bf16 v[168:171], v[176:179], a[200:203], v[168:171]
    s_mov_b32 s45, 0
    s_waitcnt lgkmcnt(8)
    v_mfma_f32_16x16x32_bf16 v[172:175], v[176:179], a[204:207], v[172:175]
    s_waitcnt lgkmcnt(6)
    v_mfma_f32_16x16x32_bf16 v[160:163], v[180:183], a[208:211], v[160:163]
    s_waitcnt lgkmcnt(4)
    v_mfma_f32_16x16x32_bf16 v[164:167], v[180:183], a[212:215], v[164:167]
    s_waitcnt lgkmcnt(2)
    v_mfma_f32_16x16x32_bf16 v[168:171], v[180:183], a[216:219], v[168:171]
    s_waitcnt lgkmcnt(0)
    v_mfma_f32_16x16x32_bf16 v[172:175], v[180:183], a[220:223], v[172:175]
    buffer_load_dwordx4 v9, s[12:15], s37 offen offset:0 sc1 lds
    buffer_load_dwordx4 v9, s[12:15], s37 offen offset:1024 sc1 lds
    buffer_load_dwordx4 v9, s[12:15], s37 offen offset:2048 sc1 lds
    buffer_load_dwordx4 v9, s[12:15], s37 offen offset:3072 sc1 lds
    buffer_load_dwordx2 v[240:241], v17, s[12:15], s34 offen offset:0 sc1
    buffer_load_dwordx2 v[242:243], v17, s[12:15], s34 offen offset:128 sc1
    buffer_load_dwordx2 v[244:245], v17, s[12:15], s34 offen offset:256 sc1
    buffer_load_dwordx2 v[246:247], v17, s[12:15], s34 offen offset:384 sc1
    v_cndmask_b32 v160, 0, v160, s[44:45]
    v_cndmask_b32 v161, 0, v161, s[44:45]
    v_cvt_pk_bf16_f32 v65, v160, v161
    v_lshlrev_b32 v96, 16, v65
    v_and_b32 v97, 0xffff0000, v65
    v_sub_f32 v96, v160, v96
    v_sub_f32 v97, v161, v97
    v_cvt_pk_bf16_f32 v64, v160, v96
    v_cvt_pk_bf16_f32 v66, v97, v161
    v_mov_b32 v67, 0
    v_cndmask_b32 v164, 0, v164, s[44:45]
    v_cndmask_b32 v165, 0, v165, s[44:45]
    v_cvt_pk_bf16_f32 v69, v164, v165
    v_lshlrev_b32 v96, 16, v69
    v_and_b32 v97, 0xffff0000, v69
    v_sub_f32 v96, v164, v96
    v_sub_f32 v97, v165, v97
    v_cvt_pk_bf16_f32 v68, v164, v96
    v_cvt_pk_bf16_f32 v70, v97, v165
    v_mov_b32 v71, 0
    v_cndmask_b32 v168, 0, v168, s[44:45]
    v_cndmask_b32 v169, 0, v169, s[44:45]
    v_cvt_pk_bf16_f32 v73, v168, v169
    v_lshlrev_b32 v96, 16, v73
    v_and_b32 v97, 0xffff0000, v73
    v_sub_f32 v96, v168, v96
    v_sub_f32 v97, v169, v97
    v_cvt_pk_bf16_f32 v72, v168, v96
    v_cvt_pk_bf16_f32 v74, v97, v169
    v_mov_b32 v75, 0
    v_cndmask_b32 v172, 0, v172, s[44:45]
    v_cndmask_b32 v173, 0, v173, s[44:45]
    v_cvt_pk_bf16_f32 v77, v172, v173
    v_lshlrev_b32 v96, 16, v77
    v_and_b32 v97, 0xffff0000, v77
    v_sub_f32 v96, v172, v96
    v_sub_f32 v97, v173, v97
    v_cvt_pk_bf16_f32 v76, v172, v96
    v_cvt_pk_bf16_f32 v78, v97, v173
    v_mov_b32 v79, 0
    s_waitcnt vmcnt(8)
    ds_read2st64_b32 v[32:33], v14 offset0:0 offset1:4
    ds_read2st64_b32 v[34:35], v14 offset0:8 offset1:12
    s_waitcnt lgkmcnt(0)
    v_max3_u32 v3, v32, v33, v34
    v_max_u32 v3, v3, v35
    v_cmp_eq_u32 vcc, -1, v3
    s_cbranch_vccnz L_slow_a1_0
L_back_a1_0:
    s_barrier
    ds_read_b128 v[80:83], v9 offset:8192
    ds_read_b128 v[84:87], v9 offset:9216
    ds_read_b128 v[88:91], v9 offset:10240
    s_waitcnt lgkmcnt(2)
    v_mfma_f32_16x16x32_bf16 v[32:35], a[0:3], v[80:83], 0
    ds_read_b128 v[92:95], v9 offset:11264
    s_add_u32 m0, s35, 0
    v_mfma_f32_16x16x32_bf16 v[36:39], a[4:7], v[80:83], 0
    s_add_u32 s37, s40, 0
    s_add_u32 s75, s74, 57344
    v_mfma_f32_16x16x32_bf16 v[40:43], a[8:11], v[80:83], 0
    buffer_load_dwordx4 v18, s[64:67], s37 offen offset:0 lds
    v_mfma_f32_16x16x32_bf16 v[44:47], a[12:15], v[80:83], 0
    s_waitcnt lgkmcnt(2)
    v_mfma_f32_16x16x32_bf16 v[32:35], a[16:19], v[84:87], v[32:35]
    ds_read_b128 v[80:83], v9 offset:12288
    v_mfma_f32_16x16x32_bf16 v[36:39], a[20:23], v[84:87], v[36:39]
    buffer_load_dwordx4 v19, s[64:67], s37 offen offset:1024 lds
    v_mfma_f32_16x16x32_bf16 v[40:43], a[24:27], v[84:87], v[40:43]
    v_mfma_f32_16x16x32_bf16 v[44:47], a[28:31], v[84:87], v[44:47]
    s_waitcnt lgkmcnt(2)
    buffer_load_dwordx4 v20, s[64:67], s37 offen offset:2048 lds
    v_mfma_f32_16x16x32_bf16 v[32:35], a[32:35], v[88:91], v[32:35]
    ds_read_b128 v[84:87], v9 offset:13312
    v_mfma_f32_16x16x32_bf16 v[36:39], a[36:39], v[88:91], v[36:39]
    v_mfma_f32_16x16x32_bf16 v[40:43], a[40:43], v[88:91], v[40:43]
    v_mfma_f32_16x16x32_bf16 v[44:47], a[44:47], v[88:91], v[44:47]
    s_waitcnt lgkmcnt(2)
    buffer_load_dwordx4 v21, s[64:67], s37 offen offset:3072 lds
    v_mfma_f32_16x16x32_bf16 v[32:35], a[48:51], v[92:95], v[32:35]
    s_add_u32 m0, s39, 0
    ds_read_b128 v[88:91], v9 offset:14336
    s_add_u32 s37, s42, 14336
    v_mfma_f32_16x16x32_bf16 v[36:39], a[52:55], v[92:95], v[36:39]
    v_mfma_f32_16x16x32_bf16 v[40:43], a[56:59], v[92:95], v[40:43]
    v_mfma_f32_16x16x32_bf16 v[44:47], a[60:63], v[92:95], v[44:47]
    s_waitcnt lgkmcnt(2)
    buffer_load_dwordx4 v9, s[12:15], s37 offen offset:0 sc1 lds
    v_mfma_f32_16x16x32_bf16 v[32:35], a[64:67], v[80:83], v[32:35]
    ds_read_b128 v[92:95], v9 offset:15360
    v_mfma_f32_16x16x32_bf16 v[36:39], a[68:71], v[80:83], v[36:39]
    v_mfma_f32_16x16x32_bf16 v[40:43], a[72:75], v[80:83], v[40:43]
    v_mfma_f32_16x16x32_bf16 v[44:47], a[76:79], v[80:83], v[44:47]
    s_waitcnt lgkmcnt(2)
    buffer_load_dwordx4 v9, s[12:15], s37 offen offset:1024 sc1 lds
    v_mfma_f32_16x16x32_bf16 v[32:35], a[80:83], v[84:87], v[32:35]
    ds_read_b128 v[80:83], v9 offset:16384
    s_waitcnt vmcnt(10)
    v_mfma_f32_16x16x32_bf16 v[36:39], a[84:87], v[84:87], v[36:39]
    ds_read2st64_b32 v[10:11], v14 offset0:56 offset1:60
    v_mfma_f32_16x16x32_bf16 v[40:43], a[88:91], v[84:87], v[40:43]
    ds_read2st64_b32 v[12:13], v14 offset0:64 offset1:68
    v_mfma_f32_16x16x32_bf16 v[44:47], a[92:95], v[84:87], v[44:47]
    s_waitcnt lgkmcnt(4)
    buffer_load_dwordx4 v9, s[12:15], s37 offen offset:2048 sc1 lds
    v_mfma_f32_16x16x32_bf16 v[32:35], a[96:99], v[88:91], v[32:35]
    ds_read_b128 v[84:87], v9 offset:17408
    s_waitcnt vmcnt(9)
    v_max3_u32 v103, v240, v241, v242
    v_mfma_f32_16x16x32_bf16 v[36:39], a[100:103], v[88:91], v[36:39]
    v_mfma_f32_16x16x32_bf16 v[40:43], a[104:107], v[88:91], v[40:43]
    s_waitcnt vmcnt(8)
    v_max3_u32 v103, v103, v243, v244
    v_mfma_f32_16x16x32_bf16 v[44:47], a[108:111], v[88:91], v[44:47]
    s_waitcnt lgkmcnt(4)
    buffer_load_dwordx4 v9, s[12:15], s37 offen offset:3072 sc1 lds
    v_mfma_f32_16x16x32_bf16 v[32:35], a[112:115], v[92:95], v[32:35]
    s_add_u32 s37, s42, 18432
    ds_read_b128 v[88:91], v9 offset:18432
    s_add_u32 m0, s39, 4096
    v_mfma_f32_16x16x32_bf16 v[36:39], a[116:119], v[92:95], v[36:39]
    s_waitcnt vmcnt(8)
    v_max3_u32 v103, v103, v245, v246
    v_max_u32 v103, v103, v247
    v_mfma_f32_16x16x32_bf16 v[40:43], a[120:123], v[92:95], v[40:43]
    v_cmp_eq_u32 vcc, -1, v103
    s_cbranch_vccnz L_slow_sv
L_back_sv:
    v_mfma_f32_16x16x32_bf16 v[44:47], a[124:127], v[92:95], v[44:47]
    s_waitcnt lgkmcnt(4)
    buffer_load_dwordx4 v9, s[12:15], s37 offen offset:0 sc1 lds
    v_mfma_f32_16x16x32_bf16 v[32:35], a[128:131], v[80:83], v[32:35]
    ds_read_b128 v[92:95], v9 offset:19456
    s_waitcnt lgkmcnt(3)
    v_max3_u32 v3, v10, v11, v12
    v_mfma_f32_16x16x32_bf16 v[36:39], a[132:135], v[80:83], v[36:39]
    v_max_u32 v3, v3, v13
    v_add_f32 v240, v240, v242
    v_mfma_f32_16x16x32_bf16 v[40:43], a[136:139], v[80:83], v[40:43]
    v_cmp_eq_u32 vcc, -1, v3
    s_cbranch_vccnz L_slow_a1_1
L_back_a1_1:
    v_mfma_f32_16x16x32_bf16 v[44:47], a[140:143], v[80:83], v[44:47]
    s_waitcnt lgkmcnt(2)
    buffer_load_dwordx4 v9, s[12:15], s37 offen offset:1024 sc1 lds
    v_mfma_f32_16x16x32_bf16 v[32:35], a[144:147], v[84:87], v[32:35]
    ds_read_b128 v[80:83], v9 offset:20480
    v_add_f32 v241, v241, v243
    v_mfma_f32_16x16x32_bf16 v[36:39], a[148:151], v[84:87], v[36:39]
    v_add_f32 v244, v244, v246
    v_add_f32 v245, v245, v247
    v_mfma_f32_16x16x32_bf16 v[40:43], a[152:155], v[84:87], v[40:43]
    v_add_f32 v240, v240, v244
    v_add_f32 v241, v241, v245
    v_mfma_f32_16x16x32_bf16 v[44:47], a[156:159], v[84:87], v[44:47]
    s_waitcnt lgkmcnt(2)
    buffer_load_dwordx4 v9, s[12:15], s37 offen offset:2048 sc1 lds
    v_mfma_f32_16x16x32_bf16 v[32:35], a[160:163], v[88:91], v[32:35]
    ds_read_b128 v[84:87], v9 offset:21504
    s_add_u32 m0, s35, 4096
    v_mfma_f32_16x16x32_bf16 v[36:39], a[164:167], v[88:91], v[36:39]
    s_add_u32 s37, s40, 28672
    v_mov_b32 v242, v240
    v_mov_b32 v243, v241
    v_mfma_f32_16x16x32_bf16 v[40:43], a[168:171], v[88:91], v[40:43]
    v_mov_b32 v247, 0
    v_permlane16_swap_b32 v240, v242
    v_mfma_f32_16x16x32_bf16 v[44:47], a[172:175], v[88:91], v[44:47]
    s_waitcnt lgkmcnt(2)
    buffer_load_dwordx4 v18, s[64:67], s37 offen offset:0 lds
    v_mfma_f32_16x16x32_bf16 v[32:35], a[176:179], v[92:95], v[32:35]
    s_barrier
    ds_read_b128 v[88:91], v9 offset:22528
    v_mfma_f32_16x16x32_bf16 v[36:39], a[180:183], v[92:95], v[36:39]
    v_permlane16_swap_b32 v241, v243
    v_add_f32 v240, v240, v242
    v_mfma_f32_16x16x32_bf16 v[40:43], a[184:187], v[92:95], v[40:43]
    v_add_f32 v241, v241, v243
    v_mul_f32 v240, 0xbb124925, v240
    v_mfma_f32_16x16x32_bf16 v[44:47], a[188:191], v[92:95], v[44:47]
    s_waitcnt lgkmcnt(2)
    buffer_load_dwordx4 v19, s[64:67], s37 offen offset:1024 lds
    v_mfma_f32_16x16x32_bf16 v[32:35], a[192:195], v[80:83], v[32:35]
    s_waitcnt vmcnt(9)
    ds_read_b128 v[92:95], v9 offset:23552
    v_mul_f32 v241, 0x3b124925, v241
    v_mfma_f32_16x16x32_bf16 v[36:39], a[196:199], v[80:83], v[36:39]
    v_fma_f32 v241, -v240, v240, v241
    v_max_f32 v241, 0, v241
    v_mfma_f32_16x16x32_bf16 v[40:43], a[200:203], v[80:83], v[40:43]
    ds_read_b64_tr_b16 v[112:113], v22 offset:0
    v_add_f32 v241, 0x3727c5ac, v241
    v_mfma_f32_16x16x32_bf16 v[44:47], a[204:207], v[80:83], v[44:47]
    s_waitcnt lgkmcnt(3)
    buffer_load_dwordx4 v20, s[64:67], s37 offen offset:2048 lds
    v_mfma_f32_16x16x32_bf16 v[32:35], a[208:211], v[84:87], v[32:35]
    ds_read_b128 v[80:83], v9 offset:24576
    v_mfma_f32_16x16x32_bf16 v[36:39], a[212:215], v[84:87], v[36:39]
    v_sqrt_f32 v241, v241
    v_mfma_f32_16x16x32_bf16 v[40:43], a[216:219], v[84:87], v[40:43]
    v_cvt_pk_bf16_f32 v244, v240, v240
    v_cvt_pk_bf16_f32 v242, v240, v241
    v_mfma_f32_16x16x32_bf16 v[44:47], a[220:223], v[84:87], v[44:47]
    s_waitcnt lgkmcnt(3)
    buffer_load_dwordx4 v21, s[64:67], s37 offen offset:3072 lds
    v_mfma_f32_16x16x32_bf16 v[48:51], a[0:3], v[88:91], 0
    ds_read_b128 v[84:87], v9 offset:25600
    s_add_u32 m0, s35, 8192
    v_mfma_f32_16x16x32_bf16 v[52:55], a[4:7], v[88:91], 0
    s_add_u32 s37, s40, 57344
    v_lshlrev_b32 v243, 16, v242
    v_and_b32 v242, 0xffff0000, v242
    v_mfma_f32_16x16x32_bf16 v[56:59], a[8:11], v[88:91], 0
    v_sub_f32 v243, v240, v243
    v_sub_f32 v242, v241, v242
    v_mfma_f32_16x16x32_bf16 v[60:63], a[12:15], v[88:91], 0
    s_waitcnt lgkmcnt(3)
    buffer_load_dwordx4 v18, s[64:67], s37 offen offset:0 lds
    v_mfma_f32_16x16x32_bf16 v[48:51], a[16:19], v[92:95], v[48:51]
    ds_read_b128 v[88:91], v9 offset:26624
    v_cvt_pk_bf16_f32 v245, v243, v241
    v_mfma_f32_16x16x32_bf16 v[52:55], a[20:23], v[92:95], v[52:55]
    ds_read_b64_tr_b16 v[114:115], v22 offset:2048
    v_cvt_pk_bf16_f32 v246, v241, v242
    v_mfma_f32_16x16x32_bf16 v[56:59], a[24:27], v[92:95], v[56:59]
    ds_write_b128 v6, v[244:247] offset:4096
    v_mfma_f32_16x16x32_bf16 v[60:63], a[28:31], v[92:95], v[60:63]
    s_waitcnt lgkmcnt(4)
    buffer_load_dwordx4 v19, s[64:67], s37 offen offset:1024 lds
    v_mfma_f32_16x16x32_bf16 v[48:51], a[32:35], v[80:83], v[48:51]
    ds_read_b128 v[92:95], v9 offset:27648
    v_mfma_f32_16x16x32_bf16 v[52:55], a[36:39], v[80:83], v[52:55]
    ds_read_b64_tr_b16 v[116:117], v23 offset:0
    v_mfma_f32_16x16x32_bf16 v[56:59], a[40:43], v[80:83], v[56:59]
    ds_read_b64_tr_b16 v[118:119], v23 offset:2048
    v_mfma_f32_16x16x32_bf16 v[60:63], a[44:47], v[80:83], v[60:63]
    s_waitcnt lgkmcnt(6)
    buffer_load_dwordx4 v20, s[64:67], s37 offen offset:2048 lds
    v_mfma_f32_16x16x32_bf16 v[48:51], a[48:51], v[84:87], v[48:51]
    s_waitcnt lgkmcnt(3)
    s_barrier
    ds_read_b128 v[80:83], v28 offset:4096
    v_mfma_f32_16x16x32_bf16 v[52:55], a[52:55], v[84:87], v[52:55]
    ds_read_b64_tr_b16 v[120:121], v24 offset:0
    v_mfma_f32_16x16x32_bf16 v[56:59], a[56:59], v[84:87], v[56:59]
    ds_read_b64_tr_b16 v[122:123], v24 offset:2048
    v_mfma_f32_16x16x32_bf16 v[60:63], a[60:63], v[84:87], v[60:63]
    buffer_load_dwordx4 v21, s[64:67], s37 offen offset:3072 lds
    v_mfma_f32_16x16x32_bf16 v[48:51], a[64:67], v[88:91], v[48:51]
    ds_read_b128 v[84:87], v9 offset:28672
    s_add_u32 m0, s35, 12288
    v_mfma_f32_16x16x32_bf16 v[52:55], a[68:71], v[88:91], v[52:55]
    s_add_u32 s37, s40, 86016
    ds_read_b64_tr_b16 v[124:125], v25 offset:0
    v_mfma_f32_16x16x32_bf16 v[56:59], a[72:75], v[88:91], v[56:59]
    ds_read_b64_tr_b16 v[126:127], v25 offset:2048
    v_mfma_f32_16x16x32_bf16 v[60:63], a[76:79], v[88:91], v[60:63]
    s_waitcnt lgkmcnt(8)
    buffer_load_dwordx4 v18, s[64:67], s37 offen offset:0 lds
    v_mfma_f32_16x16x32_bf16 v[48:51], a[80:83], v[92:95], v[48:51]
    ds_read_b128 v[88:91], v9 offset:29696
    v_mfma_f32_16x16x32_bf16 v[52:55], a[84:87], v[92:95], v[52:55]
    v_mfma_f32_16x16x32_bf16 v[56:59], a[88:91], v[92:95], v[56:59]
    v_mfma_f32_16x16x32_bf16 v[60:63], a[92:95], v[92:95], v[60:63]
    s_waitcnt lgkmcnt(6)
    buffer_load_dwordx4 v19, s[64:67], s37 offen offset:1024 lds
    v_mfma_f32_16x16x32_bf16 v[32:35], v[64:67], v[80:83], v[32:35]
    ds_read_b128 v[92:95], v9 offset:30720
    s_waitcnt vmcnt(10)
    v_mfma_f32_16x16x32_bf16 v[36:39], v[68:71], v[80:83], v[36:39]
    ds_read2st64_b32 v[10:11], v15 offset0:0 offset1:4
    v_mfma_f32_16x16x32_bf16 v[40:43], v[72:75], v[80:83], v[40:43]
    ds_read2st64_b32 v[12:13], v15 offset0:8 offset1:12
    v_mfma_f32_16x16x32_bf16 v[44:47], v[76:79], v[80:83], v[44:47]
    s_waitcnt lgkmcnt(6)
    buffer_load_dwordx4 v20, s[64:67], s37 offen offset:2048 lds
    v_mfma_f32_16x16x32_bf16 v[48:51], a[96:99], v[84:87], v[48:51]
    ds_read_b128 v[80:83], v9 offset:31744
    v_mfma_f32_16x16x32_bf16 v[52:55], a[100:103], v[84:87], v[52:55]
    ds_read2st64_b32 v[252:253], v15 offset0:16 offset1:20
    v_mfma_f32_16x16x32_bf16 v[56:59], a[104:107], v[84:87], v[56:59]
    ds_read2st64_b32 v[254:255], v15 offset0:20 offset1:24
    v_mfma_f32_16x16x32_bf16 v[60:63], a[108:111], v[84:87], v[60:63]
    s_waitcnt lgkmcnt(6)
    buffer_load_dwordx4 v21, s[64:67], s37 offen offset:3072 lds
    v_mfma_f32_16x16x32_bf16 v[48:51], a[112:115], v[88:91], v[48:51]
    s_add_u32 m0, s39, 63488
    ds_read_b128 v[84:87], v9 offset:32768
    s_add_u32 s37, s42, 28672
    v_mfma_f32_16x16x32_bf16 v[52:55], a[116:119], v[88:91], v[52:55]
    v_mfma_f32_16x16x32_bf16 v[56:59], a[120:123], v[88:91], v[56:59]
    v_max_f32 v96, 0, v32
    v_mfma_f32_16x16x32_bf16 v[60:63], a[124:127], v[88:91], v[60:63]
    s_waitcnt lgkmcnt(6)
    buffer_load_dwordx4 v9, s[12:15], s37 offen offset:0 sc1 lds
    v_mfma_f32_16x16x32_bf16 v[48:51], a[128:131], v[92:95], v[48:51]
    ds_read_b128 v[88:91], v9 offset:33792
    v_max_f32 v97, 0, v33
    v_mfma_f32_16x16x32_bf16 v[52:55], a[132:135], v[92:95], v[52:55]
    v_max_f32 v98, 0, v34
    v_max_f32 v99, 0, v35
    v_mfma_f32_16x16x32_bf16 v[56:59], a[136:139], v[92:95], v[56:59]
    v_mul_f32 v96, v96, v40
    v_mfma_f32_16x16x32_bf16 v[60:63], a[140:143], v[92:95], v[60:63]
    s_waitcnt lgkmcnt(4)
    buffer_load_dwordx4 v9, s[12:15], s37 offen offset:1024 sc1 lds
    v_mfma_f32_16x16x32_bf16 v[48:51], a[144:147], v[80:83], v[48:51]
    s_waitcnt vmcnt(10)
    ds_read_b128 v[92:95], v9 offset:34816
    v_max3_u32 v3, v10, v11, v12
    v_mfma_f32_16x16x32_bf16 v[52:55], a[148:151], v[80:83], v[52:55]
    s_waitcnt lgkmcnt(4)
    v_max3_u32 v3, v3, v13, v252
    s_waitcnt lgkmcnt(3)
    v_max3_u32 v3, v3, v253, v254
    v_mfma_f32_16x16x32_bf16 v[56:59], a[152:155], v[80:83], v[56:59]
    v_max_u32 v3, v3, v255
    v_mul_f32 v97, v97, v41
    v_mfma_f32_16x16x32_bf16 v[60:63], a[156:159], v[80:83], v[60:63]
    s_waitcnt lgkmcnt(2)
    buffer_load_dwordx4 v9, s[12:15], s37 offen offset:2048 sc1 lds
    v_mfma_f32_16x16x32_bf16 v[48:51], a[160:163], v[84:87], v[48:51]
    ds_read_b128 v[80:83], v9 offset:35840
    v_mul_f32 v98, v98, v42
    v_mfma_f32_16x16x32_bf16 v[52:55], a[164:167], v[84:87], v[52:55]
    v_cmp_eq_u32 vcc, -1, v3
    s_cbranch_vccnz L_slow_a1_2
L_back_a1_2:
    v_mfma_f32_16x16x32_bf16 v[56:59], a[168:171], v[84:87], v[56:59]
    v_mul_f32 v99, v99, v43
    v_cvt_pk_bf16_f32 v104, v96, v97
    v_mfma_f32_16x16x32_bf16 v[60:63], a[172:175], v[84:87], v[60:63]
    s_waitcnt lgkmcnt(2)
    buffer_load_dwordx4 v9, s[12:15], s37 offen offset:3072 sc1 lds
    v_mfma_f32_16x16x32_bf16 v[48:51], a[176:179], v[88:91], v[48:51]
    s_add_u32 s37, s42, 32768
    ds_read_b128 v[84:87], v28 offset:4352
    s_add_u32 m0, s39, 67584
    v_mfma_f32_16x16x32_bf16 v[52:55], a[180:183], v[88:91], v[52:55]
    v_cvt_pk_bf16_f32 v105, v98, v99
    v_max_f32 v100, 0, v36
    v_mfma_f32_16x16x32_bf16 v[56:59], a[184:187], v[88:91], v[56:59]
    v_max_f32 v101, 0, v37
    v_max_f32 v102, 0, v38
    v_mfma_f32_16x16x32_bf16 v[60:63], a[188:191], v[88:91], v[60:63]
    s_waitcnt lgkmcnt(2)
    buffer_load_dwordx4 v9, s[12:15], s37 offen offset:0 sc1 lds
    v_mfma_f32_16x16x32_bf16 v[48:51], a[192:195], v[92:95], v[48:51]
    s_waitcnt lgkmcnt(1)
    s_barrier
    ds_read_b128 v[88:91], v9 offset:36864
    v_mfma_f32_16x16x32_bf16 v[52:55], a[196:199], v[92:95], v[52:55]
    v_max_f32 v103, 0, v39
    v_mul_f32 v100, v100, v44
    v_mfma_f32_16x16x32_bf16 v[56:59], a[200:203], v[92:95], v[56:59]
    v_mul_f32 v101, v101, v45
    v_mul_f32 v102, v102, v46
    v_mfma_f32_16x16x32_bf16 v[60:63], a[204:207], v[92:95], v[60:63]
    buffer_load_dwordx4 v9, s[12:15], s37 offen offset:1024 sc1 lds
    v_mfma_f32_16x16x32_bf16 v[48:51], a[208:211], v[80:83], v[48:51]
    ds_read_b128 v[92:95], v9 offset:37888
    v_mul_f32 v103, v103, v47
    v_mfma_f32_16x16x32_bf16 v[52:55], a[212:215], v[80:83], v[52:55]
    v_cvt_pk_bf16_f32 v106, v100, v101
    v_cvt_pk_bf16_f32 v107, v102, v103
    v_mfma_f32_16x16x32_bf16 v[56:59], a[216:219], v[80:83], v[56:59]
    ds_read_b64_tr_b16 v[128:129], v22 offset:4096
    v_mfma_f32_16x16x32_bf16 v[60:63], a[220:223], v[80:83], v[60:63]
    s_waitcnt lgkmcnt(3)
    buffer_load_dwordx4 v9, s[12:15], s37 offen offset:2048 sc1 lds
    v_mfma_f32_16x16x32_bf16 v[48:51], v[64:67], v[84:87], v[48:51]
    ds_read_b128 v[80:83], v9 offset:38912
    s_add_u32 m0, s35, 0
    v_mfma_f32_16x16x32_bf16 v[52:55], v[68:71], v[84:87], v[52:55]
    s_add_u32 s37, s40, 114688
    ds_read_b64_tr_b16 v[130:131], v22 offset:6144
    v_mfma_f32_16x16x32_bf16 v[56:59], v[72:75], v[84:87], v[56:59]
    ds_read_b64_tr_b16 v[132:133], v23 offset:4096
    v_mfma_f32_16x16x32_bf16 v[60:63], v[76:79], v[84:87], v[60:63]
    s_waitcnt lgkmcnt(5)
    buffer_load_dwordx4 v18, s[64:67], s37 offen offset:0 lds
    v_mfma_f32_16x16x32_bf16 v[32:35], a[0:3], v[88:91], 0
    ds_read_b128 v[84:87], v9 offset:39936
    v_add_u32 v14, 63488, v15
    v_mfma_f32_16x16x32_bf16 v[36:39], a[4:7], v[88:91], 0
    ds_read_b64_tr_b16 v[134:135], v23 offset:6144
    v_mfma_f32_16x16x32_bf16 v[40:43], a[8:11], v[88:91], 0
    ds_read_b64_tr_b16 v[136:137], v24 offset:4096
    v_mfma_f32_16x16x32_bf16 v[44:47], a[12:15], v[88:91], 0
    s_waitcnt lgkmcnt(7)
    buffer_load_dwordx4 v19, s[64:67], s37 offen offset:1024 lds
    v_mfma_f32_16x16x32_bf16 v[32:35], a[16:19], v[92:95], v[32:35]
    ds_read_b128 v[88:91], v9 offset:40960
    v_mfma_f32_16x16x32_bf16 v[36:39], a[20:23], v[92:95], v[36:39]
    ds_read_b64_tr_b16 v[138:139], v24 offset:6144
    v_mfma_f32_16x16x32_bf16 v[40:43], a[24:27], v[92:95], v[40:43]
    ds_read_b64_tr_b16 v[140:141], v25 offset:4096
    v_max_f32 v96, 0, v48
    v_mfma_f32_16x16x32_bf16 v[44:47], a[28:31], v[92:95], v[44:47]
    s_waitcnt lgkmcnt(8)
    buffer_load_dwordx4 v20, s[64:67], s37 offen offset:2048 lds
    v_mfma_f32_16x16x32_bf16 v[32:35], a[32:35], v[80:83], v[32:35]
    ds_read_b128 v[92:95], v9 offset:41984
    v_max_f32 v97, 0, v49
    v_mfma_f32_16x16x32_bf16 v[36:39], a[36:39], v[80:83], v[36:39]
    ds_read_b64_tr_b16 v[142:143], v25 offset:6144
    v_max_f32 v98, 0, v50
    v_mfma_f32_16x16x32_bf16 v[40:43], a[40:43], v[80:83], v[40:43]
    s_waitcnt vmcnt(14)
    ds_read_b64_tr_b16 v[144:145], v22 offset:8192
    v_max_f32 v99, 0, v51
    v_mfma_f32_16x16x32_bf16 v[44:47], a[44:47], v[80:83], v[44:47]
    s_waitcnt lgkmcnt(8)
    buffer_load_dwordx4 v21, s[64:67], s37 offen offset:3072 lds
    v_mfma_f32_16x16x32_bf16 v[32:35], a[48:51], v[84:87], v[32:35]
    ds_read_b128 v[80:83], v9 offset:43008
    v_mul_f32 v96, v96, v56
    v_mfma_f32_16x16x32_bf16 v[36:39], a[52:55], v[84:87], v[36:39]
    v_mul_f32 v97, v97, v57
    v_mul_f32 v98, v98, v58
    v_mfma_f32_16x16x32_bf16 v[40:43], a[56:59], v[84:87], v[40:43]
    ds_read_b64_tr_b16 v[146:147], v22 offset:10240
    v_mul_f32 v99, v99, v59
    v_mfma_f32_16x16x32_bf16 v[44:47], a[60:63], v[84:87], v[44:47]
    s_waitcnt lgkmcnt(7)
    s_waitcnt lgkmcnt(3)
    s_add_u32 m0, s35, 4096
    v_mfma_f32_16x16x32_bf16 v[32:35], a[64:67], v[88:91], v[32:35]
    s_add_u32 s37, s40, 143360
    ds_read_b128 v[84:87], v9 offset:44032
    s_add_u32 s46, s72, 0
    v_mfma_f32_16x16x32_bf16 v[36:39], a[68:71], v[88:91], v[36:39]
    buffer_load_dwordx4 v18, s[64:67], s37 offen offset:0 lds
    v_mfma_f32_16x16x32_bf16 v[40:43], a[72:75], v[88:91], v[40:43]
    v_cvt_pk_bf16_f32 v108, v96, v97
    v_cvt_pk_bf16_f32 v109, v98, v99
    v_mfma_f32_16x16x32_bf16 v[44:47], a[76:79], v[88:91], v[44:47]
    buffer_load_dwordx4 v19, s[64:67], s37 offen offset:1024 lds
    v_mfma_f32_16x16x32_bf16 v[32:35], a[80:83], v[92:95], v[32:35]
    ds_read_b128 v[88:91], v9 offset:45056
    v_max_f32 v100, 0, v52
    v_mfma_f32_16x16x32_bf16 v[36:39], a[84:87], v[92:95], v[36:39]
    v_max_f32 v101, 0, v53
    v_max_f32 v102, 0, v54
    v_mfma_f32_16x16x32_bf16 v[40:43], a[88:91], v[92:95], v[40:43]
    ds_read_b64_tr_b16 v[148:149], v23 offset:8192
    v_max_f32 v103, 0, v55
    v_mfma_f32_16x16x32_bf16 v[44:47], a[92:95], v[92:95], v[44:47]
    s_waitcnt lgkmcnt(4)
    buffer_load_dwordx4 v20, s[64:67], s37 offen offset:2048 lds
    v_mfma_f32_16x16x32_bf16 v[32:35], a[96:99], v[80:83], v[32:35]
    ds_read_b128 v[92:95], v9 offset:46080
    v_mul_f32 v100, v100, v60
    v_mfma_f32_16x16x32_bf16 v[36:39], a[100:103], v[80:83], v[36:39]
    v_mul_f32 v101, v101, v61
    s_add_u32 s73, s72, 229376
    v_mfma_f32_16x16x32_bf16 v[40:43], a[104:107], v[80:83], v[40:43]
    ds_read_b64_tr_b16 v[150:151], v23 offset:10240
    v_mul_f32 v102, v102, v62
    v_mfma_f32_16x16x32_bf16 v[44:47], a[108:111], v[80:83], v[44:47]
    s_waitcnt lgkmcnt(4)
    buffer_load_dwordx4 v21, s[64:67], s37 offen offset:3072 lds
    v_mfma_f32_16x16x32_bf16 v[32:35], a[112:115], v[84:87], v[32:35]
    ds_read_b128 v[80:83], v9 offset:47104
    v_mul_f32 v103, v103, v63
    v_mfma_f32_16x16x32_bf16 v[36:39], a[116:119], v[84:87], v[36:39]
    buffer_store_dwordx4 v[104:107], v9, s[12:15], s46 offen sc1
    v_mfma_f32_16x16x32_bf16 v[40:43], a[120:123], v[84:87], v[40:43]
    v_cvt_pk_bf16_f32 v110, v100, v101
    v_cvt_pk_bf16_f32 v111, v102, v103
    v_mfma_f32_16x16x32_bf16 v[44:47], a[124:127], v[84:87], v[44:47]
    s_waitcnt lgkmcnt(4)
    buffer_store_dwordx4 v[108:111], v9, s[12:15], s73 offen sc1
    v_mfma_f32_16x16x32_bf16 v[32:35], a[128:131], v[88:91], v[32:35]
    ds_read_b128 v[84:87], v9 offset:48128
    v_mfma_f32_16x16x32_bf16 v[36:39], a[132:135], v[88:91], v[36:39]
    ds_read_b64_tr_b16 v[152:153], v24 offset:8192
    v_mfma_f32_16x16x32_bf16 v[40:43], a[136:139], v[88:91], v[40:43]
    buffer_atomic_add v31, v16, s[12:15], 0 offen sc1
    v_mfma_f32_16x16x32_bf16 v[44:47], a[140:143], v[88:91], v[44:47]
    s_waitcnt lgkmcnt(4)
    ds_read_b64_tr_b16 v[154:155], v24 offset:10240
    v_mfma_f32_16x16x32_bf16 v[32:35], a[144:147], v[92:95], v[32:35]
    ds_read_b128 v[88:91], v9 offset:49152
    v_mfma_f32_16x16x32_bf16 v[36:39], a[148:151], v[92:95], v[36:39]
    ds_read_b64_tr_b16 v[156:157], v25 offset:8192
    v_mfma_f32_16x16x32_bf16 v[40:43], a[152:155], v[92:95], v[40:43]
    ds_read_b64_tr_b16 v[158:159], v25 offset:10240
    v_mfma_f32_16x16x32_bf16 v[44:47], a[156:159], v[92:95], v[44:47]
    s_waitcnt lgkmcnt(6)
    s_waitcnt vmcnt(18)
    v_mfma_f32_16x16x32_bf16 v[32:35], a[160:163], v[80:83], v[32:35]
    ds_read_b128 v[92:95], v9 offset:50176
    v_mfma_f32_16x16x32_bf16 v[36:39], a[164:167], v[80:83], v[36:39]
    ds_read_b64_tr_b16 v[160:161], v22 offset:12288
    v_mfma_f32_16x16x32_bf16 v[40:43], a[168:171], v[80:83], v[40:43]
    ds_read_b64_tr_b16 v[162:163], v22 offset:14336
    v_mfma_f32_16x16x32_bf16 v[44:47], a[172:175], v[80:83], v[44:47]
    s_waitcnt lgkmcnt(8)
    ds_read_b64_tr_b16 v[164:165], v23 offset:12288
    v_mfma_f32_16x16x32_bf16 v[32:35], a[176:179], v[84:87], v[32:35]
    s_waitcnt lgkmcnt(4)
    ds_read_b128 v[80:83], v28 offset:4608
    s_add_u32 m0, s35, 8192
    v_mfma_f32_16x16x32_bf16 v[36:39], a[180:183], v[84:87], v[36:39]
    s_add_u32 s37, s40, 172032
    ds_read_b64_tr_b16 v[166:167], v23 offset:14336
    s_waitcnt vmcnt(11)
    v_mfma_f32_16x16x32_bf16 v[40:43], a[184:187], v[84:87], v[40:43]
    buffer_load_dwordx4 v18, s[64:67], s37 offen offset:0 lds
    v_mfma_f32_16x16x32_bf16 v[44:47], a[188:191], v[84:87], v[44:47]
    ds_read2st64_b32 v[10:11], v14 offset0:0 offset1:4
    v_mfma_f32_16x16x32_bf16 v[32:35], a[192:195], v[88:91], v[32:35]
    ds_read_b128 v[84:87], v26 offset:0
    v_mfma_f32_16x16x32_bf16 v[36:39], a[196:199], v[88:91], v[36:39]
    buffer_load_dwordx4 v19, s[64:67], s37 offen offset:1024 lds
    v_mfma_f32_16x16x32_bf16 v[40:43], a[200:203], v[88:91], v[40:43]
    ds_read2st64_b32 v[12:13], v14 offset0:8 offset1:12
    v_mfma_f32_16x16x32_bf16 v[44:47], a[204:207], v[88:91], v[44:47]
    s_waitcnt lgkmcnt(8)
    buffer_load_dwordx4 v20, s[64:67], s37 offen offset:2048 lds
    v_mfma_f32_16x16x32_bf16 v[32:35], a[208:211], v[92:95], v[32:35]
    ds_read_b128 v[88:91], v26 offset:1024
    v_mfma_f32_16x16x32_bf16 v[36:39], a[212:215], v[92:95], v[36:39]
    ds_read2st64_b32 v[252:253], v14 offset0:16 offset1:20
    v_mfma_f32_16x16x32_bf16 v[40:43], a[216:219], v[92:95], v[40:43]
    ds_read2st64_b32 v[254:255], v14 offset0:20 offset1:24
    v_mfma_f32_16x16x32_bf16 v[44:47], a[220:223], v[92:95], v[44:47]
    s_waitcnt lgkmcnt(7)
    buffer_load_dwordx4 v21, s[64:67], s37 offen offset:3072 lds
    v_mfma_f32_16x16x32_bf16 v[32:35], v[64:67], v[80:83], v[32:35]
    ds_read_b128 v[92:95], v26 offset:2048
    v_mfma_f32_16x16x32_bf16 v[36:39], v[68:71], v[80:83], v[36:39]
    ds_read_b64_tr_b16 v[168:169], v24 offset:12288
    v_mfma_f32_16x16x32_bf16 v[40:43], v[72:75], v[80:83], v[40:43]
    ds_read_b64_tr_b16 v[170:171], v24 offset:14336
    v_mfma_f32_16x16x32_bf16 v[44:47], v[76:79], v[80:83], v[44:47]
    s_waitcnt lgkmcnt(7)
    ds_read_b64_tr_b16 v[172:173], v25 offset:12288
    v_mfma_f32_16x16x32_bf16 v[48:51], a[0:3], v[84:87], 0
    ds_read_b128 v[80:83], v26 offset:3072
    v_mfma_f32_16x16x32_bf16 v[52:55], a[4:7], v[84:87], 0
    ds_read_b64_tr_b16 v[174:175], v25 offset:14336
    v_mfma_f32_16x16x32_bf16 v[56:59], a[8:11], v[84:87], 0
    s_waitcnt vmcnt(11)
    ds_read_b64_tr_b16 v[176:177], v22 offset:0
    v_mfma_f32_16x16x32_bf16 v[60:63], a[12:15], v[84:87], 0
    s_waitcnt lgkmcnt(9)
    v_max3_u32 v3, v10, v11, v12
    s_waitcnt lgkmcnt(8)
    v_max3_u32 v3, v3, v13, v252
    v_mfma_f32_16x16x32_bf16 v[48:51], a[16:19], v[88:91], v[48:51]
    ds_read_b128 v[84:87], v26 offset:4096
    s_waitcnt lgkmcnt(8)
    v_max3_u32 v3, v3, v253, v254
    v_mfma_f32_16x16x32_bf16 v[52:55], a[20:23], v[88:91], v[52:55]
    ds_read_b64_tr_b16 v[178:179], v22 offset:2048
    v_max_u32 v3, v3, v255
    v_mfma_f32_16x16x32_bf16 v[56:59], a[24:27], v[88:91], v[56:59]
    v_cmp_eq_u32 vcc, -1, v3
    s_cbranch_vccnz L_slow_a1_3
L_back_a1_3:
    v_mfma_f32_16x16x32_bf16 v[60:63], a[28:31], v[88:91], v[60:63]
    s_waitcnt lgkmcnt(8)
    s_waitcnt lgkmcnt(3)
    s_add_u32 m0, s35, 12288
    v_mfma_f32_16x16x32_bf16 v[48:51], a[32:35], v[92:95], v[48:51]
    s_add_u32 s37, s40, 200704
    ds_read_b128 v[88:91], v26 offset:5120
    v_max_f32 v96, 0, v32
    v_mfma_f32_16x16x32_bf16 v[52:55], a[36:39], v[92:95], v[52:55]
    buffer_load_dwordx4 v18, s[64:67], s37 offen offset:0 lds
    v_mfma_f32_16x16x32_bf16 v[56:59], a[40:43], v[92:95], v[56:59]
    v_max_f32 v97, 0, v33
    v_max_f32 v98, 0, v34
    v_mfma_f32_16x16x32_bf16 v[60:63], a[44:47], v[92:95], v[60:63]
    buffer_load_dwordx4 v19, s[64:67], s37 offen offset:1024 lds
    v_mfma_f32_16x16x32_bf16 v[48:51], a[48:51], v[80:83], v[48:51]
    ds_read_b128 v[92:95], v26 offset:6144
    v_max_f32 v99, 0, v35
    v_mfma_f32_16x16x32_bf16 v[52:55], a[52:55], v[80:83], v[52:55]
    v_mul_f32 v96, v96, v40
    v_mul_f32 v97, v97, v41
    v_mfma_f32_16x16x32_bf16 v[56:59], a[56:59], v[80:83], v[56:59]
    buffer_load_dwordx4 v20, s[64:67], s37 offen offset:2048 lds
    v_mfma_f32_16x16x32_bf16 v[60:63], a[60:63], v[80:83], v[60:63]
    s_waitcnt lgkmcnt(3)
    ds_read_b64_tr_b16 v[180:181], v23 offset:0
    v_mul_f32 v98, v98, v42
    v_mfma_f32_16x16x32_bf16 v[48:51], a[64:67], v[84:87], v[48:51]
    ds_read_b128 v[80:83], v26 offset:7168
    v_mul_f32 v99, v99, v43
    v_mfma_f32_16x16x32_bf16 v[52:55], a[68:71], v[84:87], v[52:55]
    ds_read_b64_tr_b16 v[182:183], v23 offset:2048
    v_cvt_pk_bf16_f32 v104, v96, v97
    v_mfma_f32_16x16x32_bf16 v[56:59], a[72:75], v[84:87], v[56:59]
    buffer_load_dwordx4 v21, s[64:67], s37 offen offset:3072 lds
    v_mfma_f32_16x16x32_bf16 v[60:63], a[76:79], v[84:87], v[60:63]
    s_waitcnt lgkmcnt(4)
    s_waitcnt vmcnt(9)
    s_add_u32 m0, s38, 0
    v_mfma_f32_16x16x32_bf16 v[48:51], a[80:83], v[88:91], v[48:51]
    s_add_u32 s37, s42, 43008
    ds_read_b128 v[84:87], v26 offset:8192
    v_cvt_pk_bf16_f32 v105, v98, v99
    v_mfma_f32_16x16x32_bf16 v[52:55], a[84:87], v[88:91], v[52:55]
    buffer_atomic_add v31, v29, s[12:15], 0 offen offset:0 sc1
    v_mfma_f32_16x16x32_bf16 v[56:59], a[88:91], v[88:91], v[56:59]
    v_max_f32 v100, 0, v36
    v_max_f32 v101, 0, v37
    v_mfma_f32_16x16x32_bf16 v[60:63], a[92:95], v[88:91], v[60:63]
    s_waitcnt lgkmcnt(4)
    buffer_load_dwordx4 v9, s[12:15], s37 offen offset:0 sc1 lds
    v_mfma_f32_16x16x32_bf16 v[48:51], a[96:99], v[92:95], v[48:51]
    ds_read_b128 v[88:91], v26 offset:9216
    v_max_f32 v102, 0, v38
    v_mfma_f32_16x16x32_bf16 v[52:55], a[100:103], v[92:95], v[52:55]
    v_max_f32 v103, 0, v39
    v_mul_f32 v100, v100, v44
    v_mfma_f32_16x16x32_bf16 v[56:59], a[104:107], v[92:95], v[56:59]
    ds_read_b64_tr_b16 v[184:185], v24 offset:0
    v_mul_f32 v101, v101, v45
    v_mfma_f32_16x16x32_bf16 v[60:63], a[108:111], v[92:95], v[60:63]
    s_waitcnt lgkmcnt(4)
    buffer_load_dwordx4 v9, s[12:15], s37 offen offset:1024 sc1 lds
    v_mfma_f32_16x16x32_bf16 v[48:51], a[112:115], v[80:83], v[48:51]
    ds_read_b128 v[92:95], v26 offset:10240
    v_mul_f32 v102, v102, v46
    v_mfma_f32_16x16x32_bf16 v[52:55], a[116:119], v[80:83], v[52:55]
    ds_read_b64_tr_b16 v[186:187], v24 offset:2048
    v_mul_f32 v103, v103, v47
    v_mfma_f32_16x16x32_bf16 v[56:59], a[120:123], v[80:83], v[56:59]
    ds_read_b64_tr_b16 v[188:189], v25 offset:0
    v_cvt_pk_bf16_f32 v106, v100, v101
    v_mfma_f32_16x16x32_bf16 v[60:63], a[124:127], v[80:83], v[60:63]
    s_waitcnt lgkmcnt(5)
    buffer_load_dwordx4 v9, s[12:15], s37 offen offset:2048 sc1 lds
    v_mfma_f32_16x16x32_bf16 v[48:51], a[128:131], v[84:87], v[48:51]
    ds_read_b128 v[80:83], v26 offset:11264
    v_cvt_pk_bf16_f32 v107, v102, v103
    v_mfma_f32_16x16x32_bf16 v[52:55], a[132:135], v[84:87], v[52:55]
    ds_read_b64_tr_b16 v[190:191], v25 offset:2048
    v_mfma_f32_16x16x32_bf16 v[56:59], a[136:139], v[84:87], v[56:59]
    ds_read_b64_tr_b16 v[192:193], v22 offset:4096
    v_mfma_f32_16x16x32_bf16 v[60:63], a[140:143], v[84:87], v[60:63]
    s_waitcnt lgkmcnt(7)
    buffer_load_dwordx4 v9, s[12:15], s37 offen offset:3072 sc1 lds
    v_mfma_f32_16x16x32_bf16 v[48:51], a[144:147], v[88:91], v[48:51]
    s_add_u32 s37, s42, 47104
    ds_read_b128 v[84:87], v26 offset:12288
    s_add_u32 m0, s38, 4096
    v_mfma_f32_16x16x32_bf16 v[52:55], a[148:151], v[88:91], v[52:55]
    ds_read_b64_tr_b16 v[194:195], v22 offset:6144
    v_mfma_f32_16x16x32_bf16 v[56:59], a[152:155], v[88:91], v[56:59]
    ds_read_b64_tr_b16 v[196:197], v23 offset:4096
    v_mfma_f32_16x16x32_bf16 v[60:63], a[156:159], v[88:91], v[60:63]
    s_waitcnt lgkmcnt(8)
    buffer_load_dwordx4 v9, s[12:15], s37 offen offset:0 sc1 lds
    v_mfma_f32_16x16x32_bf16 v[48:51], a[160:163], v[92:95], v[48:51]
    ds_read_b128 v[88:91], v26 offset:13312
    v_mfma_f32_16x16x32_bf16 v[52:55], a[164:167], v[92:95], v[52:55]
    ds_read_b64_tr_b16 v[198:199], v23 offset:6144
    v_mfma_f32_16x16x32_bf16 v[56:59], a[168:171], v[92:95], v[56:59]
    ds_read_b64_tr_b16 v[200:201], v24 offset:4096
    v_mfma_f32_16x16x32_bf16 v[60:63], a[172:175], v[92:95], v[60:63]
    s_waitcnt lgkmcnt(8)
    buffer_load_dwordx4 v9, s[12:15], s37 offen offset:1024 sc1 lds
    v_mfma_f32_16x16x32_bf16 v[48:51], a[176:179], v[80:83], v[48:51]
    ds_read_b128 v[92:95], v28 offset:4864
    v_mfma_f32_16x16x32_bf16 v[52:55], a[180:183], v[80:83], v[52:55]
    ds_read_b64_tr_b16 v[202:203], v24 offset:6144
    v_mfma_f32_16x16x32_bf16 v[56:59], a[184:187], v[80:83], v[56:59]
    ds_read_b64_tr_b16 v[204:205], v25 offset:4096
    v_mfma_f32_16x16x32_bf16 v[60:63], a[188:191], v[80:83], v[60:63]
    s_waitcnt lgkmcnt(8)
    buffer_load_dwordx4 v9, s[12:15], s37 offen offset:2048 sc1 lds
    v_mfma_f32_16x16x32_bf16 v[48:51], a[192:195], v[84:87], v[48:51]
    s_waitcnt lgkmcnt(5)
    s_barrier
    ds_read_b128 v[80:83], v26 offset:31744
    v_mfma_f32_16x16x32_bf16 v[52:55], a[196:199], v[84:87], v[52:55]
    s_add_u32 m0, s35, 0
    ds_read_b64_tr_b16 v[206:207], v25 offset:6144
    s_add_u32 s37, s40, 229376
    v_mfma_f32_16x16x32_bf16 v[56:59], a[200:203], v[84:87], v[56:59]
    s_waitcnt vmcnt(12)
    ds_read_b64_tr_b16 v[208:209], v22 offset:8192
    v_mfma_f32_16x16x32_bf16 v[60:63], a[204:207], v[84:87], v[60:63]
    buffer_load_dwordx4 v18, s[64:67], s37 offen offset:0 lds
    v_mfma_f32_16x16x32_bf16 v[48:51], a[208:211], v[88:91], v[48:51]
    ds_read_b128 v[84:87], v26 offset:32768
    v_mfma_f32_16x16x32_bf16 v[52:55], a[212:215], v[88:91], v[52:55]
    ds_read_b64_tr_b16 v[210:211], v22 offset:10240
    v_mfma_f32_16x16x32_bf16 v[56:59], a[216:219], v[88:91], v[56:59]
    ds_read_b64_tr_b16 v[212:213], v23 offset:8192
    v_mfma_f32_16x16x32_bf16 v[60:63], a[220:223], v[88:91], v[60:63]
    s_waitcnt lgkmcnt(8)
    buffer_load_dwordx4 v19, s[64:67], s37 offen offset:1024 lds
    v_mfma_f32_16x16x32_bf16 v[48:51], v[64:67], v[92:95], v[48:51]
    ds_read_b128 v[88:91], v26 offset:33792
    v_mfma_f32_16x16x32_bf16 v[52:55], v[68:71], v[92:95], v[52:55]
    ds_read_b64_tr_b16 v[214:215], v23 offset:10240
    v_mfma_f32_16x16x32_bf16 v[56:59], v[72:75], v[92:95], v[56:59]
    ds_read_b64_tr_b16 v[216:217], v24 offset:8192
    v_mfma_f32_16x16x32_bf16 v[60:63], v[76:79], v[92:95], v[60:63]
    s_waitcnt lgkmcnt(8)
    buffer_load_dwordx4 v20, s[64:67], s37 offen offset:2048 lds
    v_mfma_f32_16x16x32_bf16 v[32:35], a[0:3], v[80:83], 0
    ds_read_b128 v[92:95], v26 offset:34816
    v_mfma_f32_16x16x32_bf16 v[36:39], a[4:7], v[80:83], 0
    ds_read_b64_tr_b16 v[218:219], v24 offset:10240
    v_mfma_f32_16x16x32_bf16 v[40:43], a[8:11], v[80:83], 0
    ds_read_b64_tr_b16 v[220:221], v25 offset:8192
    v_mfma_f32_16x16x32_bf16 v[44:47], a[12:15], v[80:83], 0
    s_waitcnt lgkmcnt(8)
    buffer_load_dwordx4 v21, s[64:67], s37 offen offset:3072 lds
    v_mfma_f32_16x16x32_bf16 v[32:35], a[16:19], v[84:87], v[32:35]
    ds_read_b128 v[80:83], v26 offset:35840
    s_add_u32 m0, s35, 4096
    v_mfma_f32_16x16x32_bf16 v[36:39], a[20:23], v[84:87], v[36:39]
    s_add_u32 s37, s40, 258048
    ds_read_b64_tr_b16 v[222:223], v25 offset:10240
    v_mfma_f32_16x16x32_bf16 v[40:43], a[24:27], v[84:87], v[40:43]
    s_waitcnt vmcnt(12)
    ds_read_b64_tr_b16 v[224:225], v22 offset:12288
    v_max_f32 v96, 0, v48
    v_mfma_f32_16x16x32_bf16 v[44:47], a[28:31], v[84:87], v[44:47]
    s_waitcnt lgkmcnt(8)
    buffer_load_dwordx4 v18, s[64:67], s37 offen offset:0 lds
    v_mfma_f32_16x16x32_bf16 v[32:35], a[32:35], v[88:91], v[32:35]
    ds_read_b128 v[84:87], v26 offset:36864
    v_max_f32 v97, 0, v49
    v_mfma_f32_16x16x32_bf16 v[36:39], a[36:39], v[88:91], v[36:39]
    ds_read_b64_tr_b16 v[226:227], v22 offset:14336
    v_max_f32 v98, 0, v50
    v_mfma_f32_16x16x32_bf16 v[40:43], a[40:43], v[88:91], v[40:43]
    ds_read_b64_tr_b16 v[228:229], v23 offset:12288
    v_max_f32 v99, 0, v51
    v_mfma_f32_16x16x32_bf16 v[44:47], a[44:47], v[88:91], v[44:47]
    s_waitcnt lgkmcnt(8)
    buffer_load_dwordx4 v19, s[64:67], s37 offen offset:1024 lds
    v_mfma_f32_16x16x32_bf16 v[32:35], a[48:51], v[92:95], v[32:35]
    ds_read_b128 v[88:91], v26 offset:37888
    v_mul_f32 v96, v96, v56
    v_mfma_f32_16x16x32_bf16 v[36:39], a[52:55], v[92:95], v[36:39]
    v_mul_f32 v97, v97, v57
    v_mul_f32 v98, v98, v58
    v_mfma_f32_16x16x32_bf16 v[40:43], a[56:59], v[92:95], v[40:43]
    ds_read_b64_tr_b16 v[230:231], v23 offset:14336
    v_mul_f32 v99, v99, v59
    v_mfma_f32_16x16x32_bf16 v[44:47], a[60:63], v[92:95], v[44:47]
    s_waitcnt lgkmcnt(7)
    buffer_load_dwordx4 v20, s[64:67], s37 offen offset:2048 lds
    v_mfma_f32_16x16x32_bf16 v[32:35], a[64:67], v[80:83], v[32:35]
    s_add_u32 s46, s72, 57344
    ds_read_b128 v[92:95], v26 offset:38912
    v_cvt_pk_bf16_f32 v108, v96, v97
    v_mfma_f32_16x16x32_bf16 v[36:39], a[68:71], v[80:83], v[36:39]
    ds_read_b64_tr_b16 v[232:233], v24 offset:12288
    v_cvt_pk_bf16_f32 v109, v98, v99
    v_mfma_f32_16x16x32_bf16 v[40:43], a[72:75], v[80:83], v[40:43]
    ds_read_b64_tr_b16 v[234:235], v24 offset:14336
    v_max_f32 v100, 0, v52
    v_mfma_f32_16x16x32_bf16 v[44:47], a[76:79], v[80:83], v[44:47]
    s_waitcnt lgkmcnt(7)
    buffer_load_dwordx4 v21, s[64:67], s37 offen offset:3072 lds
    v_mfma_f32_16x16x32_bf16 v[32:35], a[80:83], v[84:87], v[32:35]
    ds_read_b128 v[80:83], v26 offset:39936
    s_add_u32 m0, s35, 8192
    v_mfma_f32_16x16x32_bf16 v[36:39], a[84:87], v[84:87], v[36:39]
    s_add_u32 s37, s40, 286720
    v_max_f32 v101, 0, v53
    v_max_f32 v102, 0, v54
    v_mfma_f32_16x16x32_bf16 v[40:43], a[88:91], v[84:87], v[40:43]
    ds_read_b64_tr_b16 v[236:237], v25 offset:12288
    v_max_f32 v103, 0, v55
    v_mfma_f32_16x16x32_bf16 v[44:47], a[92:95], v[84:87], v[44:47]
    s_waitcnt lgkmcnt(6)
    buffer_load_dwordx4 v18, s[64:67], s37 offen offset:0 lds
    v_mfma_f32_16x16x32_bf16 v[32:35], a[96:99], v[88:91], v[32:35]
    ds_read_b128 v[84:87], v26 offset:40960
    v_mul_f32 v100, v100, v60
    v_mfma_f32_16x16x32_bf16 v[36:39], a[100:103], v[88:91], v[36:39]
    v_mul_f32 v101, v101, v61
    s_add_u32 s73, s72, 286720
    v_mfma_f32_16x16x32_bf16 v[40:43], a[104:107], v[88:91], v[40:43]
    ds_read_b64_tr_b16 v[238:239], v25 offset:14336
    v_mul_f32 v102, v102, v62
    v_mfma_f32_16x16x32_bf16 v[44:47], a[108:111], v[88:91], v[44:47]
    s_waitcnt lgkmcnt(6)
    buffer_load_dwordx4 v19, s[64:67], s37 offen offset:1024 lds
    v_mfma_f32_16x16x32_bf16 v[32:35], a[112:115], v[92:95], v[32:35]
    ds_read_b128 v[88:91], v26 offset:41984
    v_mul_f32 v103, v103, v63
    v_mfma_f32_16x16x32_bf16 v[36:39], a[116:119], v[92:95], v[36:39]
    buffer_store_dwordx4 v[104:107], v9, s[12:15], s46 offen sc1
    v_mfma_f32_16x16x32_bf16 v[40:43], a[120:123], v[92:95], v[40:43]
    v_cvt_pk_bf16_f32 v110, v100, v101
    v_cvt_pk_bf16_f32 v111, v102, v103
    v_mfma_f32_16x16x32_bf16 v[44:47], a[124:127], v[92:95], v[44:47]
    s_waitcnt lgkmcnt(4)
    buffer_store_dwordx4 v[108:111], v9, s[12:15], s73 offen sc1
    v_mfma_f32_16x16x32_bf16 v[32:35], a[128:131], v[80:83], v[32:35]
    ds_read_b128 v[92:95], v26 offset:43008
    v_mfma_f32_16x16x32_bf16 v[36:39], a[132:135], v[80:83], v[36:39]
    v_mfma_f32_16x16x32_bf16 v[40:43], a[136:139], v[80:83], v[40:43]
    v_mfma_f32_16x16x32_bf16 v[44:47], a[140:143], v[80:83], v[44:47]
    s_waitcnt lgkmcnt(3)
    v_mfma_f32_16x16x32_bf16 v[32:35], a[144:147], v[84:87], v[32:35]
    ds_read_b128 v[80:83], v26 offset:44032
    v_mfma_f32_16x16x32_bf16 v[36:39], a[148:151], v[84:87], v[36:39]
    v_mfma_f32_16x16x32_bf16 v[40:43], a[152:155], v[84:87], v[40:43]
    v_mfma_f32_16x16x32_bf16 v[44:47], a[156:159], v[84:87], v[44:47]
    s_waitcnt lgkmcnt(2)
    buffer_load_dwordx4 v20, s[64:67], s37 offen offset:2048 lds
    v_mfma_f32_16x16x32_bf16 v[32:35], a[160:163], v[88:91], v[32:35]
    ds_read_b128 v[84:87], v26 offset:45056
    v_mfma_f32_16x16x32_bf16 v[36:39], a[164:167], v[88:91], v[36:39]
    v_mfma_f32_16x16x32_bf16 v[40:43], a[168:171], v[88:91], v[40:43]
    v_mfma_f32_16x16x32_bf16 v[44:47], a[172:175], v[88:91], v[44:47]
    s_waitcnt lgkmcnt(2)
    buffer_load_dwordx4 v21, s[64:67], s37 offen offset:3072 lds
    v_mfma_f32_16x16x32_bf16 v[32:35], a[176:179], v[92:95], v[32:35]
    ds_read_b128 v[88:91], v28 offset:5120
    s_add_u32 m0, s35, 12288
    v_mfma_f32_16x16x32_bf16 v[36:39], a[180:183], v[92:95], v[36:39]
    s_add_u32 s37, s40, 315392
    s_waitcnt vmcnt(14)
    s_waitcnt vmcnt(10)
    v_mfma_f32_16x16x32_bf16 v[40:43], a[184:187], v[92:95], v[40:43]
    ds_read2st64_b32 v[10:11], v1 offset0:0 offset1:4
    v_mfma_f32_16x16x32_bf16 v[44:47], a[188:191], v[92:95], v[44:47]
    s_waitcnt lgkmcnt(3)
    buffer_load_dwordx4 v18, s[64:67], s37 offen offset:0 lds
    v_mfma_f32_16x16x32_bf16 v[32:35], a[192:195], v[80:83], v[32:35]
    ds_read_b128 v[92:95], v27 offset:0
    v_mfma_f32_16x16x32_bf16 v[36:39], a[196:199], v[80:83], v[36:39]
    ds_read2st64_b32 v[12:13], v1 offset0:8 offset1:12
    v_mfma_f32_16x16x32_bf16 v[40:43], a[200:203], v[80:83], v[40:43]
    ds_read2st64_b32 v[252:253], v1 offset0:16 offset1:20
    v_mfma_f32_16x16x32_bf16 v[44:47], a[204:207], v[80:83], v[44:47]
    s_waitcnt lgkmcnt(5)
    buffer_load_dwordx4 v19, s[64:67], s37 offen offset:1024 lds
    v_mfma_f32_16x16x32_bf16 v[32:35], a[208:211], v[84:87], v[32:35]
    ds_read_b128 v[80:83], v27 offset:1024
    v_mfma_f32_16x16x32_bf16 v[36:39], a[212:215], v[84:87], v[36:39]
    ds_read2st64_b32 v[254:255], v1 offset0:20 offset1:24
    v_mfma_f32_16x16x32_bf16 v[40:43], a[216:219], v[84:87], v[40:43]
    ds_read_b64_tr_b16 v[240:241], v22 offset:0
    v_mfma_f32_16x16x32_bf16 v[44:47], a[220:223], v[84:87], v[44:47]
    s_waitcnt lgkmcnt(7)
    buffer_load_dwordx4 v20, s[64:67], s37 offen offset:2048 lds
    v_mfma_f32_16x16x32_bf16 v[32:35], v[64:67], v[88:91], v[32:35]
    ds_read_b128 v[84:87], v27 offset:2048
    v_mfma_f32_16x16x32_bf16 v[36:39], v[68:71], v[88:91], v[36:39]
    ds_read_b64_tr_b16 v[242:243], v22 offset:2048
    v_mfma_f32_16x16x32_bf16 v[40:43], v[72:75], v[88:91], v[40:43]
    ds_read_b64_tr_b16 v[244:245], v23 offset:0
    v_mfma_f32_16x16x32_bf16 v[44:47], v[76:79], v[88:91], v[44:47]
    s_waitcnt lgkmcnt(8)
    buffer_load_dwordx4 v21, s[64:67], s37 offen offset:3072 lds
    v_mfma_f32_16x16x32_bf16 v[48:51], a[0:3], v[92:95], 0
    ds_read_b128 v[88:91], v27 offset:3072
    v_mfma_f32_16x16x32_bf16 v[52:55], a[4:7], v[92:95], 0
    ds_read_b64_tr_b16 v[246:247], v23 offset:2048
    v_mfma_f32_16x16x32_bf16 v[56:59], a[8:11], v[92:95], 0
    s_waitcnt lgkmcnt(9)
    v_max3_u32 v3, v10, v11, v12
    s_waitcnt lgkmcnt(8)
    v_max3_u32 v3, v3, v13, v252
    v_mfma_f32_16x16x32_bf16 v[60:63], a[12:15], v[92:95], 0
    s_waitcnt lgkmcnt(7)
    s_waitcnt lgkmcnt(6)
    v_max3_u32 v3, v3, v253, v254
    v_max_u32 v3, v3, v255
    v_mfma_f32_16x16x32_bf16 v[48:51], a[16:19], v[80:83], v[48:51]
    ds_read_b128 v[92:95], v27 offset:4096
    v_mfma_f32_16x16x32_bf16 v[52:55], a[20:23], v[80:83], v[52:55]
    v_cmp_eq_u32 vcc, -1, v3
    s_cbranch_vccnz L_slow_a1_4
L_back_a1_4:
    v_mfma_f32_16x16x32_bf16 v[56:59], a[24:27], v[80:83], v[56:59]
    ds_read_b64_tr_b16 v[248:249], v24 offset:0
    v_max_f32 v96, 0, v32
    v_mfma_f32_16x16x32_bf16 v[60:63], a[28:31], v[80:83], v[60:63]
    s_waitcnt lgkmcnt(6)
    ds_read_b64_tr_b16 v[250:251], v24 offset:2048
    v_mfma_f32_16x16x32_bf16 v[48:51], a[32:35], v[84:87], v[48:51]
    ds_read_b128 v[80:83], v27 offset:5120
    v_max_f32 v97, 0, v33
    v_mfma_f32_16x16x32_bf16 v[52:55], a[36:39], v[84:87], v[52:55]
    ds_read_b64_tr_b16 v[252:253], v25 offset:0
    v_max_f32 v98, 0, v34
    v_mfma_f32_16x16x32_bf16 v[56:59], a[40:43], v[84:87], v[56:59]
    ds_read_b64_tr_b16 v[254:255], v25 offset:2048
    v_max_f32 v99, 0, v35
    v_mfma_f32_16x16x32_bf16 v[60:63], a[44:47], v[84:87], v[60:63]
    s_waitcnt vmcnt(10)
    ds_read_b64_tr_b16 a[224:225], v22 offset:4096
    s_waitcnt lgkmcnt(8)
    v_mfma_f32_16x16x32_bf16 v[48:51], a[48:51], v[88:91], v[48:51]
    ds_read_b128 v[84:87], v27 offset:6144
    v_mov_b32 v0, -1
    v_mfma_f32_16x16x32_bf16 v[52:55], a[52:55], v[88:91], v[52:55]
    buffer_atomic_smax v0, v5, s[12:15], 0 offen offset:0 sc0 sc1
    v_mfma_f32_16x16x32_bf16 v[56:59], a[56:59], v[88:91], v[56:59]
    v_mul_f32 v96, v96, v40
    v_mul_f32 v97, v97, v41
    v_mfma_f32_16x16x32_bf16 v[60:63], a[60:63], v[88:91], v[60:63]
    s_waitcnt lgkmcnt(7)
    ds_read_b64_tr_b16 a[226:227], v22 offset:6144
    v_mul_f32 v98, v98, v42
    v_mfma_f32_16x16x32_bf16 v[48:51], a[64:67], v[92:95], v[48:51]
    s_waitcnt lgkmcnt(3)
    ds_read_b128 v[88:91], v27 offset:7168
    s_add_u32 m0, s35, 0
    v_mfma_f32_16x16x32_bf16 v[52:55], a[68:71], v[92:95], v[52:55]
    s_add_u32 s37, s40, 344064
    v_mul_f32 v99, v99, v43
    v_cvt_pk_bf16_f32 v104, v96, v97
    v_mfma_f32_16x16x32_bf16 v[56:59], a[72:75], v[92:95], v[56:59]
    buffer_load_dwordx4 v18, s[64:67], s37 offen offset:0 lds
    v_mfma_f32_16x16x32_bf16 v[60:63], a[76:79], v[92:95], v[60:63]
    s_waitcnt vmcnt(8)
    v_cvt_pk_bf16_f32 v105, v98, v99
    v_mfma_f32_16x16x32_bf16 v[48:51], a[80:83], v[80:83], v[48:51]
    ds_read_b128 v[92:95], v27 offset:8192
    v_max_f32 v100, 0, v36
    v_mfma_f32_16x16x32_bf16 v[52:55], a[84:87], v[80:83], v[52:55]
    buffer_atomic_add v31, v29, s[12:15], 0 offen offset:128 sc1
    v_mfma_f32_16x16x32_bf16 v[56:59], a[88:91], v[80:83], v[56:59]
    v_max_f32 v101, 0, v37
    v_max_f32 v102, 0, v38
    v_mfma_f32_16x16x32_bf16 v[60:63], a[92:95], v[80:83], v[60:63]
    s_waitcnt lgkmcnt(3)
    buffer_load_dwordx4 v19, s[64:67], s37 offen offset:1024 lds
    v_mfma_f32_16x16x32_bf16 v[48:51], a[96:99], v[84:87], v[48:51]
    ds_read_b128 v[80:83], v27 offset:9216
    v_max_f32 v103, 0, v39
    v_mfma_f32_16x16x32_bf16 v[52:55], a[100:103], v[84:87], v[52:55]
    buffer_load_dwordx4 v20, s[64:67], s37 offen offset:2048 lds
    v_mfma_f32_16x16x32_bf16 v[56:59], a[104:107], v[84:87], v[56:59]
    v_mul_f32 v100, v100, v44
    v_mul_f32 v101, v101, v45
    v_mfma_f32_16x16x32_bf16 v[60:63], a[108:111], v[84:87], v[60:63]
    s_waitcnt lgkmcnt(2)
    ds_read_b64_tr_b16 a[228:229], v23 offset:4096
    v_mul_f32 v102, v102, v46
    v_mfma_f32_16x16x32_bf16 v[48:51], a[112:115], v[88:91], v[48:51]
    ds_read_b128 v[84:87], v27 offset:10240
    v_mfma_f32_16x16x32_bf16 v[52:55], a[116:119], v[88:91], v[52:55]
    buffer_load_dwordx4 v21, s[64:67], s37 offen offset:3072 lds
    v_mfma_f32_16x16x32_bf16 v[56:59], a[120:123], v[88:91], v[56:59]
    v_mul_f32 v103, v103, v47
    v_cvt_pk_bf16_f32 v106, v100, v101
    v_mfma_f32_16x16x32_bf16 v[60:63], a[124:127], v[88:91], v[60:63]
    s_waitcnt lgkmcnt(3)
    ds_read_b64_tr_b16 a[230:231], v23 offset:6144
    v_cvt_pk_bf16_f32 v107, v102, v103
    v_mfma_f32_16x16x32_bf16 v[48:51], a[128:131], v[92:95], v[48:51]
    ds_read_b128 v[88:91], v27 offset:11264
    v_mfma_f32_16x16x32_bf16 v[52:55], a[132:135], v[92:95], v[52:55]
    ds_read_b64_tr_b16 a[232:233], v24 offset:4096
    v_mfma_f32_16x16x32_bf16 v[56:59], a[136:139], v[92:95], v[56:59]
    ds_read_b64_tr_b16 a[234:235], v24 offset:6144
    v_mfma_f32_16x16x32_bf16 v[60:63], a[140:143], v[92:95], v[60:63]
    s_waitcnt lgkmcnt(6)
    ds_read_b64_tr_b16 a[236:237], v25 offset:4096
    v_mfma_f32_16x16x32_bf16 v[48:51], a[144:147], v[80:83], v[48:51]
    ds_read_b128 v[92:95], v27 offset:12288
    v_mfma_f32_16x16x32_bf16 v[52:55], a[148:151], v[80:83], v[52:55]
    ds_read_b64_tr_b16 a[238:239], v25 offset:6144
    v_mfma_f32_16x16x32_bf16 v[56:59], a[152:155], v[80:83], v[56:59]
    s_waitcnt vmcnt(10)
    ds_read_b64_tr_b16 a[240:241], v22 offset:8192
    v_mfma_f32_16x16x32_bf16 v[60:63], a[156:159], v[80:83], v[60:63]
    s_waitcnt lgkmcnt(8)
    ds_read_b64_tr_b16 a[242:243], v22 offset:10240
    v_mfma_f32_16x16x32_bf16 v[48:51], a[160:163], v[84:87], v[48:51]
    ds_read_b128 v[80:83], v27 offset:13312
    v_mfma_f32_16x16x32_bf16 v[52:55], a[164:167], v[84:87], v[52:55]
    ds_read_b64_tr_b16 a[244:245], v23 offset:8192
    v_mfma_f32_16x16x32_bf16 v[56:59], a[168:171], v[84:87], v[56:59]
    ds_read_b64_tr_b16 a[246:247], v23 offset:10240
    v_mfma_f32_16x16x32_bf16 v[60:63], a[172:175], v[84:87], v[60:63]
    s_waitcnt lgkmcnt(10)
    s_waitcnt lgkmcnt(5)
    s_add_u32 m0, s35, 4096
    v_mfma_f32_16x16x32_bf16 v[48:51], a[176:179], v[88:91], v[48:51]
    ds_read_b128 v[84:87], v28 offset:5376
    s_add_u32 s37, s40, 372736
    v_mfma_f32_16x16x32_bf16 v[52:55], a[180:183], v[88:91], v[52:55]
    buffer_load_dwordx4 v18, s[64:67], s37 offen offset:0 lds
    v_mfma_f32_16x16x32_bf16 v[56:59], a[184:187], v[88:91], v[56:59]
    ds_read_b64_tr_b16 a[248:249], v24 offset:8192
    v_mfma_f32_16x16x32_bf16 v[60:63], a[188:191], v[88:91], v[60:63]
    buffer_load_dwordx4 v19, s[64:67], s37 offen offset:1024 lds
    v_mfma_f32_16x16x32_bf16 v[48:51], a[192:195], v[92:95], v[48:51]
    s_waitcnt lgkmcnt(4)
    s_barrier
    ds_read_b128 v[88:91], v9 offset:8192
    v_mfma_f32_16x16x32_bf16 v[52:55], a[196:199], v[92:95], v[52:55]
    s_waitcnt vmcnt(7)
    ds_read_b64_tr_b16 a[250:251], v24 offset:10240
    v_readfirstlane_b32 s77, v0
    v_mfma_f32_16x16x32_bf16 v[56:59], a[200:203], v[92:95], v[56:59]
    s_cmp_lt_i32 s77, 13
    s_cbranch_scc1 L_slow_a
L_back_a:
    v_mfma_f32_16x16x32_bf16 v[60:63], a[204:207], v[92:95], v[60:63]
    buffer_load_dwordx4 v20, s[64:67], s37 offen offset:2048 lds
    v_mfma_f32_16x16x32_bf16 v[48:51], a[208:211], v[80:83], v[48:51]
    ds_read_b128 v[92:95], v9 offset:9216
    v_mfma_f32_16x16x32_bf16 v[52:55], a[212:215], v[80:83], v[52:55]
    ds_read_b64_tr_b16 a[252:253], v25 offset:8192
    v_mfma_f32_16x16x32_bf16 v[56:59], a[216:219], v[80:83], v[56:59]
    buffer_load_dwordx4 v21, s[64:67], s37 offen offset:3072 lds
    v_mfma_f32_16x16x32_bf16 v[60:63], a[220:223], v[80:83], v[60:63]
    s_waitcnt lgkmcnt(5)
    s_add_u32 m0, s39, 0
    s_add_u32 s37, s74, 0
    v_mfma_f32_16x16x32_bf16 v[48:51], v[64:67], v[84:87], v[48:51]
    ds_read_b128 v[80:83], v9 offset:10240
    v_mfma_f32_16x16x32_bf16 v[52:55], v[68:71], v[84:87], v[52:55]
    ds_read_b64_tr_b16 a[254:255], v25 offset:10240
    v_mfma_f32_16x16x32_bf16 v[56:59], v[72:75], v[84:87], v[56:59]
    buffer_load_dwordx4 v9, s[12:15], s37 offen offset:0 sc1 lds
    v_mfma_f32_16x16x32_bf16 v[60:63], v[76:79], v[84:87], v[60:63]
    s_waitcnt lgkmcnt(5)
    v_mfma_f32_16x16x32_bf16 v[32:35], a[0:3], v[88:91], 0
    ds_read_b128 v[84:87], v9 offset:11264
    v_mfma_f32_16x16x32_bf16 v[36:39], a[4:7], v[88:91], 0
    v_mfma_f32_16x16x32_bf16 v[40:43], a[8:11], v[88:91], 0
    buffer_load_dwordx4 v9, s[12:15], s37 offen offset:1024 sc1 lds
    v_mfma_f32_16x16x32_bf16 v[44:47], a[12:15], v[88:91], 0
    s_waitcnt lgkmcnt(4)
    v_mfma_f32_16x16x32_bf16 v[32:35], a[16:19], v[92:95], v[32:35]
    ds_read_b128 v[88:91], v9 offset:12288
    v_mfma_f32_16x16x32_bf16 v[36:39], a[20:23], v[92:95], v[36:39]
    v_mfma_f32_16x16x32_bf16 v[40:43], a[24:27], v[92:95], v[40:43]
    buffer_load_dwordx4 v9, s[12:15], s37 offen offset:2048 sc1 lds
    v_mfma_f32_16x16x32_bf16 v[44:47], a[28:31], v[92:95], v[44:47]
    s_waitcnt lgkmcnt(3)
    v_max_f32 v96, 0, v48
    v_mfma_f32_16x16x32_bf16 v[32:35], a[32:35], v[80:83], v[32:35]
    ds_read_b128 v[92:95], v9 offset:13312
    v_max_f32 v97, 0, v49
    v_mfma_f32_16x16x32_bf16 v[36:39], a[36:39], v[80:83], v[36:39]
    v_max_f32 v98, 0, v50
    v_mfma_f32_16x16x32_bf16 v[40:43], a[40:43], v[80:83], v[40:43]
    buffer_load_dwordx4 v9, s[12:15], s37 offen offset:3072 sc1 lds
    v_mfma_f32_16x16x32_bf16 v[44:47], a[44:47], v[80:83], v[44:47]
    s_waitcnt lgkmcnt(2)
    s_add_u32 m0, s39, 4096
    s_add_u32 s37, s74, 4096
    v_mfma_f32_16x16x32_bf16 v[32:35], a[48:51], v[84:87], v[32:35]
    ds_read_b128 v[80:83], v9 offset:14336
    v_max_f32 v99, 0, v51
    v_mfma_f32_16x16x32_bf16 v[36:39], a[52:55], v[84:87], v[36:39]
    v_mul_f32 v96, v96, v56
    v_mul_f32 v97, v97, v57
    v_mfma_f32_16x16x32_bf16 v[40:43], a[56:59], v[84:87], v[40:43]
    buffer_load_dwordx4 v9, s[12:15], s37 offen offset:0 sc1 lds
    v_mfma_f32_16x16x32_bf16 v[44:47], a[60:63], v[84:87], v[44:47]
    s_waitcnt lgkmcnt(2)
    v_mul_f32 v98, v98, v58
    v_mul_f32 v99, v99, v59
    v_mfma_f32_16x16x32_bf16 v[32:35], a[64:67], v[88:91], v[32:35]
    s_add_u32 s46, s72, 114688
    ds_read_b128 v[84:87], v9 offset:15360
    v_cvt_pk_bf16_f32 v108, v96, v97
    v_mfma_f32_16x16x32_bf16 v[36:39], a[68:71], v[88:91], v[36:39]
    v_cvt_pk_bf16_f32 v109, v98, v99
    v_mfma_f32_16x16x32_bf16 v[40:43], a[72:75], v[88:91], v[40:43]
    buffer_load_dwordx4 v9, s[12:15], s37 offen offset:1024 sc1 lds
    v_mfma_f32_16x16x32_bf16 v[44:47], a[76:79], v[88:91], v[44:47]
    s_waitcnt lgkmcnt(2)
    v_max_f32 v100, 0, v52
    v_max_f32 v101, 0, v53
    v_mfma_f32_16x16x32_bf16 v[32:35], a[80:83], v[92:95], v[32:35]
    ds_read_b128 v[88:91], v9 offset:16384
    v_mfma_f32_16x16x32_bf16 v[36:39], a[84:87], v[92:95], v[36:39]
    v_max_f32 v102, 0, v54
    v_mfma_f32_16x16x32_bf16 v[40:43], a[88:91], v[92:95], v[40:43]
    buffer_load_dwordx4 v9, s[12:15], s37 offen offset:2048 sc1 lds
    v_mfma_f32_16x16x32_bf16 v[44:47], a[92:95], v[92:95], v[44:47]
    s_waitcnt lgkmcnt(2)
    s_add_u32 m0, s39, 63488
    s_add_u32 s37, s74, 7168
    v_mfma_f32_16x16x32_bf16 v[32:35], a[96:99], v[80:83], v[32:35]
    ds_read_b128 v[92:95], v9 offset:17408
    v_mov_b32 v0, -1
    v_mfma_f32_16x16x32_bf16 v[36:39], a[100:103], v[80:83], v[36:39]
    buffer_atomic_smax v0, v5, s[12:15], 0 offen offset:128 sc0 sc1
    v_mfma_f32_16x16x32_bf16 v[40:43], a[104:107], v[80:83], v[40:43]
    v_max_f32 v103, 0, v55
    v_mul_f32 v100, v100, v60
    v_mfma_f32_16x16x32_bf16 v[44:47], a[108:111], v[80:83], v[44:47]
    s_waitcnt lgkmcnt(2)
    buffer_load_dwordx4 v9, s[12:15], s37 offen offset:0 sc1 lds
    v_mfma_f32_16x16x32_bf16 v[32:35], a[112:115], v[84:87], v[32:35]
    ds_read_b128 v[80:83], v9 offset:18432
    v_mul_f32 v101, v101, v61
    v_mfma_f32_16x16x32_bf16 v[36:39], a[116:119], v[84:87], v[36:39]
    s_add_u32 s73, s72, 344064
    v_mul_f32 v102, v102, v62
    v_mul_f32 v103, v103, v63
    v_mfma_f32_16x16x32_bf16 v[40:43], a[120:123], v[84:87], v[40:43]
    buffer_store_dwordx4 v[104:107], v9, s[12:15], s46 offen sc1
    v_mfma_f32_16x16x32_bf16 v[44:47], a[124:127], v[84:87], v[44:47]
    s_waitcnt lgkmcnt(2)
    v_cvt_pk_bf16_f32 v110, v100, v101
    v_cvt_pk_bf16_f32 v111, v102, v103
    v_mfma_f32_16x16x32_bf16 v[32:35], a[128:131], v[88:91], v[32:35]
    ds_read_b128 v[84:87], v9 offset:19456
    v_mfma_f32_16x16x32_bf16 v[36:39], a[132:135], v[88:91], v[36:39]
    buffer_store_dwordx4 v[108:111], v9, s[12:15], s73 offen sc1
    v_mfma_f32_16x16x32_bf16 v[40:43], a[136:139], v[88:91], v[40:43]
    v_mfma_f32_16x16x32_bf16 v[44:47], a[140:143], v[88:91], v[44:47]
    s_waitcnt lgkmcnt(2)
    v_mfma_f32_16x16x32_bf16 v[32:35], a[144:147], v[92:95], v[32:35]
    ds_read_b128 v[88:91], v9 offset:20480
    v_mfma_f32_16x16x32_bf16 v[36:39], a[148:151], v[92:95], v[36:39]
    v_mfma_f32_16x16x32_bf16 v[40:43], a[152:155], v[92:95], v[40:43]
    v_mfma_f32_16x16x32_bf16 v[44:47], a[156:159], v[92:95], v[44:47]
    s_waitcnt lgkmcnt(2)
    buffer_load_dwordx4 v9, s[12:15], s37 offen offset:1024 sc1 lds
    v_mfma_f32_16x16x32_bf16 v[32:35], a[160:163], v[80:83], v[32:35]
    ds_read_b128 v[92:95], v9 offset:21504
    v_and_b32 v14, -16, v14
    v_mfma_f32_16x16x32_bf16 v[36:39], a[164:167], v[80:83], v[36:39]
    v_and_b32 v15, -16, v15
    v_mfma_f32_16x16x32_bf16 v[40:43], a[168:171], v[80:83], v[40:43]
    v_mfma_f32_16x16x32_bf16 v[44:47], a[172:175], v[80:83], v[44:47]
    s_waitcnt lgkmcnt(2)
    buffer_load_dwordx4 v9, s[12:15], s37 offen offset:2048 sc1 lds
    v_mfma_f32_16x16x32_bf16 v[32:35], a[176:179], v[84:87], v[32:35]
    ds_read_b128 v[80:83], v28 offset:5632
    v_mfma_f32_16x16x32_bf16 v[36:39], a[180:183], v[84:87], v[36:39]
    v_mfma_f32_16x16x32_bf16 v[40:43], a[184:187], v[84:87], v[40:43]
    v_mfma_f32_16x16x32_bf16 v[44:47], a[188:191], v[84:87], v[44:47]
    s_waitcnt lgkmcnt(2)
    buffer_load_dwordx4 v9, s[12:15], s37 offen offset:3072 sc1 lds
    v_mfma_f32_16x16x32_bf16 v[32:35], a[192:195], v[88:91], v[32:35]
    s_add_u32 m0, s39, 67584
    ds_read_b128 v[84:87], v9 offset:22528
    s_add_u32 s37, s74, 11264
    v_mfma_f32_16x16x32_bf16 v[36:39], a[196:199], v[88:91], v[36:39]
    v_mfma_f32_16x16x32_bf16 v[40:43], a[200:203], v[88:91], v[40:43]
    v_mfma_f32_16x16x32_bf16 v[44:47], a[204:207], v[88:91], v[44:47]
    s_waitcnt lgkmcnt(2)
    buffer_load_dwordx4 v9, s[12:15], s37 offen offset:0 sc1 lds
    v_mfma_f32_16x16x32_bf16 v[32:35], a[208:211], v[92:95], v[32:35]
    ds_read_b128 v[88:91], v9 offset:23552
    v_mfma_f32_16x16x32_bf16 v[36:39], a[212:215], v[92:95], v[36:39]
    v_mfma_f32_16x16x32_bf16 v[40:43], a[216:219], v[92:95], v[40:43]
    v_mfma_f32_16x16x32_bf16 v[44:47], a[220:223], v[92:95], v[44:47]
    s_waitcnt lgkmcnt(2)
    buffer_load_dwordx4 v9, s[12:15], s37 offen offset:1024 sc1 lds
    v_mfma_f32_16x16x32_bf16 v[32:35], v[64:67], v[80:83], v[32:35]
    ds_read_b128 v[92:95], v9 offset:24576
    v_mfma_f32_16x16x32_bf16 v[36:39], v[68:71], v[80:83], v[36:39]
    v_mfma_f32_16x16x32_bf16 v[40:43], v[72:75], v[80:83], v[40:43]
    v_mfma_f32_16x16x32_bf16 v[44:47], v[76:79], v[80:83], v[44:47]
    s_waitcnt lgkmcnt(2)
    buffer_load_dwordx4 v9, s[12:15], s37 offen offset:2048 sc1 lds
    v_mfma_f32_16x16x32_bf16 v[48:51], a[0:3], v[84:87], 0
    ds_read_b128 v[80:83], v9 offset:25600
    v_mfma_f32_16x16x32_bf16 v[52:55], a[4:7], v[84:87], 0
    ds_read_b64_tr_b16 a[0:1], v22 offset:12288
    v_mfma_f32_16x16x32_bf16 v[56:59], a[8:11], v[84:87], 0
    ds_read_b64_tr_b16 a[2:3], v22 offset:14336
    v_mfma_f32_16x16x32_bf16 v[60:63], a[12:15], v[84:87], 0
    s_waitcnt lgkmcnt(4)
    ds_read_b64_tr_b16 a[4:5], v23 offset:12288
    v_mfma_f32_16x16x32_bf16 v[48:51], a[16:19], v[88:91], v[48:51]
    ds_read_b128 v[84:87], v9 offset:26624
    v_mfma_f32_16x16x32_bf16 v[52:55], a[20:23], v[88:91], v[52:55]
    ds_read_b64_tr_b16 a[6:7], v23 offset:14336
    v_mfma_f32_16x16x32_bf16 v[56:59], a[24:27], v[88:91], v[56:59]
    ds_read_b64_tr_b16 a[8:9], v24 offset:12288
    v_max_f32 v96, 0, v32
    v_mfma_f32_16x16x32_bf16 v[60:63], a[28:31], v[88:91], v[60:63]
    s_waitcnt lgkmcnt(7)
    ds_read_b64_tr_b16 a[10:11], v24 offset:14336
    v_mfma_f32_16x16x32_bf16 v[48:51], a[32:35], v[92:95], v[48:51]
    ds_read_b128 v[88:91], v9 offset:27648
    v_max_f32 v97, 0, v33
    v_mfma_f32_16x16x32_bf16 v[52:55], a[36:39], v[92:95], v[52:55]
    ds_read_b64_tr_b16 a[12:13], v25 offset:12288
    v_max_f32 v98, 0, v34
    v_mfma_f32_16x16x32_bf16 v[56:59], a[40:43], v[92:95], v[56:59]
    ds_read_b64_tr_b16 a[14:15], v25 offset:14336
    v_max_f32 v99, 0, v35
    v_mfma_f32_16x16x32_bf16 v[60:63], a[44:47], v[92:95], v[60:63]
    s_waitcnt lgkmcnt(10)
    v_mul_f32 v96, v96, v40
    s_waitcnt vmcnt(21)
    v_mfma_f32_16x16x32_bf16 v[48:51], a[48:51], v[80:83], v[48:51]
    ds_read_b128 v[92:95], v9 offset:28672
    v_mul_f32 v97, v97, v41
    v_mfma_f32_16x16x32_bf16 v[52:55], a[52:55], v[80:83], v[52:55]
    ds_read_b64_tr_b16 a[16:17], v22 offset:0
    v_mfma_f32_16x16x32_bf16 v[56:59], a[56:59], v[80:83], v[56:59]
    ds_read_b64_tr_b16 a[18:19], v22 offset:2048
    v_mul_f32 v98, v98, v42
    v_mfma_f32_16x16x32_bf16 v[60:63], a[60:63], v[80:83], v[60:63]
    s_waitcnt lgkmcnt(9)
    ds_read_b64_tr_b16 a[20:21], v23 offset:0
    v_mul_f32 v99, v99, v43
    v_mfma_f32_16x16x32_bf16 v[48:51], a[64:67], v[84:87], v[48:51]
    ds_read_b128 v[80:83], v9 offset:29696
    v_cvt_pk_bf16_f32 v104, v96, v97
    v_mfma_f32_16x16x32_bf16 v[52:55], a[68:71], v[84:87], v[52:55]
    ds_read_b64_tr_b16 a[22:23], v23 offset:2048
    v_cvt_pk_bf16_f32 v105, v98, v99
    v_mfma_f32_16x16x32_bf16 v[56:59], a[72:75], v[84:87], v[56:59]
    s_waitcnt vmcnt(9)
    v_readfirstlane_b32 s77, v0
    v_max_f32 v100, 0, v36
    v_mfma_f32_16x16x32_bf16 v[60:63], a[76:79], v[84:87], v[60:63]
    s_waitcnt lgkmcnt(8)
    s_cmp_lt_i32 s77, 29
    s_cbranch_scc1 L_slow_b
L_back_b:
    v_mfma_f32_16x16x32_bf16 v[48:51], a[80:83], v[88:91], v[48:51]
    ds_read_b128 v[84:87], v9 offset:30720
    v_max_f32 v101, 0, v37
    v_mfma_f32_16x16x32_bf16 v[52:55], a[84:87], v[88:91], v[52:55]
    buffer_load_dwordx4 a[48:51], v9, s[12:15], s75 offen offset:0 sc1
    v_mfma_f32_16x16x32_bf16 v[56:59], a[88:91], v[88:91], v[56:59]
    v_max_f32 v102, 0, v38
    v_max_f32 v103, 0, v39
    v_mfma_f32_16x16x32_bf16 v[60:63], a[92:95], v[88:91], v[60:63]
    s_waitcnt lgkmcnt(6)
    s_waitcnt vmcnt(7)
    v_mul_f32 v100, v100, v44
    v_mfma_f32_16x16x32_bf16 v[48:51], a[96:99], v[92:95], v[48:51]
    ds_read_b128 v[88:91], v9 offset:31744
    v_mul_f32 v101, v101, v45
    v_mfma_f32_16x16x32_bf16 v[52:55], a[100:103], v[92:95], v[52:55]
    buffer_atomic_add v31, v29, s[12:15], 0 offen offset:256 sc1
    v_mfma_f32_16x16x32_bf16 v[56:59], a[104:107], v[92:95], v[56:59]
    s_add_u32 s73, s72, 172032
    ds_read_b64_tr_b16 a[24:25], v24 offset:0
    v_mfma_f32_16x16x32_bf16 v[60:63], a[108:111], v[92:95], v[60:63]
    s_waitcnt lgkmcnt(4)
    buffer_load_dwordx4 a[52:55], v9, s[12:15], s75 offen offset:1024 sc1
    v_mfma_f32_16x16x32_bf16 v[48:51], a[112:115], v[80:83], v[48:51]
    ds_read_b128 v[92:95], v9 offset:32768
    v_mul_f32 v102, v102, v46
    v_mfma_f32_16x16x32_bf16 v[52:55], a[116:119], v[80:83], v[52:55]
    buffer_load_dwordx4 a[56:59], v9, s[12:15], s75 offen offset:2048 sc1
    v_mfma_f32_16x16x32_bf16 v[56:59], a[120:123], v[80:83], v[56:59]
    v_mul_f32 v103, v103, v47
    v_cvt_pk_bf16_f32 v106, v100, v101
    v_mfma_f32_16x16x32_bf16 v[60:63], a[124:127], v[80:83], v[60:63]
    s_waitcnt lgkmcnt(3)
    ds_read_b64_tr_b16 a[26:27], v24 offset:2048
    v_cvt_pk_bf16_f32 v107, v102, v103
    v_mfma_f32_16x16x32_bf16 v[48:51], a[128:131], v[84:87], v[48:51]
    ds_read_b128 v[80:83], v9 offset:33792
    v_mfma_f32_16x16x32_bf16 v[52:55], a[132:135], v[84:87], v[52:55]
    buffer_store_dwordx4 v[104:107], v9, s[12:15], s73 offen sc1
    v_mfma_f32_16x16x32_bf16 v[56:59], a[136:139], v[84:87], v[56:59]
    ds_read_b64_tr_b16 a[28:29], v25 offset:0
    v_mfma_f32_16x16x32_bf16 v[60:63], a[140:143], v[84:87], v[60:63]
    s_waitcnt lgkmcnt(5)
    ds_read_b64_tr_b16 a[30:31], v25 offset:2048
    v_mfma_f32_16x16x32_bf16 v[48:51], a[144:147], v[88:91], v[48:51]
    ds_read_b128 v[84:87], v9 offset:34816
    v_mfma_f32_16x16x32_bf16 v[52:55], a[148:151], v[88:91], v[52:55]
    buffer_load_dwordx4 a[60:63], v9, s[12:15], s75 offen offset:3072 sc1
    v_mfma_f32_16x16x32_bf16 v[56:59], a[152:155], v[88:91], v[56:59]
    s_add_u32 s75, s74, 61440
    ds_read_b64_tr_b16 a[32:33], v22 offset:4096
    v_mfma_f32_16x16x32_bf16 v[60:63], a[156:159], v[88:91], v[60:63]
    s_waitcnt lgkmcnt(6)
    ds_read_b64_tr_b16 a[34:35], v22 offset:6144
    v_mfma_f32_16x16x32_bf16 v[48:51], a[160:163], v[92:95], v[48:51]
    ds_read_b128 v[88:91], v9 offset:35840
    v_mfma_f32_16x16x32_bf16 v[52:55], a[164:167], v[92:95], v[52:55]
    buffer_load_dwordx4 a[64:67], v9, s[12:15], s75 offen offset:0 sc1
    v_mfma_f32_16x16x32_bf16 v[56:59], a[168:171], v[92:95], v[56:59]
    ds_read_b64_tr_b16 a[36:37], v23 offset:4096
    v_mfma_f32_16x16x32_bf16 v[60:63], a[172:175], v[92:95], v[60:63]
    s_waitcnt lgkmcnt(7)
    ds_read_b64_tr_b16 a[38:39], v23 offset:6144
    v_mfma_f32_16x16x32_bf16 v[48:51], a[176:179], v[80:83], v[48:51]
    ds_read_b128 v[92:95], v28 offset:5888
    v_mfma_f32_16x16x32_bf16 v[52:55], a[180:183], v[80:83], v[52:55]
    buffer_load_dwordx4 a[68:71], v9, s[12:15], s75 offen offset:1024 sc1
    v_mfma_f32_16x16x32_bf16 v[56:59], a[184:187], v[80:83], v[56:59]
    ds_read_b64_tr_b16 a[40:41], v24 offset:4096
    v_mfma_f32_16x16x32_bf16 v[60:63], a[188:191], v[80:83], v[60:63]
    s_waitcnt lgkmcnt(7)
    ds_read_b64_tr_b16 a[42:43], v24 offset:6144
    v_mfma_f32_16x16x32_bf16 v[48:51], a[192:195], v[84:87], v[48:51]
    ds_read_b128 v[80:83], v15 offset:0
    v_mfma_f32_16x16x32_bf16 v[52:55], a[196:199], v[84:87], v[52:55]
    buffer_load_dwordx4 a[72:75], v9, s[12:15], s75 offen offset:2048 sc1
    v_mfma_f32_16x16x32_bf16 v[56:59], a[200:203], v[84:87], v[56:59]
    ds_read_b64_tr_b16 a[44:45], v25 offset:4096
    v_mfma_f32_16x16x32_bf16 v[60:63], a[204:207], v[84:87], v[60:63]
    s_waitcnt lgkmcnt(7)
    ds_read_b64_tr_b16 a[46:47], v25 offset:6144
    v_mfma_f32_16x16x32_bf16 v[48:51], a[208:211], v[88:91], v[48:51]
    ds_read_b128 v[84:87], v15 offset:1024
    v_mfma_f32_16x16x32_bf16 v[52:55], a[212:215], v[88:91], v[52:55]
    buffer_load_dwordx4 a[76:79], v9, s[12:15], s75 offen offset:3072 sc1
    v_mfma_f32_16x16x32_bf16 v[56:59], a[216:219], v[88:91], v[56:59]
    s_add_u32 s75, s74, 65536
    v_mfma_f32_16x16x32_bf16 v[60:63], a[220:223], v[88:91], v[60:63]
    s_waitcnt lgkmcnt(6)
    v_mfma_f32_16x16x32_bf16 v[48:51], v[64:67], v[92:95], v[48:51]
    ds_read_b128 v[88:91], v15 offset:2048
    v_mfma_f32_16x16x32_bf16 v[52:55], v[68:71], v[92:95], v[52:55]
    buffer_load_dwordx4 a[80:83], v9, s[12:15], s75 offen offset:0 sc1
    v_mfma_f32_16x16x32_bf16 v[56:59], v[72:75], v[92:95], v[56:59]
    v_mfma_f32_16x16x32_bf16 v[60:63], v[76:79], v[92:95], v[60:63]
    s_waitcnt lgkmcnt(4)
    v_mfma_f32_16x16x32_bf16 v[64:67], v[112:115], v[80:83], 0
    ds_read_b128 v[92:95], v15 offset:3072
    v_mfma_f32_16x16x32_bf16 v[68:71], v[116:119], v[80:83], 0
    buffer_load_dwordx4 a[84:87], v9, s[12:15], s75 offen offset:1024 sc1
    v_mfma_f32_16x16x32_bf16 v[72:75], v[120:123], v[80:83], 0
    v_mfma_f32_16x16x32_bf16 v[76:79], v[124:127], v[80:83], 0
    s_waitcnt lgkmcnt(2)
    v_max_f32 v96, 0, v48
    v_mfma_f32_16x16x32_bf16 v[64:67], v[128:131], v[84:87], v[64:67]
    ds_read_b128 v[80:83], v15 offset:4096
    v_max_f32 v97, 0, v49
    v_mfma_f32_16x16x32_bf16 v[68:71], v[132:135], v[84:87], v[68:71]
    buffer_load_dwordx4 a[88:91], v9, s[12:15], s75 offen offset:2048 sc1
    v_mfma_f32_16x16x32_bf16 v[72:75], v[136:139], v[84:87], v[72:75]
    v_max_f32 v98, 0, v50
    v_max_f32 v99, 0, v51
    v_mfma_f32_16x16x32_bf16 v[76:79], v[140:143], v[84:87], v[76:79]
    s_waitcnt lgkmcnt(2)
    v_mul_f32 v96, v96, v56
    v_mul_f32 v97, v97, v57
    v_mfma_f32_16x16x32_bf16 v[64:67], v[144:147], v[88:91], v[64:67]
    ds_read_b128 v[84:87], v15 offset:5120
    v_mul_f32 v98, v98, v58
    v_mfma_f32_16x16x32_bf16 v[68:71], v[148:151], v[88:91], v[68:71]
    buffer_load_dwordx4 a[92:95], v9, s[12:15], s75 offen offset:3072 sc1
    v_mfma_f32_16x16x32_bf16 v[72:75], v[152:155], v[88:91], v[72:75]
    s_add_u32 s75, s74, 69632
    v_mul_f32 v99, v99, v59
    v_cvt_pk_bf16_f32 v108, v96, v97
    v_mfma_f32_16x16x32_bf16 v[76:79], v[156:159], v[88:91], v[76:79]
    s_waitcnt lgkmcnt(2)
    v_cvt_pk_bf16_f32 v109, v98, v99
    v_max_f32 v100, 0, v52
    v_mfma_f32_16x16x32_bf16 v[64:67], v[160:163], v[92:95], v[64:67]
    ds_read_b128 v[88:91], v15 offset:6144
    v_max_f32 v101, 0, v53
    v_mfma_f32_16x16x32_bf16 v[68:71], v[164:167], v[92:95], v[68:71]
    buffer_load_dwordx4 a[96:99], v9, s[12:15], s75 offen offset:0 sc1
    v_mfma_f32_16x16x32_bf16 v[72:75], v[168:171], v[92:95], v[72:75]
    v_max_f32 v102, 0, v54
    v_max_f32 v103, 0, v55
    v_mfma_f32_16x16x32_bf16 v[76:79], v[172:175], v[92:95], v[76:79]
    s_waitcnt lgkmcnt(2)
    v_mul_f32 v100, v100, v60
    v_mul_f32 v101, v101, v61
    v_mfma_f32_16x16x32_bf16 v[64:67], v[176:179], v[80:83], v[64:67]
    s_add_u32 s73, s72, 401408
    ds_read_b128 v[92:95], v14 offset:0
    v_mul_f32 v102, v102, v62
    v_mfma_f32_16x16x32_bf16 v[68:71], v[180:183], v[80:83], v[68:71]
    buffer_load_dwordx4 a[100:103], v9, s[12:15], s75 offen offset:1024 sc1
    v_mfma_f32_16x16x32_bf16 v[72:75], v[184:187], v[80:83], v[72:75]
    s_add_u32 s75, s74, 114688
    v_mul_f32 v103, v103, v63
    v_cvt_pk_bf16_f32 v110, v100, v101
    v_mfma_f32_16x16x32_bf16 v[76:79], v[188:191], v[80:83], v[76:79]
    s_waitcnt lgkmcnt(2)
    v_cvt_pk_bf16_f32 v111, v102, v103
    v_mfma_f32_16x16x32_bf16 v[64:67], v[192:195], v[84:87], v[64:67]
    s_waitcnt vmcnt(21)
    ds_read_b128 v[80:83], v14 offset:1024
    s_lshl_b32 s4, s22, 2
    v_mfma_f32_16x16x32_bf16 v[68:71], v[196:199], v[84:87], v[68:71]
    buffer_store_dwordx4 v[108:111], v9, s[12:15], s73 offen sc1
    v_mfma_f32_16x16x32_bf16 v[72:75], v[200:203], v[84:87], v[72:75]
    s_add_u32 s4, s4, s16
    v_mfma_f32_16x16x32_bf16 v[76:79], v[204:207], v[84:87], v[76:79]
    s_waitcnt lgkmcnt(2)
    s_lshl_b32 s5, s4, 10
    v_mfma_f32_16x16x32_bf16 v[64:67], v[208:211], v[88:91], v[64:67]
    s_add_u32 s5, s5, 6420480
    s_waitcnt vmcnt(21)
    ds_read_b128 v[84:87], v14 offset:2048
    v_mov_b32 v0, -1
    v_mfma_f32_16x16x32_bf16 v[68:71], v[212:215], v[88:91], v[68:71]
    buffer_atomic_smax v0, v5, s[12:15], 0 offen offset:256 sc0 sc1
    v_mfma_f32_16x16x32_bf16 v[72:75], v[216:219], v[88:91], v[72:75]
    s_mul_i32 s4, s4, 14336
    s_lshl_b32 s6, s23, 11
    v_and_b32 v16, 7, v7
    v_mfma_f32_16x16x32_bf16 v[76:79], v[220:223], v[88:91], v[76:79]
    s_waitcnt lgkmcnt(2)
    s_add_u32 s4, s4, s6
    v_xor_b32 v16, v16, v8
    v_mfma_f32_16x16x32_bf16 v[64:67], v[224:227], v[92:95], v[64:67]
    s_mov_b32 m0, s39
    s_waitcnt vmcnt(21)
    ds_read_b128 v[88:91], v14 offset:3072
    v_lshlrev_b32 v16, 4, v16
    v_mfma_f32_16x16x32_bf16 v[68:71], v[228:231], v[92:95], v[68:71]
    s_add_u32 s4, s4, 1048576
    v_lshl_add_u32 v16, v7, 8, v16
    v_add_u32 v26, s35, v16
    v_mfma_f32_16x16x32_bf16 v[72:75], v[232:235], v[92:95], v[72:75]
    v_lshlrev_b32 v10, 1, v8
    v_xor_b32 v27, 64, v26
    v_mfma_f32_16x16x32_bf16 v[76:79], v[236:239], v[92:95], v[76:79]
    s_waitcnt lgkmcnt(2)
    v_lshl_add_u32 v24, s16, 2, v8
    v_mfma_f32_16x16x32_bf16 v[64:67], v[240:243], v[80:83], v[64:67]
    s_waitcnt vmcnt(20)
    ds_read_b128 v[92:95], v14 offset:4096
    v_sub_u32 v10, v7, v10
    v_mfma_f32_16x16x32_bf16 v[68:71], v[244:247], v[80:83], v[68:71]
    v_and_b32 v10, 15, v10
    v_and_b32 v18, 7, v24
    v_mfma_f32_16x16x32_bf16 v[72:75], v[248:251], v[80:83], v[72:75]
    v_lshlrev_b32 v10, 4, v10
    v_xor_b32 v18, v18, v7
    v_mfma_f32_16x16x32_bf16 v[76:79], v[252:255], v[80:83], v[76:79]
    s_waitcnt lgkmcnt(2)
    v_lshl_add_u32 v10, v8, 8, v10
    v_lshlrev_b32 v16, 8, v24
    v_mfma_f32_16x16x32_bf16 v[64:67], a[224:227], v[84:87], v[64:67]
    s_waitcnt vmcnt(19)
    ds_read_b128 v[80:83], v14 offset:5120
    v_xor_b32 v11, 128, v10
    v_mfma_f32_16x16x32_bf16 v[68:71], a[228:231], v[84:87], v[68:71]
    buffer_load_dwordx4 v10, s[12:15], s4 offen sc1 lds
    v_mfma_f32_16x16x32_bf16 v[72:75], a[232:235], v[84:87], v[72:75]
    v_lshl_add_u32 v16, v18, 4, v16
    v_add_u32 v16, 52224, v16
    v_mfma_f32_16x16x32_bf16 v[76:79], a[236:239], v[84:87], v[76:79]
    s_waitcnt lgkmcnt(2)
    buffer_load_dwordx4 v11, s[12:15], s4 offen offset:1024 sc1 lds
    v_mfma_f32_16x16x32_bf16 v[64:67], a[240:243], v[88:91], v[64:67]
    s_waitcnt vmcnt(20)
    ds_read_b128 v[84:87], v14 offset:6144
    v_add_u32 v23, 63488, v16
    v_mfma_f32_16x16x32_bf16 v[68:71], a[244:247], v[88:91], v[68:71]
    buffer_load_dwordx4 v9, s[12:15], s5 offen offset:2048 sc1 lds
    v_mfma_f32_16x16x32_bf16 v[72:75], a[248:251], v[88:91], v[72:75]
    v_lshlrev_b32 v21, 4, v7
    v_mul_u32_u24 v22, 28672, v8
    v_mfma_f32_16x16x32_bf16 v[76:79], a[252:255], v[88:91], v[76:79]
    s_waitcnt lgkmcnt(2)
    v_lshl_add_u32 v22, v7, 3, v22
    s_lshl_b32 s36, s16, 7
    v_mfma_f32_16x16x32_bf16 v[64:67], a[0:3], v[92:95], v[64:67]
    s_add_u32 s36, s36, s22
    s_mul_i32 s36, s36, 896
    v_mfma_f32_16x16x32_bf16 v[68:71], a[4:7], v[92:95], v[68:71]
    s_lshl_b32 s7, s23, 7
    v_mfma_f32_16x16x32_bf16 v[72:75], a[8:11], v[92:95], v[72:75]
    s_add_u32 s36, s36, s7
    v_mfma_f32_16x16x32_bf16 v[76:79], a[12:15], v[92:95], v[76:79]
    s_waitcnt lgkmcnt(1)
    v_and_b32 v17, 14, v7
    v_mfma_f32_16x16x32_bf16 v[64:67], a[16:19], v[80:83], v[64:67]
    v_add_u32 v18, v24, v17
    v_mfma_f32_16x16x32_bf16 v[68:71], a[20:23], v[80:83], v[68:71]
    v_and_b32 v18, 15, v18
    v_mfma_f32_16x16x32_bf16 v[72:75], a[24:27], v[80:83], v[72:75]
    v_lshlrev_b32 v17, 7, v17
    v_mfma_f32_16x16x32_bf16 v[76:79], a[28:31], v[80:83], v[76:79]
    s_waitcnt lgkmcnt(0)
    v_mfma_f32_16x16x32_bf16 v[64:67], a[32:35], v[84:87], v[64:67]
    v_lshl_add_u32 v17, v18, 4, v17
    v_mfma_f32_16x16x32_bf16 v[68:71], a[36:39], v[84:87], v[68:71]
    v_and_b32 v18, 1, v7
    v_mfma_f32_16x16x32_bf16 v[72:75], a[40:43], v[84:87], v[72:75]
    v_lshl_add_u32 v17, v18, 3, v17
    v_mfma_f32_16x16x32_bf16 v[76:79], a[44:47], v[84:87], v[76:79]
    s_waitcnt vmcnt(20)
    v_add_u32 v17, 16384, v17
    v_mfma_f32_16x16x32_bf16 v[80:83], v[112:115], a[48:51], 0
    v_lshlrev_b32 v24, 4, v24
    v_mfma_f32_16x16x32_bf16 v[84:87], v[116:119], a[48:51], 0
    s_waitcnt vmcnt(4)
    buffer_atomic_add v31, v29, s[12:15], 0 offen offset:384 sc1
    v_mfma_f32_16x16x32_bf16 v[88:91], v[120:123], a[48:51], 0
    v_lshrrev_b32 v18, 2, v2
    v_and_b32 v19, 3, v2
    v_mfma_f32_16x16x32_bf16 v[92:95], v[124:127], a[48:51], 0
    v_lshlrev_b32 v20, 8, v19
    v_mfma_f32_16x16x32_bf16 v[80:83], v[128:131], a[52:55], v[80:83]
    v_lshl_add_u32 v20, v18, 3, v20
    v_mfma_f32_16x16x32_bf16 v[84:87], v[132:135], a[52:55], v[84:87]
    s_waitcnt vmcnt(4)
    v_readfirstlane_b32 s77, v0
    v_add_u32 v20, s39, v20
    v_mfma_f32_16x16x32_bf16 v[88:91], v[136:139], a[52:55], v[88:91]
    s_cmp_lt_i32 s77, 13
    s_cbranch_scc1 L_slow_cc
L_back_cc:
    v_mfma_f32_16x16x32_bf16 v[92:95], v[140:143], a[52:55], v[92:95]
    buffer_load_dwordx4 a[104:107], v9, s[12:15], s75 offen offset:0 sc1
    v_mfma_f32_16x16x32_bf16 v[80:83], v[144:147], a[56:59], v[80:83]
    ds_write_b128 v26, v[64:67] offset:0
    v_mfma_f32_16x16x32_bf16 v[84:87], v[148:151], a[56:59], v[84:87]
    buffer_load_dwordx4 a[108:111], v9, s[12:15], s75 offen offset:1024 sc1
    v_mfma_f32_16x16x32_bf16 v[88:91], v[152:155], a[56:59], v[88:91]
    s_lshl_b32 s7, s16, 2
    v_lshl_add_u32 v25, v18, 4, s7
    v_mfma_f32_16x16x32_bf16 v[92:95], v[156:159], a[56:59], v[92:95]
    buffer_load_dwordx4 a[112:115], v9, s[12:15], s75 offen offset:2048 sc1
    v_mfma_f32_16x16x32_bf16 v[80:83], v[160:163], a[60:63], v[80:83]
    ds_write_b128 v27, v[68:71] offset:0
    v_mfma_f32_16x16x32_bf16 v[84:87], v[164:167], a[60:63], v[84:87]
    buffer_load_dwordx4 a[116:119], v9, s[12:15], s75 offen offset:3072 sc1
    v_mfma_f32_16x16x32_bf16 v[88:91], v[168:171], a[60:63], v[88:91]
    s_add_u32 s75, s74, 118784
    v_mfma_f32_16x16x32_bf16 v[92:95], v[172:175], a[60:63], v[92:95]
    buffer_load_dwordx4 a[120:123], v9, s[12:15], s75 offen offset:0 sc1
    v_mfma_f32_16x16x32_bf16 v[80:83], v[176:179], a[64:67], v[80:83]
    ds_write_b128 v26, v[72:75] offset:128
    v_mfma_f32_16x16x32_bf16 v[84:87], v[180:183], a[64:67], v[84:87]
    buffer_load_dwordx4 a[124:127], v9, s[12:15], s75 offen offset:1024 sc1
    v_mfma_f32_16x16x32_bf16 v[88:91], v[184:187], a[64:67], v[88:91]
    v_mfma_f32_16x16x32_bf16 v[92:95], v[188:191], a[64:67], v[92:95]
    buffer_load_dwordx4 a[128:131], v9, s[12:15], s75 offen offset:2048 sc1
    v_mfma_f32_16x16x32_bf16 v[80:83], v[192:195], a[68:71], v[80:83]
    ds_write_b128 v27, v[76:79] offset:128
    v_mfma_f32_16x16x32_bf16 v[84:87], v[196:199], a[68:71], v[84:87]
    buffer_load_dwordx4 a[132:135], v9, s[12:15], s75 offen offset:3072 sc1
    v_mfma_f32_16x16x32_bf16 v[88:91], v[200:203], a[68:71], v[88:91]
    s_add_u32 s75, s74, 122880
    v_mfma_f32_16x16x32_bf16 v[92:95], v[204:207], a[68:71], v[92:95]
    buffer_load_dwordx4 a[136:139], v9, s[12:15], s75 offen offset:0 sc1
    v_mfma_f32_16x16x32_bf16 v[80:83], v[208:211], a[72:75], v[80:83]
    v_mfma_f32_16x16x32_bf16 v[84:87], v[212:215], a[72:75], v[84:87]
    buffer_load_dwordx4 a[140:143], v9, s[12:15], s75 offen offset:1024 sc1
    v_mfma_f32_16x16x32_bf16 v[88:91], v[216:219], a[72:75], v[88:91]
    v_mfma_f32_16x16x32_bf16 v[92:95], v[220:223], a[72:75], v[92:95]
    buffer_load_dwordx4 a[144:147], v9, s[12:15], s75 offen offset:2048 sc1
    v_mfma_f32_16x16x32_bf16 v[80:83], v[224:227], a[76:79], v[80:83]
    v_mfma_f32_16x16x32_bf16 v[84:87], v[228:231], a[76:79], v[84:87]
    buffer_load_dwordx4 a[148:151], v9, s[12:15], s75 offen offset:3072 sc1
    v_mfma_f32_16x16x32_bf16 v[88:91], v[232:235], a[76:79], v[88:91]
    s_add_u32 s75, s74, 126976
    v_mfma_f32_16x16x32_bf16 v[92:95], v[236:239], a[76:79], v[92:95]
    buffer_load_dwordx4 a[152:155], v9, s[12:15], s75 offen offset:0 sc1
    v_mfma_f32_16x16x32_bf16 v[80:83], v[240:243], a[80:83], v[80:83]
    v_mfma_f32_16x16x32_bf16 v[84:87], v[244:247], a[80:83], v[84:87]
    buffer_load_dwordx4 a[156:159], v9, s[12:15], s75 offen offset:1024 sc1
    v_mfma_f32_16x16x32_bf16 v[88:91], v[248:251], a[80:83], v[88:91]
    s_add_u32 s75, s74, 172032
    v_mfma_f32_16x16x32_bf16 v[92:95], v[252:255], a[80:83], v[92:95]
    v_mfma_f32_16x16x32_bf16 v[80:83], a[224:227], a[84:87], v[80:83]
    s_waitcnt vmcnt(15)
    v_mfma_f32_16x16x32_bf16 v[84:87], a[228:231], a[84:87], v[84:87]
    v_mfma_f32_16x16x32_bf16 v[88:91], a[232:235], a[84:87], v[88:91]
    v_mfma_f32_16x16x32_bf16 v[92:95], a[236:239], a[84:87], v[92:95]
    v_mfma_f32_16x16x32_bf16 v[80:83], a[240:243], a[88:91], v[80:83]
    ds_read_b64 v[104:105], v20 offset:2048
    v_mfma_f32_16x16x32_bf16 v[84:87], a[244:247], a[88:91], v[84:87]
    v_mfma_f32_16x16x32_bf16 v[88:91], a[248:251], a[88:91], v[88:91]
    v_mfma_f32_16x16x32_bf16 v[92:95], a[252:255], a[88:91], v[92:95]
    v_mfma_f32_16x16x32_bf16 v[80:83], a[0:3], a[92:95], v[80:83]
    ds_read_b64 v[106:107], v20 offset:2176
    v_mfma_f32_16x16x32_bf16 v[84:87], a[4:7], a[92:95], v[84:87]
    v_mfma_f32_16x16x32_bf16 v[88:91], a[8:11], a[92:95], v[88:91]
    v_mfma_f32_16x16x32_bf16 v[92:95], a[12:15], a[92:95], v[92:95]
    v_mfma_f32_16x16x32_bf16 v[80:83], a[16:19], a[96:99], v[80:83]
    v_mov_b32 v0, -1
    v_mfma_f32_16x16x32_bf16 v[84:87], a[20:23], a[96:99], v[84:87]
    buffer_atomic_smax v0, v5, s[12:15], 0 offen offset:384 sc0 sc1
    v_mfma_f32_16x16x32_bf16 v[88:91], a[24:27], a[96:99], v[88:91]
    v_mfma_f32_16x16x32_bf16 v[92:95], a[28:31], a[96:99], v[92:95]
    v_mfma_f32_16x16x32_bf16 v[80:83], a[32:35], a[100:103], v[80:83]
    s_waitcnt lgkmcnt(0)
    v_add_f32 v104, v104, v106
    v_add_f32 v105, v105, v107
    v_mfma_f32_16x16x32_bf16 v[84:87], a[36:39], a[100:103], v[84:87]
    v_mfma_f32_16x16x32_bf16 v[88:91], a[40:43], a[100:103], v[88:91]
    v_add_f32_dpp v104, v104, v104 quad_perm:[1,0,3,2] row_mask:0xf bank_mask:0xf
    v_mfma_f32_16x16x32_bf16 v[92:95], a[44:47], a[100:103], v[92:95]
    s_waitcnt vmcnt(14)
    v_mfma_f32_16x16x32_bf16 v[32:35], v[112:115], a[104:107], 0
    v_mfma_f32_16x16x32_bf16 v[36:39], v[116:119], a[104:107], 0
    v_mfma_f32_16x16x32_bf16 v[40:43], v[120:123], a[104:107], 0
    v_add_f32_dpp v105, v105, v105 quad_perm:[1,0,3,2] row_mask:0xf bank_mask:0xf
    v_mfma_f32_16x16x32_bf16 v[44:47], v[124:127], a[104:107], 0
    s_waitcnt vmcnt(13)
    v_mfma_f32_16x16x32_bf16 v[32:35], v[128:131], a[108:111], v[32:35]
    v_mfma_f32_16x16x32_bf16 v[36:39], v[132:135], a[108:111], v[36:39]
    v_add_f32_dpp v104, v104, v104 quad_perm:[2,3,0,1] row_mask:0xf bank_mask:0xf
    v_mfma_f32_16x16x32_bf16 v[40:43], v[136:139], a[108:111], v[40:43]
    v_mfma_f32_16x16x32_bf16 v[44:47], v[140:143], a[108:111], v[44:47]
    s_waitcnt vmcnt(12)
    v_mfma_f32_16x16x32_bf16 v[32:35], v[144:147], a[112:115], v[32:35]
    ds_write_b128 v26, v[80:83] offset:4096
    v_mfma_f32_16x16x32_bf16 v[36:39], v[148:151], a[112:115], v[36:39]
    v_add_f32_dpp v105, v105, v105 quad_perm:[2,3,0,1] row_mask:0xf bank_mask:0xf
    v_mfma_f32_16x16x32_bf16 v[40:43], v[152:155], a[112:115], v[40:43]
    v_mfma_f32_16x16x32_bf16 v[44:47], v[156:159], a[112:115], v[44:47]
    s_waitcnt vmcnt(11)
    v_mfma_f32_16x16x32_bf16 v[32:35], v[160:163], a[116:119], v[32:35]
    ds_write_b128 v27, v[84:87] offset:4096
    v_mfma_f32_16x16x32_bf16 v[36:39], v[164:167], a[116:119], v[36:39]
    v_mul_f32 v104, 0x3b124925, v104
    v_mfma_f32_16x16x32_bf16 v[40:43], v[168:171], a[116:119], v[40:43]
    v_mfma_f32_16x16x32_bf16 v[44:47], v[172:175], a[116:119], v[44:47]
    s_waitcnt vmcnt(10)
    v_mfma_f32_16x16x32_bf16 v[32:35], v[176:179], a[120:123], v[32:35]
    ds_write_b128 v26, v[88:91] offset:4224
    v_mfma_f32_16x16x32_bf16 v[36:39], v[180:183], a[120:123], v[36:39]
    v_mul_f32 v105, 0x3b124925, v105
    v_mfma_f32_16x16x32_bf16 v[40:43], v[184:187], a[120:123], v[40:43]
    v_mfma_f32_16x16x32_bf16 v[44:47], v[188:191], a[120:123], v[44:47]
    s_waitcnt vmcnt(9)
    v_fma_f32 v105, -v104, v104, v105
    v_mfma_f32_16x16x32_bf16 v[32:35], v[192:195], a[124:127], v[32:35]
    ds_write_b128 v27, v[92:95] offset:4224
    v_mfma_f32_16x16x32_bf16 v[36:39], v[196:199], a[124:127], v[36:39]
    v_mfma_f32_16x16x32_bf16 v[40:43], v[200:203], a[124:127], v[40:43]
    v_mfma_f32_16x16x32_bf16 v[44:47], v[204:207], a[124:127], v[44:47]
    s_waitcnt vmcnt(8)
    v_max_f32 v105, 0, v105
    v_mfma_f32_16x16x32_bf16 v[32:35], v[208:211], a[128:131], v[32:35]
    v_mfma_f32_16x16x32_bf16 v[36:39], v[212:215], a[128:131], v[36:39]
    v_mfma_f32_16x16x32_bf16 v[40:43], v[216:219], a[128:131], v[40:43]
    v_add_f32 v105, 0x3727c5ac, v105
    v_mfma_f32_16x16x32_bf16 v[44:47], v[220:223], a[128:131], v[44:47]
    s_waitcnt vmcnt(7)
    v_mfma_f32_16x16x32_bf16 v[32:35], v[224:227], a[132:135], v[32:35]
    v_mfma_f32_16x16x32_bf16 v[36:39], v[228:231], a[132:135], v[36:39]
    s_waitcnt vmcnt(0)
    v_readfirstlane_b32 s77, v0
    v_mfma_f32_16x16x32_bf16 v[40:43], v[232:235], a[132:135], v[40:43]
    s_cmp_lt_i32 s77, 13
    s_cbranch_scc1 L_slow_dd
L_back_dd:
    v_mfma_f32_16x16x32_bf16 v[44:47], v[236:239], a[132:135], v[44:47]
    buffer_load_dwordx4 a[160:163], v9, s[12:15], s75 offen offset:0 sc1
    v_mfma_f32_16x16x32_bf16 v[32:35], v[240:243], a[136:139], v[32:35]
    v_rcp_f32 v105, v105
    v_mfma_f32_16x16x32_bf16 v[36:39], v[244:247], a[136:139], v[36:39]
    buffer_load_dwordx4 a[164:167], v9, s[12:15], s75 offen offset:1024 sc1
    v_mfma_f32_16x16x32_bf16 v[40:43], v[248:251], a[136:139], v[40:43]
    ds_write_b32 v25, v105 offset:4096
    v_mfma_f32_16x16x32_bf16 v[44:47], v[252:255], a[136:139], v[44:47]
    buffer_load_dwordx4 a[168:171], v9, s[12:15], s75 offen offset:2048 sc1
    v_mfma_f32_16x16x32_bf16 v[32:35], a[224:227], a[140:143], v[32:35]
    v_mfma_f32_16x16x32_bf16 v[36:39], a[228:231], a[140:143], v[36:39]
    buffer_load_dwordx4 a[172:175], v9, s[12:15], s75 offen offset:3072 sc1
    v_mfma_f32_16x16x32_bf16 v[40:43], a[232:235], a[140:143], v[40:43]
    s_add_u32 s75, s74, 176128
    ds_read_b128 v[28:31], v21 offset:512
    v_mfma_f32_16x16x32_bf16 v[44:47], a[236:239], a[140:143], v[44:47]
    buffer_load_dwordx4 a[176:179], v9, s[12:15], s75 offen offset:0 sc1
    v_mfma_f32_16x16x32_bf16 v[32:35], a[240:243], a[144:147], v[32:35]
    v_mfma_f32_16x16x32_bf16 v[36:39], a[244:247], a[144:147], v[36:39]
    buffer_load_dwordx4 a[180:183], v9, s[12:15], s75 offen offset:1024 sc1
    v_mfma_f32_16x16x32_bf16 v[40:43], a[248:251], a[144:147], v[40:43]
    v_mfma_f32_16x16x32_bf16 v[44:47], a[252:255], a[144:147], v[44:47]
    buffer_load_dwordx4 a[184:187], v9, s[12:15], s75 offen offset:2048 sc1
    v_mfma_f32_16x16x32_bf16 v[32:35], a[0:3], a[148:151], v[32:35]
    v_mfma_f32_16x16x32_bf16 v[36:39], a[4:7], a[148:151], v[36:39]
    buffer_load_dwordx4 a[188:191], v9, s[12:15], s75 offen offset:3072 sc1
    v_mfma_f32_16x16x32_bf16 v[40:43], a[8:11], a[148:151], v[40:43]
    s_add_u32 s75, s74, 180224
    v_mfma_f32_16x16x32_bf16 v[44:47], a[12:15], a[148:151], v[44:47]
    buffer_load_dwordx4 a[192:195], v9, s[12:15], s75 offen offset:0 sc1
    v_mfma_f32_16x16x32_bf16 v[32:35], a[16:19], a[152:155], v[32:35]
    v_mfma_f32_16x16x32_bf16 v[36:39], a[20:23], a[152:155], v[36:39]
    buffer_load_dwordx4 a[196:199], v9, s[12:15], s75 offen offset:1024 sc1
    v_mfma_f32_16x16x32_bf16 v[40:43], a[24:27], a[152:155], v[40:43]
    v_mfma_f32_16x16x32_bf16 v[44:47], a[28:31], a[152:155], v[44:47]
    buffer_load_dwordx4 a[200:203], v9, s[12:15], s75 offen offset:2048 sc1
    v_mfma_f32_16x16x32_bf16 v[32:35], a[32:35], a[156:159], v[32:35]
    v_mfma_f32_16x16x32_bf16 v[36:39], a[36:39], a[156:159], v[36:39]
    buffer_load_dwordx4 a[204:207], v9, s[12:15], s75 offen offset:3072 sc1
    v_mfma_f32_16x16x32_bf16 v[40:43], a[40:43], a[156:159], v[40:43]
    s_add_u32 s75, s74, 184320
    v_mfma_f32_16x16x32_bf16 v[44:47], a[44:47], a[156:159], v[44:47]
    s_waitcnt vmcnt(11)
    buffer_load_dwordx4 a[208:211], v9, s[12:15], s75 offen offset:0 sc1
    v_mfma_f32_16x16x32_bf16 v[48:51], v[112:115], a[160:163], 0
    v_mfma_f32_16x16x32_bf16 v[52:55], v[116:119], a[160:163], 0
    buffer_load_dwordx4 a[212:215], v9, s[12:15], s75 offen offset:1024 sc1
    v_mfma_f32_16x16x32_bf16 v[56:59], v[120:123], a[160:163], 0
    v_mfma_f32_16x16x32_bf16 v[60:63], v[124:127], a[160:163], 0
    s_waitcnt vmcnt(12)
    ds_write_b128 v26, v[32:35] offset:8192
    v_mfma_f32_16x16x32_bf16 v[48:51], v[128:131], a[164:167], v[48:51]
    v_mfma_f32_16x16x32_bf16 v[52:55], v[132:135], a[164:167], v[52:55]
    ds_write_b128 v27, v[36:39] offset:8192
    v_mfma_f32_16x16x32_bf16 v[56:59], v[136:139], a[164:167], v[56:59]
    v_mfma_f32_16x16x32_bf16 v[60:63], v[140:143], a[164:167], v[60:63]
    s_waitcnt vmcnt(11)
    ds_write_b128 v26, v[40:43] offset:8320
    v_mfma_f32_16x16x32_bf16 v[48:51], v[144:147], a[168:171], v[48:51]
    v_mfma_f32_16x16x32_bf16 v[52:55], v[148:151], a[168:171], v[52:55]
    ds_write_b128 v27, v[44:47] offset:8320
    v_mfma_f32_16x16x32_bf16 v[56:59], v[152:155], a[168:171], v[56:59]
    v_mfma_f32_16x16x32_bf16 v[60:63], v[156:159], a[168:171], v[60:63]
    s_waitcnt vmcnt(10)
    s_waitcnt lgkmcnt(0)
    s_barrier
    v_mfma_f32_16x16x32_bf16 v[48:51], v[160:163], a[172:175], v[48:51]
    ds_read_b128 v[4:7], v24 offset:4096
    v_mfma_f32_16x16x32_bf16 v[52:55], v[164:167], a[172:175], v[52:55]
    ds_read_b64 v[82:83], v17 offset:20480
    v_mfma_f32_16x16x32_bf16 v[56:59], v[168:171], a[172:175], v[56:59]
    ds_read_b64 v[86:87], v17 offset:27648
    v_mfma_f32_16x16x32_bf16 v[60:63], v[172:175], a[172:175], v[60:63]
    s_waitcnt vmcnt(9)
    ds_read_b128 v[32:35], v16 offset:0
    v_mfma_f32_16x16x32_bf16 v[48:51], v[176:179], a[176:179], v[48:51]
    ds_read_b128 v[36:39], v16 offset:31744
    v_mfma_f32_16x16x32_bf16 v[52:55], v[180:183], a[176:179], v[52:55]
    ds_read_b128 v[40:43], v23 offset:0
    v_mfma_f32_16x16x32_bf16 v[56:59], v[184:187], a[176:179], v[56:59]
    ds_read_b128 v[44:47], v23 offset:31744
    v_mfma_f32_16x16x32_bf16 v[60:63], v[188:191], a[176:179], v[60:63]
    s_waitcnt vmcnt(8)
    ds_read_b64 v[90:91], v17 offset:52224
    v_mfma_f32_16x16x32_bf16 v[48:51], v[192:195], a[180:183], v[48:51]
    ds_read_b64 v[94:95], v17 offset:59392
    v_mfma_f32_16x16x32_bf16 v[52:55], v[196:199], a[180:183], v[52:55]
    ds_read_b128 v[96:99], v16 offset:4096
    s_waitcnt lgkmcnt(9)
    v_mul_f32 v64, v28, v4
    v_mfma_f32_16x16x32_bf16 v[56:59], v[200:203], a[180:183], v[56:59]
    ds_read_b128 v[100:103], v16 offset:35840
    v_mul_f32 v65, v29, v4
    v_mfma_f32_16x16x32_bf16 v[60:63], v[204:207], a[180:183], v[60:63]
    s_waitcnt vmcnt(7)
    ds_read_b128 v[104:107], v23 offset:4096
    v_mul_f32 v66, v30, v4
    v_mfma_f32_16x16x32_bf16 v[48:51], v[208:211], a[184:187], v[48:51]
    ds_read_b128 v[108:111], v23 offset:35840
    v_mul_f32 v67, v31, v4
    v_mfma_f32_16x16x32_bf16 v[52:55], v[212:215], a[184:187], v[52:55]
    s_waitcnt lgkmcnt(11)
    v_lshlrev_b32 v80, 16, v82
    v_and_b32 v81, 0xffff0000, v82
    v_mfma_f32_16x16x32_bf16 v[56:59], v[216:219], a[184:187], v[56:59]
    v_lshlrev_b32 v82, 16, v83
    v_and_b32 v83, 0xffff0000, v83
    v_mfma_f32_16x16x32_bf16 v[60:63], v[220:223], a[184:187], v[60:63]
    s_waitcnt vmcnt(6)
    v_mul_f32 v68, v28, v5
    v_mul_f32 v69, v29, v5
    v_mfma_f32_16x16x32_bf16 v[48:51], v[224:227], a[188:191], v[48:51]
    v_mul_f32 v70, v30, v5
    v_mul_f32 v71, v31, v5
    v_mfma_f32_16x16x32_bf16 v[52:55], v[228:231], a[188:191], v[52:55]
    s_waitcnt lgkmcnt(10)
    v_lshlrev_b32 v84, 16, v86
    v_and_b32 v85, 0xffff0000, v86
    v_mfma_f32_16x16x32_bf16 v[56:59], v[232:235], a[188:191], v[56:59]
    v_lshlrev_b32 v86, 16, v87
    v_and_b32 v87, 0xffff0000, v87
    v_mfma_f32_16x16x32_bf16 v[60:63], v[236:239], a[188:191], v[60:63]
    s_waitcnt vmcnt(5)
    s_waitcnt lgkmcnt(8)
    v_add_f32 v32, v32, v36
    v_add_f32 v33, v33, v37
    v_mfma_f32_16x16x32_bf16 v[48:51], v[240:243], a[192:195], v[48:51]
    v_add_f32 v34, v34, v38
    v_add_f32 v35, v35, v39
    v_mfma_f32_16x16x32_bf16 v[52:55], v[244:247], a[192:195], v[52:55]
    s_waitcnt lgkmcnt(6)
    v_add_f32 v40, v40, v44
    v_add_f32 v41, v41, v45
    v_mfma_f32_16x16x32_bf16 v[56:59], v[248:251], a[192:195], v[56:59]
    v_add_f32 v42, v42, v46
    v_add_f32 v43, v43, v47
    v_mfma_f32_16x16x32_bf16 v[60:63], v[252:255], a[192:195], v[60:63]
    s_waitcnt vmcnt(4)
    v_add_f32 v32, v32, v40
    v_add_f32 v33, v33, v41
    v_mfma_f32_16x16x32_bf16 v[48:51], a[224:227], a[196:199], v[48:51]
    v_add_f32 v34, v34, v42
    v_add_f32 v35, v35, v43
    v_mfma_f32_16x16x32_bf16 v[52:55], a[228:231], a[196:199], v[52:55]
    v_fma_f32 v32, v32, v64, v80
    v_fma_f32 v33, v33, v65, v81
    v_mfma_f32_16x16x32_bf16 v[56:59], a[232:235], a[196:199], v[56:59]
    v_fma_f32 v34, v34, v66, v82
    v_fma_f32 v35, v35, v67, v83
    v_mfma_f32_16x16x32_bf16 v[60:63], a[236:239], a[196:199], v[60:63]
    s_waitcnt vmcnt(3)
    v_cvt_pk_bf16_f32 v10, v32, v33
    v_cvt_pk_bf16_f32 v11, v34, v35
    v_mfma_f32_16x16x32_bf16 v[48:51], a[240:243], a[200:203], v[48:51]
    buffer_store_dwordx2 v[10:11], v22, s[48:51], s36 offen sc1
    v_mfma_f32_16x16x32_bf16 v[52:55], a[244:247], a[200:203], v[52:55]
    ds_read_b128 v[32:35], v16 offset:8192
    s_add_u32 s36, s36, 458752
    v_mfma_f32_16x16x32_bf16 v[56:59], a[248:251], a[200:203], v[56:59]
    ds_read_b128 v[36:39], v16 offset:39936
    v_mul_f32 v72, v28, v6
    v_mfma_f32_16x16x32_bf16 v[60:63], a[252:255], a[200:203], v[60:63]
    s_waitcnt vmcnt(3)
    ds_read_b128 v[40:43], v23 offset:8192
    v_mul_f32 v73, v29, v6
    v_mfma_f32_16x16x32_bf16 v[48:51], a[0:3], a[204:207], v[48:51]
    ds_read_b128 v[44:47], v23 offset:39936
    v_mul_f32 v74, v30, v6
    v_mfma_f32_16x16x32_bf16 v[52:55], a[4:7], a[204:207], v[52:55]
    v_mul_f32 v75, v31, v6
    s_waitcnt lgkmcnt(9)
    v_lshlrev_b32 v88, 16, v90
    v_mfma_f32_16x16x32_bf16 v[56:59], a[8:11], a[204:207], v[56:59]
    v_and_b32 v89, 0xffff0000, v90
    v_lshlrev_b32 v90, 16, v91
    v_mfma_f32_16x16x32_bf16 v[60:63], a[12:15], a[204:207], v[60:63]
    s_waitcnt vmcnt(2)
    v_and_b32 v91, 0xffff0000, v91
    s_waitcnt vmcnt(1)
    v_mfma_f32_16x16x32_bf16 v[48:51], a[16:19], a[208:211], v[48:51]
    s_waitcnt lgkmcnt(6)
    v_add_f32 v96, v96, v100
    v_add_f32 v97, v97, v101
    v_mfma_f32_16x16x32_bf16 v[48:51], a[32:35], a[212:215], v[48:51]
    v_add_f32 v98, v98, v102
    v_add_f32 v99, v99, v103
    v_mfma_f32_16x16x32_bf16 v[52:55], a[20:23], a[208:211], v[52:55]
    s_waitcnt lgkmcnt(4)
    v_add_f32 v104, v104, v108
    v_add_f32 v105, v105, v109
    v_mfma_f32_16x16x32_bf16 v[52:55], a[36:39], a[212:215], v[52:55]
    s_nop 0
    ds_write_b128 v26, v[48:51] offset:12288
    v_mfma_f32_16x16x32_bf16 v[56:59], a[24:27], a[208:211], v[56:59]
    v_add_f32 v106, v106, v110
    v_add_f32 v107, v107, v111
    v_mfma_f32_16x16x32_bf16 v[56:59], a[40:43], a[212:215], v[56:59]
    s_nop 0
    ds_write_b128 v27, v[52:55] offset:12288
    v_mfma_f32_16x16x32_bf16 v[60:63], a[28:31], a[208:211], v[60:63]
    v_add_f32 v96, v96, v104
    v_add_f32 v97, v97, v105
    v_mfma_f32_16x16x32_bf16 v[60:63], a[44:47], a[212:215], v[60:63]
    s_nop 0
    ds_write_b128 v26, v[56:59] offset:12416
    v_add_f32 v98, v98, v106
    v_add_f32 v99, v99, v107
    v_fma_f32 v96, v96, v68, v84
    s_nop 2
    ds_write_b128 v27, v[60:63] offset:12416
    v_fma_f32 v97, v97, v69, v85
    v_fma_f32 v98, v98, v70, v86
    v_fma_f32 v99, v99, v71, v87
    v_cvt_pk_bf16_f32 v12, v96, v97
    v_cvt_pk_bf16_f32 v13, v98, v99
    buffer_store_dwordx2 v[12:13], v22, s[48:51], s36 offen sc1
    s_add_u32 s36, s36, 458752
    v_mul_f32 v76, v28, v7
    v_mul_f32 v77, v29, v7
    v_mul_f32 v78, v30, v7
    v_mul_f32 v79, v31, v7
    v_lshlrev_b32 v92, 16, v94
    s_waitcnt lgkmcnt(0)
    s_barrier
    ds_read_b128 v[96:99], v16 offset:12288
    ds_read_b128 v[100:103], v16 offset:44032
    ds_read_b128 v[104:107], v23 offset:12288
    ds_read_b128 v[108:111], v23 offset:44032
    v_and_b32 v93, 0xffff0000, v94
    v_lshlrev_b32 v94, 16, v95
    v_and_b32 v95, 0xffff0000, v95
    v_add_f32 v32, v32, v36
    v_add_f32 v33, v33, v37
    v_add_f32 v34, v34, v38
    v_add_f32 v35, v35, v39
    v_add_f32 v40, v40, v44
    v_add_f32 v41, v41, v45
    v_add_f32 v42, v42, v46
    v_add_f32 v43, v43, v47
    v_add_f32 v32, v32, v40
    v_add_f32 v33, v33, v41
    v_add_f32 v34, v34, v42
    v_add_f32 v35, v35, v43
    v_fma_f32 v32, v32, v72, v88
    v_fma_f32 v33, v33, v73, v89
    v_fma_f32 v34, v34, v74, v90
    v_fma_f32 v35, v35, v75, v91
    v_cvt_pk_bf16_f32 v10, v32, v33
    v_cvt_pk_bf16_f32 v11, v34, v35
    buffer_store_dwordx2 v[10:11], v22, s[48:51], s36 offen sc1
    s_add_u32 s36, s36, 458752
    s_waitcnt lgkmcnt(2)
    v_add_f32 v96, v96, v100
    v_add_f32 v97, v97, v101
    v_add_f32 v98, v98, v102
    v_add_f32 v99, v99, v103
    s_waitcnt lgkmcnt(0)
    v_add_f32 v104, v104, v108
    v_add_f32 v105, v105, v109
    v_add_f32 v106, v106, v110
    v_add_f32 v107, v107, v111
    v_add_f32 v96, v96, v104
    v_add_f32 v97, v97, v105
    v_add_f32 v98, v98, v106
    v_add_f32 v99, v99, v107
    v_fma_f32 v96, v96, v76, v92
    v_fma_f32 v97, v97, v77, v93
    v_fma_f32 v98, v98, v78, v94
    v_fma_f32 v99, v99, v79, v95
    v_cvt_pk_bf16_f32 v12, v96, v97
    v_cvt_pk_bf16_f32 v13, v98, v99
    buffer_store_dwordx2 v[12:13], v22, s[48:51], s36 offen sc1
L_fin:
L_end:
    s_endpgm
L_early:
    s_waitcnt vmcnt(0) lgkmcnt(0)
    s_barrier
    buffer_atomic_add v31, v16, s[12:15], 0 offen sc1
    s_branch L_fin
L_slow_s2g:
    buffer_load_dwordx2 v[92:93], v253, s[12:15], 0 offen sc1
    s_add_u32 s31, s31, 16777216
    s_add_u32 s76, s76, 1
    s_waitcnt vmcnt(0)
    v_xor_b32 v93, v92, v93
    v_subrev_u32 v94, s70, v92
    v_xor_b32 v93, 0x5bd1e995, v93
    v_lshrrev_b32 v92, 14, v94
    v_or_b32 v92, v92, v93
    v_cmp_ne_u32 vcc, 0, v92
    s_cmp_gt_u32 s76, 20000
    s_cbranch_scc1 L_back_s2g
    s_cbranch_vccnz L_slow_s2g
    s_branch L_back_s2g
L_slow_ca:
    s_add_u32 s31, s31, 16777216
    s_add_u32 s76, s76, 1
    s_cmp_gt_u32 s76, 20000
    s_cbranch_scc1 L_back_ca
    s_nop 7
    s_mov_b32 s4, m0
    s_add_u32 m0, s29, 14336
    s_nop 0
    buffer_load_dwordx4 v28, s[12:15], 0 offen sc1 lds
    s_waitcnt vmcnt(0)
    s_mov_b32 m0, s4
    ds_read2_b32 v[208:209], v29 offset0:128 offset1:136
    ds_read2_b32 v[210:211], v29 offset0:192 offset1:200
    ds_read2_b32 v[212:213], v29 offset0:0 offset1:8
    ds_read2_b32 v[214:215], v29 offset0:64 offset1:72
    s_waitcnt lgkmcnt(0)
    v_max3_u32 v27, v208, v209, v210
    v_max3_u32 v27, v27, v211, v212
    v_max3_u32 v27, v27, v213, v214
    v_max_u32 v27, v27, v215
    s_nop 1
    v_cmp_eq_u32 vcc, -1, v27
    s_nop 1
    s_cbranch_vccnz L_slow_ca
    s_branch L_back_ca
L_slow_n:
    s_lshl_b32 s3, s16, 11
    s_add_u32 s3, s3, 32768
    buffer_load_dwordx4 v[64:67], v9, s[12:15], s3 offen sc1
    s_add_u32 s31, s31, 1
    s_add_u32 s76, s76, 1
    s_cmp_gt_u32 s76, 20000
    s_cbranch_scc1 L_back_n
    s_waitcnt vmcnt(0)
    v_xor_b32 v65, v65, v64
    v_xor_b32 v67, v67, v66
    v_subrev_u32 v64, s70, v64
    v_subrev_u32 v66, s70, v66
    v_xor_b32 v65, 0x5bd1e995, v65
    v_xor_b32 v67, 0x5bd1e995, v67
    v_max_u32 v64, v64, v66
    v_or_b32 v65, v65, v67
    v_cmp_lt_u32 vcc, 0x3fff, v64
    v_cmp_ne_u32 s[4:5], 0, v65
    s_nop 0
    s_or_b64 vcc, vcc, s[4:5]
    s_cbranch_scc1 L_slow_n
    v_cmp_lt_u32 vcc, s44, v64
    s_nop 1
    s_cbranch_vccz L_back_n
    s_mov_b32 s4, m0
    s_add_u32 m0, s29, 0
    s_add_u32 s3, s72, 0
    buffer_load_dwordx4 v9, s[12:15], s3 offen offset:0 sc1 lds
    buffer_load_dwordx4 v9, s[12:15], s3 offen offset:1024 sc1 lds
    buffer_load_dwordx4 v9, s[12:15], s3 offen offset:2048 sc1 lds
    buffer_load_dwordx4 v9, s[12:15], s3 offen offset:3072 sc1 lds
    s_add_u32 m0, s29, 4096
    s_add_u32 s3, s72, 4096
    buffer_load_dwordx4 v9, s[12:15], s3 offen offset:0 sc1 lds
    buffer_load_dwordx4 v9, s[12:15], s3 offen offset:1024 sc1 lds
    buffer_load_dwordx4 v9, s[12:15], s3 offen offset:2048 sc1 lds
    buffer_load_dwordx4 v9, s[12:15], s3 offen offset:3072 sc1 lds
    s_add_u32 m0, s29, 8192
    s_add_u32 s3, s72, 8192
    buffer_load_dwordx4 v9, s[12:15], s3 offen offset:0 sc1 lds
    buffer_load_dwordx4 v9, s[12:15], s3 offen offset:1024 sc1 lds
    buffer_load_dwordx4 v9, s[12:15], s3 offen offset:2048 sc1 lds
    buffer_load_dwordx4 v9, s[12:15], s3 offen offset:3072 sc1 lds
    s_add_u32 m0, s29, 12288
    s_add_u32 s3, s72, 12288
    buffer_load_dwordx4 v9, s[12:15], s3 offen offset:0 sc1 lds
    buffer_load_dwordx4 v9, s[12:15], s3 offen offset:1024 sc1 lds
    s_waitcnt vmcnt(0) lgkmcnt(0)
    s_mov_b32 m0, s4
    ds_read_b128 v[64:67], v16 offset:0
    ds_read_b128 v[80:83], v18 offset:0
    ds_read_b128 v[68:71], v20 offset:0
    ds_read_b128 v[84:87], v22 offset:0
    ds_read_b128 v[72:75], v17 offset:0
    ds_read_b128 v[88:91], v19 offset:0
    ds_read_b128 v[76:79], v21 offset:0
    ds_read_b128 v[92:95], v23 offset:0
    ds_read_b128 v[96:99], v16 offset:7168
    ds_read_b128 v[112:115], v18 offset:7168
    ds_read_b128 v[100:103], v20 offset:7168
    ds_read_b128 v[116:119], v22 offset:7168
    ds_read_b128 v[104:107], v17 offset:7168
    ds_read_b128 v[120:123], v19 offset:7168
    ds_read_b128 v[108:111], v21 offset:7168
    ds_read_b128 v[124:127], v23 offset:7168
    s_waitcnt lgkmcnt(15)
    v_mfma_f32_16x16x32_bf16 v[208:211], v[32:35], v[64:67], v[204:207]
    s_waitcnt lgkmcnt(14)
    v_mfma_f32_16x16x32_bf16 v[216:219], v[48:51], v[80:83], v[228:231]
    s_waitcnt lgkmcnt(13)
    v_mfma_f32_16x16x32_bf16 v[208:211], v[36:39], v[68:71], v[208:211]
    s_waitcnt lgkmcnt(12)
    v_mfma_f32_16x16x32_bf16 v[216:219], v[52:55], v[84:87], v[216:219]
    s_waitcnt lgkmcnt(11)
    v_mfma_f32_16x16x32_bf16 v[208:211], v[40:43], v[72:75], v[208:211]
    s_waitcnt lgkmcnt(10)
    v_mfma_f32_16x16x32_bf16 v[216:219], v[56:59], v[88:91], v[216:219]
    s_waitcnt lgkmcnt(9)
    v_mfma_f32_16x16x32_bf16 v[208:211], v[44:47], v[76:79], v[208:211]
    s_waitcnt lgkmcnt(8)
    v_mfma_f32_16x16x32_bf16 v[216:219], v[60:63], v[92:95], v[216:219]
    s_nop 4
    v_cvt_pk_bf16_f32 v200, v208, v209
    v_cvt_pk_bf16_f32 v201, v210, v211
    s_nop 0
    v_cvt_pk_bf16_f32 v202, v216, v217
    v_cvt_pk_bf16_f32 v203, v218, v219
    ds_write_b64 v25, v[200:201] offset:0
    ds_write_b64 v25, v[202:203] offset:512
    s_waitcnt lgkmcnt(0)
    s_branch L_back_n
L_slow_s2:
    buffer_load_dwordx2 v[28:29], v6, s[12:15], 0 offen sc1
    s_add_u32 s31, s31, 16777216
    s_add_u32 s76, s76, 1
    s_waitcnt vmcnt(0)
    v_xor_b32 v29, v28, v29
    v_subrev_u32 v28, s70, v28
    v_xor_b32 v29, 0x5bd1e995, v29
    v_lshrrev_b32 v28, 14, v28
    v_or_b32 v28, v28, v29
    v_cmp_ne_u32 vcc, 0, v28
    s_cmp_gt_u32 s76, 20000
    s_cbranch_scc1 L_back_s2
    s_cbranch_vccnz L_slow_s2
    s_branch L_back_s2
L_slow_mp:
    s_add_u32 s31, s31, 16777216
    s_add_u32 s76, s76, 1
    s_cmp_gt_u32 s76, 20000
    s_cbranch_scc1 L_back_mp
    s_nop 7
    buffer_load_dwordx4 v[28:31], v16, s[12:15], 0 offen sc1
    s_waitcnt vmcnt(0)
    v_max3_u32 v27, v28, v29, v30
    v_max_u32 v27, v27, v31
    s_nop 1
    v_cmp_eq_u32 vcc, -1, v27
    s_nop 1
    s_cbranch_vccnz L_slow_mp
    s_branch L_back_mp
L_slow_z:
    s_add_u32 s31, s31, 256
    s_add_u32 s76, s76, 1
    s_cmp_gt_u32 s76, 20000
    s_cbranch_scc1 L_back_z
    s_nop 7
    s_and_b32 s0, s76, 7
    s_cbranch_scc1 L_nrs
    s_memrealtime s[0:1]
    s_waitcnt lgkmcnt(0)
    v_mov_b32 v56, s0
    v_xor_b32 v57, 0x5bd1e995, v56
    s_lshl_b32 s0, s2, 3
    s_add_u32 s0, s0, 32768
    s_lshl_b32 s1, s2, 7
    v_and_b32 v58, 3, v2
    v_lshl_add_u32 v58, v58, 11, s0
    v_lshl_add_u32 v59, v2, 3, s1
    v_cmp_gt_u32 vcc, 16, v2
    s_nop 1
    v_cndmask_b32 v58, v58, v59, vcc
    buffer_store_dwordx2 v[56:57], v58, s[12:15], 0 offen sc1
    L_nrs:
    buffer_load_dwordx4 v[48:51], v20, s[12:15], s73 offen sc1
    buffer_load_dwordx4 v[52:55], v21, s[12:15], s73 offen sc1
    s_waitcnt vmcnt(0)
    v_max3_u32 v27, v48, v49, v50
    v_max3_u32 v27, v27, v51, v52
    v_max3_u32 v27, v27, v53, v54
    v_max_u32 v27, v27, v55
    s_nop 1
    v_cmp_eq_u32 vcc, -1, v27
    s_nop 1
    s_cbranch_vccnz L_slow_z
    s_branch L_back_z
L_slow_a1_0:
    s_add_u32 s31, s31, 65536
    s_add_u32 s76, s76, 1
    s_cmp_gt_u32 s76, 20000
    s_cbranch_scc1 L_back_a1_0
    s_nop 7
    s_mov_b32 s5, m0
    s_add_u32 s4, s33, 0
    s_add_u32 m0, s32, 0
    s_nop 0
    buffer_load_dwordx4 v9, s[12:15], s4 offen offset:0 sc1 lds
    buffer_load_dwordx4 v9, s[12:15], s4 offen offset:1024 sc1 lds
    buffer_load_dwordx4 v9, s[12:15], s4 offen offset:2048 sc1 lds
    buffer_load_dwordx4 v9, s[12:15], s4 offen offset:3072 sc1 lds
    s_waitcnt vmcnt(0)
    s_mov_b32 m0, s5
    v_mov_b32 v3, 0
    ds_read2st64_b32 v[10:11], v14 offset0:0 offset1:4
    s_waitcnt lgkmcnt(0)
    v_max3_u32 v3, v3, v10, v11
    ds_read2st64_b32 v[10:11], v14 offset0:8 offset1:12
    s_waitcnt lgkmcnt(0)
    v_max3_u32 v3, v3, v10, v11
    s_nop 1
    v_cmp_eq_u32 vcc, -1, v3
    s_nop 1
    s_cbranch_vccnz L_slow_a1_0
    s_branch L_back_a1_0
L_slow_a:
    v_mov_b32 v0, -1
    buffer_atomic_smax v0, v5, s[12:15], 0 offen offset:0 sc0 sc1
    s_add_u32 s76, s76, 1
    s_add_u32 s31, s31, 1
    s_waitcnt vmcnt(0)
    v_readfirstlane_b32 s77, v0
    s_cmp_gt_u32 s76, 20000
    s_cbranch_scc1 L_back_a
    s_cmp_lt_i32 s77, 13
    s_cbranch_scc1 L_slow_a
    s_branch L_back_a
L_slow_b:
    v_mov_b32 v0, -1
    buffer_atomic_smax v0, v5, s[12:15], 0 offen offset:128 sc0 sc1
    s_add_u32 s76, s76, 1
    s_add_u32 s31, s31, 1
    s_waitcnt vmcnt(0)
    v_readfirstlane_b32 s77, v0
    s_cmp_gt_u32 s76, 20000
    s_cbranch_scc1 L_back_b
    s_cmp_lt_i32 s77, 29
    s_cbranch_scc1 L_slow_b
    s_branch L_back_b
L_slow_cc:
    v_mov_b32 v0, -1
    buffer_atomic_smax v0, v5, s[12:15], 0 offen offset:256 sc0 sc1
    s_add_u32 s76, s76, 1
    s_add_u32 s31, s31, 1
    s_waitcnt vmcnt(0)
    v_readfirstlane_b32 s77, v0
    s_cmp_gt_u32 s76, 20000
    s_cbranch_scc1 L_back_cc
    s_cmp_lt_i32 s77, 13
    s_cbranch_scc1 L_slow_cc
    s_branch L_back_cc
L_slow_dd:
    v_mov_b32 v0, -1
    buffer_atomic_smax v0, v5, s[12:15], 0 offen offset:384 sc0 sc1
    s_add_u32 s76, s76, 1
    s_add_u32 s31, s31, 1
    s_waitcnt vmcnt(0)
    v_readfirstlane_b32 s77, v0
    s_cmp_gt_u32 s76, 20000
    s_cbranch_scc1 L_back_dd
    s_cmp_lt_i32 s77, 13
    s_cbranch_scc1 L_slow_dd
    s_branch L_back_dd
L_slow_sv:
    s_add_u32 s31, s31, 65536
    s_add_u32 s76, s76, 1
    s_cmp_gt_u32 s76, 20000
    s_cbranch_scc1 L_back_sv
    s_nop 7
    buffer_load_dwordx2 v[240:241], v17, s[12:15], s34 offen offset:0 sc1
    buffer_load_dwordx2 v[242:243], v17, s[12:15], s34 offen offset:128 sc1
    buffer_load_dwordx2 v[244:245], v17, s[12:15], s34 offen offset:256 sc1
    buffer_load_dwordx2 v[246:247], v17, s[12:15], s34 offen offset:384 sc1
    s_waitcnt vmcnt(0)
    v_max3_u32 v103, v240, v241, v242
    v_max3_u32 v103, v103, v243, v244
    v_max3_u32 v103, v103, v245, v246
    v_max_u32 v103, v103, v247
    s_nop 1
    v_cmp_eq_u32 vcc, -1, v103
    s_nop 1
    s_cbranch_vccnz L_slow_sv
    s_branch L_back_sv
L_slow_a1_1:
    s_add_u32 s31, s31, 65536
    s_add_u32 s76, s76, 1
    s_cmp_gt_u32 s76, 20000
    s_cbranch_scc1 L_back_a1_1
    s_nop 7
    s_mov_b32 s5, m0
    s_add_u32 s4, s33, 57344
    s_add_u32 m0, s32, 14336
    s_nop 0
    buffer_load_dwordx4 v9, s[12:15], s4 offen offset:0 sc1 lds
    buffer_load_dwordx4 v9, s[12:15], s4 offen offset:1024 sc1 lds
    buffer_load_dwordx4 v9, s[12:15], s4 offen offset:2048 sc1 lds
    buffer_load_dwordx4 v9, s[12:15], s4 offen offset:3072 sc1 lds
    s_waitcnt vmcnt(0)
    s_mov_b32 m0, s5
    v_mov_b32 v3, 0
    ds_read2st64_b32 v[10:11], v14 offset0:56 offset1:60
    s_waitcnt lgkmcnt(0)
    v_max3_u32 v3, v3, v10, v11
    ds_read2st64_b32 v[10:11], v14 offset0:64 offset1:68
    s_waitcnt lgkmcnt(0)
    v_max3_u32 v3, v3, v10, v11
    s_nop 1
    v_cmp_eq_u32 vcc, -1, v3
    s_nop 1
    s_cbranch_vccnz L_slow_a1_1
    s_branch L_back_a1_1
L_slow_a1_2:
    s_add_u32 s31, s31, 65536
    s_add_u32 s76, s76, 1
    s_cmp_gt_u32 s76, 20000
    s_cbranch_scc1 L_back_a1_2
    s_nop 7
    s_mov_b32 s5, m0
    s_add_u32 s4, s42, 14336
    s_add_u32 m0, s39, 0
    s_nop 0
    buffer_load_dwordx4 v9, s[12:15], s4 offen offset:0 sc1 lds
    buffer_load_dwordx4 v9, s[12:15], s4 offen offset:1024 sc1 lds
    buffer_load_dwordx4 v9, s[12:15], s4 offen offset:2048 sc1 lds
    buffer_load_dwordx4 v9, s[12:15], s4 offen offset:3072 sc1 lds
    s_add_u32 s4, s42, 18432
    s_add_u32 m0, s39, 4096
    s_nop 0
    buffer_load_dwordx4 v9, s[12:15], s4 offen offset:0 sc1 lds
    buffer_load_dwordx4 v9, s[12:15], s4 offen offset:1024 sc1 lds
    buffer_load_dwordx4 v9, s[12:15], s4 offen offset:2048 sc1 lds
    s_waitcnt vmcnt(0)
    s_mov_b32 m0, s5
    v_mov_b32 v3, 0
    ds_read2st64_b32 v[10:11], v15 offset0:0 offset1:4
    s_waitcnt lgkmcnt(0)
    v_max3_u32 v3, v3, v10, v11
    ds_read2st64_b32 v[10:11], v15 offset0:8 offset1:12
    s_waitcnt lgkmcnt(0)
    v_max3_u32 v3, v3, v10, v11
    ds_read2st64_b32 v[10:11], v15 offset0:16 offset1:20
    s_waitcnt lgkmcnt(0)
    v_max3_u32 v3, v3, v10, v11
    ds_read2st64_b32 v[10:11], v15 offset0:20 offset1:24
    s_waitcnt lgkmcnt(0)
    v_max3_u32 v3, v3, v10, v11
    s_nop 1
    v_cmp_eq_u32 vcc, -1, v3
    s_nop 1
    s_cbranch_vccnz L_slow_a1_2
    s_branch L_back_a1_2
L_slow_a1_3:
    s_add_u32 s31, s31, 65536
    s_add_u32 s76, s76, 1
    s_cmp_gt_u32 s76, 20000
    s_cbranch_scc1 L_back_a1_3
    s_nop 7
    s_mov_b32 s5, m0
    s_add_u32 s4, s42, 28672
    s_add_u32 m0, s39, 63488
    s_nop 0
    buffer_load_dwordx4 v9, s[12:15], s4 offen offset:0 sc1 lds
    buffer_load_dwordx4 v9, s[12:15], s4 offen offset:1024 sc1 lds
    buffer_load_dwordx4 v9, s[12:15], s4 offen offset:2048 sc1 lds
    buffer_load_dwordx4 v9, s[12:15], s4 offen offset:3072 sc1 lds
    s_add_u32 s4, s42, 32768
    s_add_u32 m0, s39, 67584
    s_nop 0
    buffer_load_dwordx4 v9, s[12:15], s4 offen offset:0 sc1 lds
    buffer_load_dwordx4 v9, s[12:15], s4 offen offset:1024 sc1 lds
    buffer_load_dwordx4 v9, s[12:15], s4 offen offset:2048 sc1 lds
    s_waitcnt vmcnt(0)
    s_mov_b32 m0, s5
    v_mov_b32 v3, 0
    ds_read2st64_b32 v[10:11], v14 offset0:0 offset1:4
    s_waitcnt lgkmcnt(0)
    v_max3_u32 v3, v3, v10, v11
    ds_read2st64_b32 v[10:11], v14 offset0:8 offset1:12
    s_waitcnt lgkmcnt(0)
    v_max3_u32 v3, v3, v10, v11
    ds_read2st64_b32 v[10:11], v14 offset0:16 offset1:20
    s_waitcnt lgkmcnt(0)
    v_max3_u32 v3, v3, v10, v11
    ds_read2st64_b32 v[10:11], v14 offset0:20 offset1:24
    s_waitcnt lgkmcnt(0)
    v_max3_u32 v3, v3, v10, v11
    s_nop 1
    v_cmp_eq_u32 vcc, -1, v3
    s_nop 1
    s_cbranch_vccnz L_slow_a1_3
    s_branch L_back_a1_3
L_slow_a1_4:
    s_add_u32 s31, s31, 65536
    s_add_u32 s76, s76, 1
    s_cmp_gt_u32 s76, 20000
    s_cbranch_scc1 L_back_a1_4
    s_nop 7
    s_mov_b32 s5, m0
    s_add_u32 s4, s42, 43008
    s_add_u32 m0, s38, 0
    s_nop 0
    buffer_load_dwordx4 v9, s[12:15], s4 offen offset:0 sc1 lds
    buffer_load_dwordx4 v9, s[12:15], s4 offen offset:1024 sc1 lds
    buffer_load_dwordx4 v9, s[12:15], s4 offen offset:2048 sc1 lds
    buffer_load_dwordx4 v9, s[12:15], s4 offen offset:3072 sc1 lds
    s_add_u32 s4, s42, 47104
    s_add_u32 m0, s38, 4096
    s_nop 0
    buffer_load_dwordx4 v9, s[12:15], s4 offen offset:0 sc1 lds
    buffer_load_dwordx4 v9, s[12:15], s4 offen offset:1024 sc1 lds
    buffer_load_dwordx4 v9, s[12:15], s4 offen offset:2048 sc1 lds
    s_waitcnt vmcnt(0)
    s_mov_b32 m0, s5
    v_mov_b32 v3, 0
    ds_read2st64_b32 v[10:11], v1 offset0:0 offset1:4
    s_waitcnt lgkmcnt(0)
    v_max3_u32 v3, v3, v10, v11
    ds_read2st64_b32 v[10:11], v1 offset0:8 offset1:12
    s_waitcnt lgkmcnt(0)
    v_max3_u32 v3, v3, v10, v11
    ds_read2st64_b32 v[10:11], v1 offset0:16 offset1:20
    s_waitcnt lgkmcnt(0)
    v_max3_u32 v3, v3, v10, v11
    ds_read2st64_b32 v[10:11], v1 offset0:20 offset1:24
    s_waitcnt lgkmcnt(0)
    v_max3_u32 v3, v3, v10, v11
    s_nop 1
    v_cmp_eq_u32 vcc, -1, v3
    s_nop 1
    s_cbranch_vccnz L_slow_a1_4
    s_branch L_back_a1_4
L_slow_s2gm:
    buffer_load_dwordx2 v[92:93], v253, s[12:15], 0 offen sc1
    s_add_u32 s31, s31, 16777216
    s_add_u32 s76, s76, 1
    s_waitcnt vmcnt(0)
    v_xor_b32 v93, v92, v93
    v_subrev_u32 v94, s70, v92
    v_xor_b32 v93, 0x5bd1e995, v93
    v_lshrrev_b32 v92, 14, v94
    v_or_b32 v92, v92, v93
    v_cmp_ne_u32 vcc, 0, v92
    s_cmp_gt_u32 s76, 20000
    s_cbranch_scc1 L_back_s2gm
    s_cbranch_vccnz L_slow_s2gm
    s_branch L_back_s2gm
L_slow_s2m:
    buffer_load_dwordx2 v[30:31], v6, s[12:15], 0 offen sc1
    s_add_u32 s31, s31, 0
    s_add_u32 s76, s76, 1
    s_waitcnt vmcnt(0)
    v_xor_b32 v31, v30, v31
    v_subrev_u32 v30, s70, v30
    v_xor_b32 v31, 0x5bd1e995, v31
    v_lshrrev_b32 v30, 14, v30
    v_or_b32 v30, v30, v31
    v_cmp_ne_u32 vcc, 0, v30
    s_cmp_gt_u32 s76, 20000
    s_cbranch_scc1 L_back_s2m
    s_cbranch_vccnz L_slow_s2m
    s_branch L_back_s2m
L_slow_mpm:
    s_add_u32 s31, s31, 16777216
    s_add_u32 s76, s76, 1
    s_cmp_gt_u32 s76, 20000
    s_cbranch_scc1 L_back_mpm
    s_nop 7
    buffer_load_dwordx4 v[28:31], v16, s[12:15], 0 offen sc1
    s_waitcnt vmcnt(0)
    v_max3_u32 v27, v28, v29, v30
    v_max_u32 v27, v27, v31
    s_nop 1
    v_cmp_eq_u32 vcc, -1, v27
    s_nop 1
    s_cbranch_vccnz L_slow_mpm
    s_branch L_back_mpm
L_slow_zm:
    s_add_u32 s31, s31, 256
    s_add_u32 s76, s76, 1
    s_cmp_gt_u32 s76, 20000
    s_cbranch_scc1 L_back_zm
    s_nop 7
    s_and_b32 s0, s76, 7
    s_cbranch_scc1 L_nrsm
    s_memrealtime s[0:1]
    s_waitcnt lgkmcnt(0)
    v_mov_b32 v56, s0
    v_xor_b32 v57, 0x5bd1e995, v56
    s_lshl_b32 s0, s2, 3
    s_add_u32 s0, s0, 32768
    s_lshl_b32 s1, s2, 7
    v_and_b32 v58, 3, v2
    v_lshl_add_u32 v58, v58, 11, s0
    v_lshl_add_u32 v59, v2, 3, s1
    v_cmp_gt_u32 vcc, 16, v2
    s_nop 1
    v_cndmask_b32 v58, v58, v59, vcc
    buffer_store_dwordx2 v[56:57], v58, s[12:15], 0 offen sc1
    L_nrsm:
    buffer_load_dwordx4 v[48:51], v20, s[12:15], s73 offen sc1
    buffer_load_dwordx4 v[52:55], v21, s[12:15], s73 offen sc1
    s_waitcnt vmcnt(0)
    v_max3_u32 v27, v48, v49, v50
    v_max3_u32 v27, v27, v51, v52
    v_max3_u32 v27, v27, v53, v54
    v_max_u32 v27, v27, v55
    s_nop 1
    v_cmp_eq_u32 vcc, -1, v27
    s_nop 1
    s_cbranch_vccnz L_slow_zm
    s_branch L_back_zm
    s_endpgm
.p2align 7
.type L_ct,@object
L_ct:
    .long 0x12000000,0x9100900,0xc000400,0x3200,0x12010001,0x92c091c,0xc010402,0x13200
    .long 0x12020002,0x9480938,0xc020404,0x23201,0x12030003,0x9640954,0xc030406,0x33201
    .long 0x120800e0,0x9810971,0xc100408,0x43202,0x120900e1,0x99d098d,0xc11040a,0x53202
    .long 0x120a00e2,0x9b909a9,0xc12040c,0x63203,0x120b00e3,0x9d509c5,0xc13040e,0x73203
    .long 0x121001c0,0x9f209e2,0xc200410,0x83204,0x121101c1,0xa0e09fe,0xc210412,0x93204
    .long 0x121201c2,0xa2a0a1a,0xc220414,0xa3205,0x121301c3,0xa460a36,0xc230416,0xb3205
    .long 0x121802a0,0xa630a53,0xc300418,0xc3206,0x121902a1,0xa7f0a6f,0xc31041a,0xd3206
    .long 0x121a02a2,0xa9b0a8b,0xc32041c,0xe3207,0x121b02a3,0xab70aa7,0xc33041e,0xf3207
    .long 0x12440380,0x9140904,0xc400401,0x3803210,0x12450381,0x9300920,0xc410403,0x3813210
    .long 0x12460382,0x94c093c,0xc420405,0x3823211,0x12470383,0x9680958,0xc430407,0x3833211
    .long 0x124c0460,0x9850975,0xc500409,0x3843212,0x124d0461,0x9a10991,0xc51040b,0x3853212
    .long 0x124e0462,0x9bd09ad,0xc52040d,0x3863213,0x124f0463,0x9d909c9,0xc53040f,0x3873213
    .long 0x12540540,0x9f609e6,0xc600411,0x3883214,0x12550541,0xa120a02,0xc610413,0x3893214
    .long 0x12560542,0xa2e0a1e,0xc620415,0x38a3215,0x12570543,0xa4a0a3a,0xc630417,0x38b3215
    .long 0x125c0620,0xa670a57,0xc600419,0x38c3216,0x125d0621,0xa830a73,0xc61041b,0x38d3216
    .long 0x125e0622,0xa9f0a8f,0xc62041d,0x38e3217,0x125f0623,0xabb0aab,0xc63041f,0x38f3217
    .long 0x12800702,0x9180908,0xc700420,0x803220,0x12810703,0x9340924,0xc710422,0x813220
    .long 0x12820700,0x9500940,0xc720424,0x823221,0x12830701,0x96c095c,0xc730426,0x833221
    .long 0x128807e2,0x9890979,0xc800428,0x843222,0x128907e3,0x9a50995,0xc81042a,0x853222
    .long 0x128a07e0,0x9c109b1,0xc82042c,0x863223,0x128b07e1,0x9dd09cd,0xc83042e,0x873223
    .long 0x129008c2,0x9fa09ea,0xc900430,0x883224,0x129108c3,0xa160a06,0xc910432,0x893224
    .long 0x129208c0,0xa320a22,0xc920434,0x8a3225,0x129308c1,0xa4e0a3e,0xc930436,0x8b3225
    .long 0x129809a2,0xa6b0a5b,0xca00438,0x8c3226,0x129909a3,0xa870a77,0xca1043a,0x8d3226
    .long 0x129a09a0,0xaa30a93,0xca2043c,0x8e3227,0x129b09a1,0xabf0aaf,0xca3043e,0x8f3227
    .long 0x12c40a82,0x918090c,0xcb00421,0x4003230,0x12c50a83,0x9340928,0xcb10423,0x4013230
    .long 0x12c60a80,0x9500944,0xcb20425,0x4023231,0x12c70a81,0x96c0960,0xcb30427,0x4033231
    .long 0x12cc0b62,0x989097d,0xcc00429,0x4043232,0x12cd0b63,0x9a50999,0xcc1042b,0x4053232
    .long 0x12ce0b60,0x9c109b5,0xcc2042d,0x4063233,0x12cf0b61,0x9dd09d1,0xcc3042f,0x4073233
    .long 0x12d40c42,0x9fa09ee,0xcd00431,0x4083234,0x12d50c43,0xa160a0a,0xcd10433,0x4093234
    .long 0x12d60c40,0xa320a26,0xcd20435,0x40a3235,0x12d70c41,0xa4e0a42,0xcd30437,0x40b3235
    .long 0x12dc0d22,0xa6b0a5f,0xcd00439,0x40c3236,0x12dd0d23,0xa870a7b,0xcd1043b,0x40d3236
    .long 0x12de0d20,0xaa30a97,0xcd2043d,0x40e3237,0x12df0d21,0xabf0ab3,0xcd3043f,0x40f3237
    .long 0xce0,0x1fc0080,0x1fc,0x7000180,0x10ce1,0x2fd0081,0x1fd,0x7010181
    .long 0x40cf0,0x1fe0084,0x1fe,0x7020182,0x50cf1,0x2ff0085,0x1ff,0x7030183
    .long 0x80d00,0x2000088,0x200,0x7040184,0x90d01,0x3010089,0x201,0x7050185
    .long 0xc0d10,0x202008c,0x202,0x7060186,0xd0d11,0x303008d,0x203,0x7070187
    .long 0x100d20,0x1fd8000,0x23c,0x7080188,0x110d21,0x2fe8000,0x23d,0x7090189
    .long 0x80000d30,0x1ff8000,0x23e,0x70a018a,0x80000d31,0x3008000,0x23f,0x70b018b
    .long 0x80000d40,0x2018000,0x240,0x70c018c,0x80000d41,0x3028000,0x241,0x70d018d
    .long 0x80000d40,0x2038000,0x242,0x70e018e,0x80000d41,0x3048000,0x243,0x70f018f
    .long 0x200dc0,0x20400a0,0x204,0x7100190,0x210dc1,0x30500a1,0x205,0x7110191
    .long 0x240dd0,0x20600a4,0x206,0x7120192,0x250dd1,0x30700a5,0x207,0x7130193
    .long 0x280de0,0x20800a8,0x208,0x7140194,0x290de1,0x30900a9,0x209,0x7150195
    .long 0x2c0df0,0x20a00ac,0x20a,0x7160196,0x2d0df1,0x30b00ad,0x20b,0x7170197
    .long 0x300e00,0x20500b0,0x244,0x7180198,0x310e01,0x30600b1,0x245,0x7190199
    .long 0x340e10,0x20700b4,0x246,0x71a019a,0x350e11,0x30800b5,0x247,0x71b019b
    .long 0x380e20,0x20900b8,0x248,0x71c019c,0x390e21,0x30a00b9,0x249,0x71d019d
    .long 0x3c0e20,0x20b00bc,0x24a,0x71e019e,0x3d0e21,0x30c00bd,0x24b,0x71f019f
    .long 0x400e30,0x20c00c0,0x2020c,0x74001c0,0x410e31,0x30d00c1,0x2020d,0x74101c1
    .long 0x440e32,0x20e00c4,0x2020e,0x74201c2,0x450e33,0x30f00c5,0x2020f,0x74301c3
    .long 0x480e34,0x21000c8,0x20210,0x74401c4,0x490e35,0x31100c9,0x20211,0x74501c5
    .long 0x4c0e36,0x21200cc,0x20212,0x74601c6,0x4d0e37,0x31300cd,0x20213,0x74701c7
    .long 0x500e38,0x20d00d0,0x2024c,0x74801c8,0x510e39,0x30e00d1,0x2024d,0x74901c9
    .long 0x540e3a,0x20f00d4,0x2024e,0x74a01ca,0x550e3b,0x31000d5,0x2024f,0x74b01cb
    .long 0x580e3c,0x21100d8,0x20250,0x74c01cc,0x590e3d,0x31200d9,0x20251,0x74d01cd
    .long 0x5c0e3e,0x21300dc,0x20252,0x74e01ce,0x5d0e3f,0x31400dd,0x20253,0x74f01cf
    .long 0x600e30,0x21400e0,0x20214,0x75001d0,0x610e31,0x31500e1,0x20215,0x75101d1
    .long 0x640e32,0x21600e4,0x20216,0x75201d2,0x650e33,0x31700e5,0x20217,0x75301d3
    .long 0x680e34,0x21800e8,0x20218,0x75401d4,0x690e35,0x31900e9,0x20219,0x75501d5
    .long 0x6c0e36,0x21a00ec,0x2021a,0x75601d6,0x6d0e37,0x31b00ed,0x2021b,0x75701d7
    .long 0x700e38,0x21500f0,0x20254,0x75801d8,0x710e39,0x31600f1,0x20255,0x75901d9
    .long 0x740e3a,0x21700f4,0x20256,0x75a01da,0x750e3b,0x31800f5,0x20257,0x75b01db
    .long 0x780e3c,0x21900f8,0x20258,0x75c01dc,0x790e3d,0x31a00f9,0x20259,0x75d01dd
    .long 0x7c0e3e,0x21b00fc,0x2025a,0x75e01de,0x7d0e3f,0x31c00fd,0x2025b,0x75f01df
    .long 0x3f80,0x3f80,0x3f80,0x3f80,0x3f80,0x3dc93f7f,0x3e483f7b,0x3e953f75
    .long 0x3f80,0x3e483f7b,0x3ec43f6d,0x3f0e3f55,0x3f80,0x3e953f75,0x3f0e3f55,0x3f463f22
    .long 0x3f80,0x3ec43f6d,0x3f353f35,0x3f6d3ec4,0x3f80,0x3ef13f62,0x3f553f0e,0x3f7f3dc9
    .long 0x3f80,0x3f0e3f55,0x3f6d3ec4,0x3f7bbe48,0x3f80,0x3f223f46,0x3f7b3e48,0x3f62bef1
    .long 0x3f80,0x3f353f35,0x3f800000,0x3f35bf35,0x3f80,0x3f463f22,0x3f7bbe48,0x3ef1bf62
    .long 0x3f80,0x3f553f0e,0x3f6dbec4,0x3e48bf7b,0x3f80,0x3f623ef1,0x3f55bf0e,0xbdc9bf7f
    .long 0x3f80,0x3f6d3ec4,0x3f35bf35,0xbec4bf6d,0x3f80,0x3f753e95,0x3f0ebf55,0xbf22bf46
    .long 0x3f80,0x3f7b3e48,0x3ec4bf6d,0xbf55bf0e,0x3f80,0x3f7f3dc9,0x3e48bf7b,0xbf75be95
    .long 0x3f80,0x3f80,0x3f80,0x3f80,0x3ec43f6d,0x3ef13f62,0x3f0e3f55,0x3f223f46
    .long 0x3f353f35,0x3f553f0e,0x3f6d3ec4,0x3f7b3e48,0x3f6d3ec4,0x3f7f3dc9,0x3f7bbe48,0x3f62bef1
    .long 0x3f800000,0x3f6dbec4,0x3f35bf35,0x3ec4bf6d,0x3f6dbec4,0x3f22bf46,0x3e48bf7b,0xbe95bf75
    .long 0x3f35bf35,0x3e48bf7b,0xbec4bf6d,0xbf55bf0e,0x3ec4bf6d,0xbe95bf75,0xbf55bf0e,0xbf7f3dc9
    .long 0xbf80,0xbf35bf35,0xbf800000,0xbf353f35,0xbec4bf6d,0xbf75be95,0xbf553f0e,0xbdc93f7f
    .long 0xbf35bf35,0xbf7b3e48,0xbec43f6d,0x3f0e3f55,0xbf6dbec4,0xbf463f22,0x3e483f7b,0x3f753e95
    .long 0xbf800000,0xbec43f6d,0x3f353f35,0x3f6dbec4,0xbf6d3ec4,0x3dc93f7f,0x3f7b3e48,0x3ef1bf62
    .long 0xbf353f35,0x3f0e3f55,0x3f6dbec4,0xbe48bf7b,0xbec43f6d,0x3f623ef1,0x3f0ebf55,0xbf46bf22
    .long 0x3f80,0x3f80,0x3f80,0x3f80,0x3f353f35,0x3f463f22,0x3f553f0e,0x3f623ef1
    .long 0x3f800000,0x3f7bbe48,0x3f6dbec4,0x3f55bf0e,0x3f35bf35,0x3ef1bf62,0x3e48bf7b,0xbdc9bf7f
    .long 0xbf80,0xbec4bf6d,0xbf35bf35,0xbf6dbec4,0xbf35bf35,0xbf75be95,0xbf7b3e48,0xbf463f22
    .long 0xbf800000,0xbf553f0e,0xbec43f6d,0x3e483f7b,0xbf353f35,0xbdc93f7f,0x3f0e3f55,0x3f753e95
    .long 0x3f80,0x3f353f35,0x3f800000,0x3f35bf35,0x3f353f35,0x3f7fbdc9,0x3f0ebf55,0xbe95bf75
    .long 0x3f800000,0x3f0ebf55,0xbec4bf6d,0xbf7bbe48,0x3f35bf35,0xbe95bf75,0xbf7bbe48,0xbf223f46
    .long 0xbf80,0xbf6dbec4,0xbf353f35,0x3ec43f6d,0xbf35bf35,0xbf623ef1,0x3e483f7b,0x3f7f3dc9
    .long 0xbf800000,0xbe483f7b,0x3f6d3ec4,0x3f0ebf55,0xbf353f35,0x3f223f46,0x3f55bf0e,0xbef1bf62
    .long 0x3f80,0x3f80,0x3f80,0x3f80,0x3f6d3ec4,0x3f753e95,0x3f7b3e48,0x3f7f3dc9
    .long 0x3f35bf35,0x3f0ebf55,0x3ec4bf6d,0x3e48bf7b,0xbec4bf6d,0xbf22bf46,0xbf55bf0e,0xbf75be95
    .long 0xbf800000,0xbf6d3ec4,0xbf353f35,0xbec43f6d,0xbec43f6d,0x3dc93f7f,0x3f0e3f55,0x3f623ef1
    .long 0x3f353f35,0x3f7b3e48,0x3f6dbec4,0x3f0ebf55,0x3f6dbec4,0x3ef1bf62,0xbe48bf7b,0xbf46bf22
    .long 0xbf80,0xbf35bf35,0xbf800000,0xbf353f35,0xbf6dbec4,0xbf623ef1,0xbe483f7b,0x3f223f46
    .long 0xbf353f35,0x3e483f7b,0x3f6d3ec4,0x3f55bf0e,0x3ec43f6d,0x3f7f3dc9,0x3f0ebf55,0xbef1bf62
    .long 0x3f800000,0x3ec4bf6d,0xbf35bf35,0xbf6d3ec4,0x3ec4bf6d,0xbf46bf22,0xbf553f0e,0x3e953f75
    .long 0xbf35bf35,0xbf553f0e,0x3ec43f6d,0x3f7bbe48,0xbf6d3ec4,0x3e953f75,0x3f7bbe48,0xbdc9bf7f
    .long 0x3f80,0x3f80,0x3f80,0x3f80,0x3f800000,0x3f7fbdc9,0x3f7bbe48,0x3f75be95
    .long 0xbf80,0xbe48bf7b,0xbec4bf6d,0xbf0ebf55,0xbf800000,0xbf753e95,0xbf553f0e,0xbf223f46
    .long 0x3f80,0x3ec43f6d,0x3f353f35,0x3f6d3ec4,0x3f800000,0x3f62bef1,0x3f0ebf55,0x3dc9bf7f
    .long 0xbf80,0xbf0ebf55,0xbf6dbec4,0xbf7b3e48,0xbf800000,0xbf463f22,0xbe483f7b,0x3ef13f62
    .long 0x3f80,0x3f353f35,0x3f800000,0x3f35bf35,0x3f800000,0x3f22bf46,0xbe48bf7b,0xbf62bef1
    .long 0xbf80,0xbf55bf0e,0xbf6d3ec4,0xbe483f7b,0xbf800000,0xbef13f62,0x3f0e3f55,0x3f7fbdc9
    .long 0x3f80,0x3f6d3ec4,0x3f35bf35,0xbec4bf6d,0x3f800000,0x3e95bf75,0xbf55bf0e,0xbf463f22
    .long 0xbf80,0xbf7bbe48,0xbec43f6d,0x3f553f0e,0xbf800000,0xbdc93f7f,0x3f7b3e48,0x3e95bf75
    .long 0x3f80,0x3f80,0x3f80,0x3f80,0x3f6dbec4,0x3f62bef1,0x3f55bf0e,0x3f46bf22
    .long 0xbf35bf35,0xbf55bf0e,0xbf6dbec4,0xbf7bbe48,0xbec43f6d,0xbdc93f7f,0x3e483f7b,0x3ef13f62
    .long 0x3f800000,0x3f6dbec4,0x3f35bf35,0x3ec4bf6d,0xbec4bf6d,0xbf46bf22,0xbf7bbe48,0xbf753e95
    .long 0xbf353f35,0xbe483f7b,0x3ec43f6d,0x3f553f0e,0x3f6d3ec4,0x3f75be95,0x3f0ebf55,0xbdc9bf7f
    .long 0xbf80,0xbf35bf35,0xbf800000,0xbf353f35,0xbf6d3ec4,0xbe953f75,0x3f0e3f55,0x3f7f3dc9
    .long 0x3f353f35,0x3f7bbe48,0x3ec4bf6d,0xbf0ebf55,0x3ec4bf6d,0xbf22bf46,0xbf7b3e48,0xbe953f75
    .long 0xbf800000,0xbec43f6d,0x3f353f35,0x3f6dbec4,0x3ec43f6d,0x3f7fbdc9,0x3e48bf7b,0xbf62bef1
    .long 0x3f35bf35,0xbf0ebf55,0xbf6d3ec4,0x3e483f7b,0xbf6dbec4,0xbef13f62,0x3f553f0e,0x3f22bf46
    .long 0x3f80,0x3f80,0x3f80,0x3f80,0x3f35bf35,0x3f22bf46,0x3f0ebf55,0x3ef1bf62
    .long 0xbf800000,0xbf7b3e48,0xbf6d3ec4,0xbf553f0e,0x3f353f35,0x3f623ef1,0x3f7b3e48,0x3f7fbdc9
    .long 0xbf80,0xbec4bf6d,0xbf35bf35,0xbf6dbec4,0xbf353f35,0xbe953f75,0x3e483f7b,0x3f223f46
    .long 0x3f800000,0x3f55bf0e,0x3ec4bf6d,0xbe48bf7b,0xbf35bf35,0xbf7fbdc9,0xbf553f0e,0xbe953f75
    .long 0x3f80,0x3f353f35,0x3f800000,0x3f35bf35,0x3f35bf35,0xbdc9bf7f,0xbf55bf0e,0xbf753e95
    .long 0xbf800000,0xbf0e3f55,0x3ec43f6d,0x3f7b3e48,0x3f353f35,0x3f75be95,0x3e48bf7b,0xbf46bf22
    .long 0xbf80,0xbf6dbec4,0xbf353f35,0x3ec43f6d,0xbf353f35,0x3ef13f62,0x3f7bbe48,0x3dc9bf7f
    .long 0x3f800000,0x3e48bf7b,0xbf6dbec4,0xbf0e3f55,0xbf35bf35,0xbf463f22,0x3f0e3f55,0x3f62bef1
    .long 0x3f80,0x3f80,0x3f80,0x3f80,0x3ec4bf6d,0x3e95bf75,0x3e48bf7b,0x3dc9bf7f
    .long 0xbf353f35,0xbf0e3f55,0xbec43f6d,0xbe483f7b,0x3f6dbec4,0x3f46bf22,0x3f0ebf55,0x3e95bf75
    .long 0xbf800000,0xbf6d3ec4,0xbf353f35,0xbec43f6d,0x3f6d3ec4,0x3f7fbdc9,0x3f55bf0e,0x3ef1bf62
    .long 0xbf35bf35,0xbf7bbe48,0xbf6d3ec4,0xbf0e3f55,0x3ec43f6d,0x3f623ef1,0x3f7bbe48,0x3f22bf46
    .long 0xbf80,0xbf35bf35,0xbf800000,0xbf353f35,0xbec43f6d,0x3ef13f62,0x3f7b3e48,0x3f46bf22
    .long 0x3f35bf35,0xbe48bf7b,0xbf6dbec4,0xbf553f0e,0xbf6d3ec4,0xbdc93f7f,0x3f553f0e,0x3f62bef1
    .long 0x3f800000,0x3ec4bf6d,0xbf35bf35,0xbf6d3ec4,0xbf6dbec4,0xbf223f46,0x3f0e3f55,0x3f75be95
    .long 0x3f353f35,0x3f55bf0e,0xbec4bf6d,0xbf7b3e48,0xbec4bf6d,0xbf753e95,0x3e483f7b,0x3f7fbdc9
    .long 0x3f803f80,0x3f803f80,0x3f803f80,0x3f803f80,0xbf803f80,0x3f353f35,0x3f6d3f6d,0x3ec43ec4
    .long 0x3f803f80,0x0,0x3f353f35,0xbf35bf35,0xbf803f80,0xbf35bf35,0x3ec43ec4,0xbf6dbf6d
    .long 0x3f803f80,0xbf80bf80,0x0,0x0,0xbf803f80,0xbf35bf35,0xbec4bec4,0x3f6d3f6d
    .long 0x3f803f80,0x0,0xbf35bf35,0x3f353f35,0xbf803f80,0x3f353f35,0xbf6dbf6d,0xbec4bec4
    .long 0x3f803f80,0x3f803f80,0xbf80bf80,0xbf80bf80,0xbf803f80,0x3f353f35,0xbf6dbf6d,0xbec4bec4
    .long 0x3f803f80,0x0,0xbf35bf35,0x3f353f35,0xbf803f80,0xbf35bf35,0xbec4bec4,0x3f6d3f6d
    .long 0x3f803f80,0xbf80bf80,0x0,0x0,0xbf803f80,0xbf35bf35,0x3ec43ec4,0xbf6dbf6d
    .long 0x3f803f80,0x0,0x3f353f35,0xbf35bf35,0xbf803f80,0x3f353f35,0x3f6d3f6d,0x3ec43ec4
    .long 0x3f803f80,0x3f803f80,0x3f803f80,0x3f803f80,0x0,0xbf35bf35,0xbec4bec4,0xbf6dbf6d
    .long 0xbf80bf80,0x0,0xbf35bf35,0x3f353f35,0x0,0x3f353f35,0x3f6d3f6d,0xbec4bec4
    .long 0x3f803f80,0xbf80bf80,0x0,0x0,0x0,0x3f353f35,0xbf6dbf6d,0x3ec43ec4
    .long 0xbf80bf80,0x0,0x3f353f35,0xbf35bf35,0x0,0xbf35bf35,0x3ec43ec4,0x3f6d3f6d
    .long 0x3f803f80,0x3f803f80,0xbf80bf80,0xbf80bf80,0x0,0xbf35bf35,0x3ec43ec4,0x3f6d3f6d
    .long 0xbf80bf80,0x0,0x3f353f35,0xbf35bf35,0x0,0x3f353f35,0xbf6dbf6d,0x3ec43ec4
    .long 0x3f803f80,0xbf80bf80,0x0,0x0,0x0,0x3f353f35,0x3f6d3f6d,0xbec4bec4
    .long 0xbf80bf80,0x0,0xbf35bf35,0x3f353f35,0x0,0xbf35bf35,0xbec4bec4,0xbf6dbf6d
    .long 0x3f803f80,0x3f803f80,0x3f803f80,0x3f803f80,0x3f7b3f7b,0x3f0e3f0e,0x3f553f55,0x3e483e48
    .long 0x3f6d3f6d,0xbec4bec4,0x3ec43ec4,0xbf6dbf6d,0x3f553f55,0xbf7bbf7b,0xbe48be48,0xbf0ebf0e
    .long 0x3f353f35,0xbf35bf35,0xbf35bf35,0x3f353f35,0x3f0e3f0e,0x3e483e48,0xbf7bbf7b,0x3f553f55
    .long 0x3ec43ec4,0x3f6d3f6d,0xbf6dbf6d,0xbec4bec4,0x3e483e48,0x3f553f55,0xbf0ebf0e,0xbf7bbf7b
    .long 0x0,0x0,0x0,0x0,0xbe48be48,0xbf55bf55,0x3f0e3f0e,0x3f7b3f7b
    .long 0xbec4bec4,0xbf6dbf6d,0x3f6d3f6d,0x3ec43ec4,0xbf0ebf0e,0xbe48be48,0x3f7b3f7b,0xbf55bf55
    .long 0xbf35bf35,0x3f353f35,0x3f353f35,0xbf35bf35,0xbf55bf55,0x3f7b3f7b,0x3e483e48,0x3f0e3f0e
    .long 0xbf6dbf6d,0x3ec43ec4,0xbec4bec4,0x3f6d3f6d,0xbf7bbf7b,0xbf0ebf0e,0xbf55bf55,0xbe48be48
    .long 0x3f803f80,0x3f803f80,0x3f803f80,0x3f803f80,0xbe48be48,0xbf55bf55,0xbf0ebf0e,0xbf7bbf7b
    .long 0xbf6dbf6d,0x3ec43ec4,0xbec4bec4,0x3f6d3f6d,0x3f0e3f0e,0x3e483e48,0x3f7b3f7b,0xbf55bf55
    .long 0x3f353f35,0xbf35bf35,0xbf35bf35,0x3f353f35,0xbf55bf55,0x3f7b3f7b,0xbe48be48,0xbf0ebf0e
    .long 0xbec4bec4,0xbf6dbf6d,0x3f6d3f6d,0x3ec43ec4,0x3f7b3f7b,0x3f0e3f0e,0xbf55bf55,0xbe48be48
    .long 0x0,0x0,0x0,0x0,0xbf7bbf7b,0xbf0ebf0e,0x3f553f55,0x3e483e48
    .long 0x3ec43ec4,0x3f6d3f6d,0xbf6dbf6d,0xbec4bec4,0x3f553f55,0xbf7bbf7b,0x3e483e48,0x3f0e3f0e
    .long 0xbf35bf35,0x3f353f35,0x3f353f35,0xbf35bf35,0xbf0ebf0e,0xbe48be48,0xbf7bbf7b,0x3f553f55
    .long 0x3f6d3f6d,0xbec4bec4,0x3ec43ec4,0xbf6dbf6d,0x3e483e48,0x3f553f55,0x3f0e3f0e,0x3f7b3f7b
    .long 0x8000,0x8000,0x8000,0x8000,0x8000,0x3f35bf35,0x3ec4bec4,0x3f6dbf6d
    .long 0x8000,0x3f80bf80,0x3f35bf35,0x3f35bf35,0x8000,0x3f35bf35,0x3f6dbf6d,0xbec43ec4
    .long 0x8000,0x8000,0x3f80bf80,0xbf803f80,0x8000,0xbf353f35,0x3f6dbf6d,0xbec43ec4
    .long 0x8000,0xbf803f80,0x3f35bf35,0x3f35bf35,0x8000,0xbf353f35,0x3ec4bec4,0x3f6dbf6d
    .long 0x8000,0x8000,0x8000,0x8000,0x8000,0x3f35bf35,0xbec43ec4,0xbf6d3f6d
    .long 0x8000,0x3f80bf80,0xbf353f35,0xbf353f35,0x8000,0x3f35bf35,0xbf6d3f6d,0x3ec4bec4
    .long 0x8000,0x8000,0xbf803f80,0x3f80bf80,0x8000,0xbf353f35,0xbf6d3f6d,0x3ec4bec4
    .long 0x8000,0xbf803f80,0xbf353f35,0xbf353f35,0x8000,0xbf353f35,0xbec43ec4,0xbf6d3f6d
    .long 0x8000,0x8000,0x8000,0x8000,0x3f80bf80,0x3f35bf35,0x3f6dbf6d,0x3ec4bec4
    .long 0x8000,0xbf803f80,0xbf353f35,0xbf353f35,0xbf803f80,0x3f35bf35,0xbec43ec4,0x3f6dbf6d
    .long 0x8000,0x8000,0x3f80bf80,0xbf803f80,0x3f80bf80,0xbf353f35,0xbec43ec4,0x3f6dbf6d
    .long 0x8000,0x3f80bf80,0xbf353f35,0xbf353f35,0xbf803f80,0xbf353f35,0x3f6dbf6d,0x3ec4bec4
    .long 0x8000,0x8000,0x8000,0x8000,0x3f80bf80,0x3f35bf35,0xbf6d3f6d,0xbec43ec4
    .long 0x8000,0xbf803f80,0x3f35bf35,0x3f35bf35,0xbf803f80,0x3f35bf35,0x3ec4bec4,0xbf6d3f6d
    .long 0x8000,0x8000,0xbf803f80,0x3f80bf80,0x3f80bf80,0xbf353f35,0x3ec4bec4,0xbf6d3f6d
    .long 0x8000,0x3f80bf80,0x3f35bf35,0x3f35bf35,0xbf803f80,0xbf353f35,0xbf6d3f6d,0xbec43ec4
    .long 0x8000,0x8000,0x8000,0x8000,0x3e48be48,0x3f55bf55,0x3f0ebf0e,0x3f7bbf7b
    .long 0x3ec4bec4,0x3f6dbf6d,0x3f6dbf6d,0x3ec4bec4,0x3f0ebf0e,0x3e48be48,0x3f7bbf7b,0xbf553f55
    .long 0x3f35bf35,0xbf353f35,0x3f35bf35,0xbf353f35,0x3f55bf55,0xbf7b3f7b,0x3e48be48,0x3f0ebf0e
    .long 0x3f6dbf6d,0xbec43ec4,0xbec43ec4,0x3f6dbf6d,0x3f7bbf7b,0x3f0ebf0e,0xbf553f55,0xbe483e48
    .long 0x3f80bf80,0x3f80bf80,0xbf803f80,0xbf803f80,0x3f7bbf7b,0x3f0ebf0e,0xbf553f55,0xbe483e48
    .long 0x3f6dbf6d,0xbec43ec4,0xbec43ec4,0x3f6dbf6d,0x3f55bf55,0xbf7b3f7b,0x3e48be48,0x3f0ebf0e
    .long 0x3f35bf35,0xbf353f35,0x3f35bf35,0xbf353f35,0x3f0ebf0e,0x3e48be48,0x3f7bbf7b,0xbf553f55
    .long 0x3ec4bec4,0x3f6dbf6d,0x3f6dbf6d,0x3ec4bec4,0x3e48be48,0x3f55bf55,0x3f0ebf0e,0x3f7bbf7b
    .long 0x8000,0x8000,0x8000,0x8000,0x3f7bbf7b,0x3f0ebf0e,0x3f55bf55,0x3e48be48
    .long 0xbec43ec4,0xbf6d3f6d,0xbf6d3f6d,0xbec43ec4,0xbf553f55,0x3f7bbf7b,0x3e48be48,0x3f0ebf0e
    .long 0x3f35bf35,0xbf353f35,0x3f35bf35,0xbf353f35,0x3f0ebf0e,0x3e48be48,0xbf7b3f7b,0x3f55bf55
    .long 0xbf6d3f6d,0x3ec4bec4,0x3ec4bec4,0xbf6d3f6d,0xbe483e48,0xbf553f55,0x3f0ebf0e,0x3f7bbf7b
    .long 0x3f80bf80,0x3f80bf80,0xbf803f80,0xbf803f80,0xbe483e48,0xbf553f55,0x3f0ebf0e,0x3f7bbf7b
    .long 0xbf6d3f6d,0x3ec4bec4,0x3ec4bec4,0xbf6d3f6d,0x3f0ebf0e,0x3e48be48,0xbf7b3f7b,0x3f55bf55
    .long 0x3f35bf35,0xbf353f35,0x3f35bf35,0xbf353f35,0xbf553f55,0x3f7bbf7b,0x3e48be48,0x3f0ebf0e
    .long 0xbec43ec4,0xbf6d3f6d,0xbf6d3f6d,0xbec43ec4,0x3f7bbf7b,0x3f0ebf0e,0x3f55bf55,0x3e48be48
    .long 0x21800000,0x10d010c0,0xc040500,0x1005100,0x21810001,0x10ec10dc,0xc050502,0x1015100
    .long 0x21820002,0x110810f8,0xc060504,0x1025101,0x21830003,0x11241114,0xc070506,0x1035101
    .long 0x218800e0,0x11411131,0xc140508,0x1045102,0x218900e1,0x115d114d,0xc15050a,0x1055102
    .long 0x218a00e2,0x11791169,0xc16050c,0x1065103,0x218b00e3,0x11951185,0xc17050e,0x1075103
    .long 0x219001c0,0x11b211a2,0xc240510,0x1085104,0x219101c1,0x11ce11be,0xc250512,0x1095104
    .long 0x219201c2,0x11ea11da,0xc260514,0x10a5105,0x219301c3,0x120611f6,0xc270516,0x10b5105
    .long 0x219802a0,0x12231213,0xc340518,0x10c5106,0x219902a1,0x123f122f,0xc35051a,0x10d5106
    .long 0x219a02a2,0x125b124b,0xc36051c,0x10e5107,0x219b02a3,0x12771267,0xc37051e,0x10f5107
    .long 0x21c40380,0x10d410c4,0xc440501,0x4805110,0x21c50381,0x10f010e0,0xc450503,0x4815110
    .long 0x21c60382,0x110c10fc,0xc460505,0x4825111,0x21c70383,0x11281118,0xc470507,0x4835111
    .long 0x21cc0460,0x11451135,0xc540509,0x4845112,0x21cd0461,0x11611151,0xc55050b,0x4855112
    .long 0x21ce0462,0x117d116d,0xc56050d,0x4865113,0x21cf0463,0x11991189,0xc57050f,0x4875113
    .long 0x21d40540,0x11b611a6,0xc640511,0x4885114,0x21d50541,0x11d211c2,0xc650513,0x4895114
    .long 0x21d60542,0x11ee11de,0xc660515,0x48a5115,0x21d70543,0x120a11fa,0xc670517,0x48b5115
    .long 0x21dc0620,0x12271217,0xc640519,0x48c5116,0x21dd0621,0x12431233,0xc65051b,0x48d5116
    .long 0x21de0622,0x125f124f,0xc66051d,0x48e5117,0x21df0623,0x127b126b,0xc67051f,0x48f5117
    .long 0x22000702,0x10d810c8,0xc740520,0x1805120,0x22010703,0x10f410e4,0xc750522,0x1815120
    .long 0x22020700,0x11101100,0xc760524,0x1825121,0x22030701,0x112c111c,0xc770526,0x1835121
    .long 0x220807e2,0x11491139,0xc840528,0x1845122,0x220907e3,0x11651155,0xc85052a,0x1855122
    .long 0x220a07e0,0x11811171,0xc86052c,0x1865123,0x220b07e1,0x119d118d,0xc87052e,0x1875123
    .long 0x221008c2,0x11ba11aa,0xc940530,0x1885124,0x221108c3,0x11d611c6,0xc950532,0x1895124
    .long 0x221208c0,0x11f211e2,0xc960534,0x18a5125,0x221308c1,0x120e11fe,0xc970536,0x18b5125
    .long 0x221809a2,0x122b121b,0xca40538,0x18c5126,0x221909a3,0x12471237,0xca5053a,0x18d5126
    .long 0x221a09a0,0x12631253,0xca6053c,0x18e5127,0x221b09a1,0x127f126f,0xca7053e,0x18f5127
    .long 0x22440a82,0x10d810cc,0xcb40521,0x5005130,0x22450a83,0x10f410e8,0xcb50523,0x5015130
    .long 0x22460a80,0x11101104,0xcb60525,0x5025131,0x22470a81,0x112c1120,0xcb70527,0x5035131
    .long 0x224c0b62,0x1149113d,0xcc40529,0x5045132,0x224d0b63,0x11651159,0xcc5052b,0x5055132
    .long 0x224e0b60,0x11811175,0xcc6052d,0x5065133,0x224f0b61,0x119d1191,0xcc7052f,0x5075133
    .long 0x22540c42,0x11ba11ae,0xcd40531,0x5085134,0x22550c43,0x11d611ca,0xcd50533,0x5095134
    .long 0x22560c40,0x11f211e6,0xcd60535,0x50a5135,0x22570c41,0x120e1202,0xcd70537,0x50b5135
    .long 0x225c0d22,0x122b121f,0xcd40539,0x50c5136,0x225d0d23,0x1247123b,0xcd5053b,0x50d5136
    .long 0x225e0d20,0x12631257,0xcd6053d,0x50e5137,0x225f0d21,0x127f1273,0xcd7053f,0x50f5137
    .long 0x1000ea0,0x23c0180,0x401fc,0x7800200,0x1010ea1,0x33d0181,0x401fd,0x7810201
    .long 0x1040ea2,0x23e0184,0x401fe,0x7820202,0x1050ea3,0x33f0185,0x401ff,0x7830203
    .long 0x1080ea4,0x2400188,0x40200,0x7840204,0x1090ea5,0x3410189,0x40201,0x7850205
    .long 0x10c0ea6,0x242018c,0x40202,0x7860206,0x10d0ea7,0x343018d,0x40203,0x7870207
    .long 0x80000ea8,0x23d8000,0x4023c,0x7880208,0x80000ea9,0x33e8000,0x4023d,0x7890209
    .long 0x80000eaa,0x23f8000,0x4023e,0x78a020a,0x80000eab,0x3408000,0x4023f,0x78b020b
    .long 0x80000eac,0x2418000,0x40240,0x78c020c,0x80000ead,0x3428000,0x40241,0x78d020d
    .long 0x80000eae,0x2438000,0x40242,0x78e020e,0x80000eaf,0x3448000,0x40243,0x78f020f
    .long 0x1200eb0,0x24401a0,0x40204,0x7900210,0x1210eb1,0x34501a1,0x40205,0x7910211
    .long 0x1240eb2,0x24601a4,0x40206,0x7920212,0x1250eb3,0x34701a5,0x40207,0x7930213
    .long 0x1280eb4,0x24801a8,0x40208,0x7940214,0x1290eb5,0x34901a9,0x40209,0x7950215
    .long 0x12c0eb6,0x24a01ac,0x4020a,0x7960216,0x12d0eb7,0x34b01ad,0x4020b,0x7970217
    .long 0x1300eb8,0x24501b0,0x40244,0x7980218,0x1310eb9,0x34601b1,0x40245,0x7990219
    .long 0x1340eba,0x24701b4,0x40246,0x79a021a,0x1350ebb,0x34801b5,0x40247,0x79b021b
    .long 0x1380ebc,0x24901b8,0x40248,0x79c021c,0x1390ebd,0x34a01b9,0x40249,0x79d021d
    .long 0x13c0ebe,0x24b01bc,0x4024a,0x79e021e,0x13d0ebf,0x34c01bd,0x4024b,0x79f021f
    .long 0x1400ec0,0x24c01c0,0x6020c,0x7c00240,0x1410ec1,0x34d01c1,0x6020d,0x7c10241
    .long 0x1440ec2,0x24e01c4,0x6020e,0x7c20242,0x1450ec3,0x34f01c5,0x6020f,0x7c30243
    .long 0x1480ec4,0x25001c8,0x60210,0x7c40244,0x1490ec5,0x35101c9,0x60211,0x7c50245
    .long 0x14c0ec6,0x25201cc,0x60212,0x7c60246,0x14d0ec7,0x35301cd,0x60213,0x7c70247
    .long 0x1500ec8,0x24d01d0,0x6024c,0x7c80248,0x1510ec9,0x34e01d1,0x6024d,0x7c90249
    .long 0x1540eca,0x24f01d4,0x6024e,0x7ca024a,0x1550ecb,0x35001d5,0x6024f,0x7cb024b
    .long 0x1580ecc,0x25101d8,0x60250,0x7cc024c,0x1590ecd,0x35201d9,0x60251,0x7cd024d
    .long 0x15c0ece,0x25301dc,0x60252,0x7ce024e,0x15d0ecf,0x35401dd,0x60253,0x7cf024f
    .long 0x1600ed0,0x25401e0,0x60214,0x7d00250,0x1610ed1,0x35501e1,0x60215,0x7d10251
    .long 0x1640ed2,0x25601e4,0x60216,0x7d20252,0x1650ed3,0x35701e5,0x60217,0x7d30253
    .long 0x1680ed4,0x25801e8,0x60218,0x7d40254,0x1690ed5,0x35901e9,0x60219,0x7d50255
    .long 0x16c0ed6,0x25a01ec,0x6021a,0x7d60256,0x16d0ed7,0x35b01ed,0x6021b,0x7d70257
    .long 0x1700ed7,0x25501f0,0x60254,0x7d80258,0x1710ed7,0x35601f1,0x60255,0x7d90259
    .long 0x1740ed7,0x25701f4,0x60256,0x7da025a,0x1750ed7,0x35801f5,0x60257,0x7db025b
    .long 0x1780ed7,0x25901f8,0x60258,0x7dc025c,0x1790ed7,0x35a01f9,0x60259,0x7dd025d
    .long 0x17c0ed7,0x25b01fc,0x6025a,0x7de025e,0x17d0ed7,0x35c01fd,0x6025b,0x7df025f
    .long 0x3f80,0x3f800000,0xbf80,0xbf800000,0x3f80,0x3f7fbdc9,0xbe48bf7b,0xbf753e95
    .long 0x3f80,0x3f7bbe48,0xbec4bf6d,0xbf553f0e,0x3f80,0x3f75be95,0xbf0ebf55,0xbf223f46
    .long 0x3f80,0x3f6dbec4,0xbf35bf35,0xbec43f6d,0x3f80,0x3f62bef1,0xbf55bf0e,0xbdc93f7f
    .long 0x3f80,0x3f55bf0e,0xbf6dbec4,0x3e483f7b,0x3f80,0x3f46bf22,0xbf7bbe48,0x3ef13f62
    .long 0x3f80,0x3f35bf35,0xbf800000,0x3f353f35,0x3f80,0x3f22bf46,0xbf7b3e48,0x3f623ef1
    .long 0x3f80,0x3f0ebf55,0xbf6d3ec4,0x3f7b3e48,0x3f80,0x3ef1bf62,0xbf553f0e,0x3f7fbdc9
    .long 0x3f80,0x3ec4bf6d,0xbf353f35,0x3f6dbec4,0x3f80,0x3e95bf75,0xbf0e3f55,0x3f46bf22
    .long 0x3f80,0x3e48bf7b,0xbec43f6d,0x3f0ebf55,0x3f80,0x3dc9bf7f,0xbe483f7b,0x3e95bf75
    .long 0x3f80,0x3f800000,0xbf80,0xbf800000,0x3ec43f6d,0x3f62bef1,0xbf0ebf55,0xbf463f22
    .long 0x3f353f35,0x3f0ebf55,0xbf6dbec4,0xbe483f7b,0x3f6d3ec4,0x3dc9bf7f,0xbf7b3e48,0x3ef13f62
    .long 0x3f800000,0xbec4bf6d,0xbf353f35,0x3f6d3ec4,0x3f6dbec4,0xbf46bf22,0xbe483f7b,0x3f75be95
    .long 0x3f35bf35,0xbf7bbe48,0x3ec43f6d,0x3f0ebf55,0x3ec4bf6d,0xbf753e95,0x3f553f0e,0xbdc9bf7f
    .long 0xbf80,0xbf353f35,0x3f800000,0xbf35bf35,0xbec4bf6d,0xbe953f75,0x3f55bf0e,0xbf7fbdc9
    .long 0xbf35bf35,0x3e483f7b,0x3ec4bf6d,0xbf553f0e,0xbf6dbec4,0x3f223f46,0xbe48bf7b,0xbe953f75
    .long 0xbf800000,0x3f6d3ec4,0xbf35bf35,0x3ec43f6d,0xbf6d3ec4,0x3f7fbdc9,0xbf7bbe48,0x3f623ef1
    .long 0xbf353f35,0x3f55bf0e,0xbf6d3ec4,0x3f7bbe48,0xbec43f6d,0x3ef1bf62,0xbf0e3f55,0x3f22bf46
    .long 0x3f80,0x3f800000,0xbf80,0xbf800000,0x3f353f35,0x3f22bf46,0xbf55bf0e,0xbef13f62
    .long 0x3f800000,0xbe48bf7b,0xbf6d3ec4,0x3f0e3f55,0x3f35bf35,0xbf62bef1,0xbe483f7b,0x3f7fbdc9
    .long 0xbf80,0xbf6d3ec4,0x3f353f35,0x3ec4bf6d,0xbf35bf35,0xbe953f75,0x3f7bbe48,0xbf22bf46
    .long 0xbf800000,0x3f0e3f55,0x3ec4bf6d,0xbf7b3e48,0xbf353f35,0x3f7f3dc9,0xbf0ebf55,0xbe953f75
    .long 0x3f80,0x3f35bf35,0xbf800000,0x3f353f35,0x3f353f35,0xbdc9bf7f,0xbf0e3f55,0x3f75be95
    .long 0x3f800000,0xbf55bf0e,0x3ec43f6d,0x3e48bf7b,0x3f35bf35,0xbf753e95,0x3f7b3e48,0xbf46bf22
    .long 0xbf80,0xbec43f6d,0x3f35bf35,0xbf6d3ec4,0xbf35bf35,0x3ef13f62,0xbe48bf7b,0xbdc93f7f
    .long 0xbf800000,0x3f7b3e48,0xbf6dbec4,0x3f553f0e,0xbf353f35,0x3f46bf22,0xbf553f0e,0x3f62bef1
    .long 0x3f80,0x3f800000,0xbf80,0xbf800000,0x3f6d3ec4,0x3e95bf75,0xbf7bbe48,0xbdc93f7f
    .long 0x3f35bf35,0xbf55bf0e,0xbec43f6d,0x3f7b3e48,0xbec4bf6d,0xbf463f22,0x3f553f0e,0x3e95bf75
    .long 0xbf800000,0x3ec43f6d,0x3f35bf35,0xbf6dbec4,0xbec43f6d,0x3f7fbdc9,0xbf0ebf55,0xbef13f62
    .long 0x3f353f35,0x3e48bf7b,0xbf6d3ec4,0x3f553f0e,0x3f6dbec4,0xbf62bef1,0x3e483f7b,0x3f22bf46
    .long 0xbf80,0xbf353f35,0x3f800000,0xbf35bf35,0xbf6dbec4,0x3ef13f62,0x3e48bf7b,0xbf463f22
    .long 0xbf353f35,0x3f7bbe48,0xbf6dbec4,0x3f0e3f55,0x3ec43f6d,0x3dc9bf7f,0xbf0e3f55,0x3f62bef1
    .long 0x3f800000,0xbf6dbec4,0x3f353f35,0xbec4bf6d,0x3ec4bf6d,0xbf223f46,0x3f55bf0e,0xbf753e95
    .long 0xbf35bf35,0x3f0e3f55,0xbec4bf6d,0x3e483f7b,0xbf6d3ec4,0x3f75be95,0xbf7b3e48,0x3f7fbdc9
    .long 0x3f80,0x3f800000,0xbf80,0xbf800000,0x3f800000,0xbdc9bf7f,0xbf7b3e48,0x3e953f75
    .long 0xbf80,0xbf7b3e48,0x3ec43f6d,0x3f55bf0e,0xbf800000,0x3e953f75,0x3f55bf0e,0xbf46bf22
    .long 0x3f80,0x3f6dbec4,0xbf35bf35,0xbec43f6d,0x3f800000,0xbef1bf62,0xbf0e3f55,0x3f7f3dc9
    .long 0xbf80,0xbf553f0e,0x3f6d3ec4,0xbe48bf7b,0xbf800000,0x3f223f46,0x3e48bf7b,0xbf623ef1
    .long 0x3f80,0x3f35bf35,0xbf800000,0x3f353f35,0x3f800000,0xbf46bf22,0x3e483f7b,0x3ef1bf62
    .long 0xbf80,0xbf0e3f55,0x3f6dbec4,0xbf7bbe48,0xbf800000,0x3f623ef1,0xbf0ebf55,0x3dc93f7f
    .long 0x3f80,0x3ec4bf6d,0xbf353f35,0x3f6dbec4,0x3f800000,0xbf75be95,0x3f553f0e,0xbf22bf46
    .long 0xbf80,0xbe483f7b,0x3ec4bf6d,0xbf0e3f55,0xbf800000,0x3f7f3dc9,0xbf7bbe48,0x3f753e95
    .long 0x3f80,0x3f800000,0xbf80,0xbf800000,0x3f6dbec4,0xbef1bf62,0xbf553f0e,0x3f223f46
    .long 0xbf35bf35,0xbf0e3f55,0x3f6d3ec4,0x3e48bf7b,0xbec43f6d,0x3f7f3dc9,0xbe48bf7b,0xbf623ef1
    .long 0x3f800000,0xbec4bf6d,0xbf353f35,0x3f6d3ec4,0xbec4bf6d,0xbf223f46,0x3f7b3e48,0xbe95bf75
    .long 0xbf353f35,0x3f7b3e48,0xbec4bf6d,0xbf0e3f55,0x3f6d3ec4,0xbe95bf75,0xbf0e3f55,0x3f7fbdc9
    .long 0xbf80,0xbf353f35,0x3f800000,0xbf35bf35,0xbf6d3ec4,0x3f753e95,0xbf0ebf55,0xbdc93f7f
    .long 0x3f353f35,0xbe48bf7b,0xbec43f6d,0x3f55bf0e,0x3ec4bf6d,0xbf463f22,0x3f7bbe48,0xbf75be95
    .long 0xbf800000,0x3f6d3ec4,0xbf35bf35,0x3ec43f6d,0x3ec43f6d,0xbdc9bf7f,0xbe483f7b,0x3ef1bf62
    .long 0x3f35bf35,0xbf553f0e,0x3f6dbec4,0xbf7b3e48,0xbf6dbec4,0x3f623ef1,0xbf55bf0e,0x3f463f22
    .long 0x3f80,0x3f800000,0xbf80,0xbf800000,0x3f35bf35,0xbf46bf22,0xbf0e3f55,0x3f623ef1
    .long 0xbf800000,0x3e483f7b,0x3f6dbec4,0xbf0ebf55,0x3f353f35,0x3ef1bf62,0xbf7bbe48,0x3dc93f7f
    .long 0xbf80,0xbf6d3ec4,0x3f353f35,0x3ec4bf6d,0xbf353f35,0x3f753e95,0xbe48bf7b,0xbf463f22
    .long 0x3f800000,0xbf0ebf55,0xbec43f6d,0x3f7bbe48,0xbf35bf35,0xbdc93f7f,0x3f55bf0e,0xbf75be95
    .long 0x3f80,0x3f35bf35,0xbf800000,0x3f353f35,0x3f35bf35,0xbf7f3dc9,0x3f553f0e,0xbe95bf75
    .long 0xbf800000,0x3f553f0e,0xbec4bf6d,0xbe483f7b,0x3f353f35,0xbe95bf75,0xbe483f7b,0x3f22bf46
    .long 0xbf80,0xbec43f6d,0x3f35bf35,0xbf6d3ec4,0xbf353f35,0x3f62bef1,0xbf7b3e48,0x3f7f3dc9
    .long 0x3f800000,0xbf7bbe48,0x3f6d3ec4,0xbf55bf0e,0xbf35bf35,0x3f223f46,0xbf0ebf55,0x3ef13f62
    .long 0x3f80,0x3f800000,0xbf80,0xbf800000,0x3ec4bf6d,0xbf75be95,0xbe483f7b,0x3f7f3dc9
    .long 0xbf353f35,0x3f553f0e,0x3ec4bf6d,0xbf7bbe48,0x3f6dbec4,0xbf22bf46,0xbf0e3f55,0x3f753e95
    .long 0xbf800000,0x3ec43f6d,0x3f35bf35,0xbf6dbec4,0x3f6d3ec4,0xbdc9bf7f,0xbf553f0e,0x3f623ef1
    .long 0xbf35bf35,0xbe483f7b,0x3f6dbec4,0xbf55bf0e,0x3ec43f6d,0x3ef1bf62,0xbf7b3e48,0x3f463f22
    .long 0xbf80,0xbf353f35,0x3f800000,0xbf35bf35,0xbec43f6d,0x3f62bef1,0xbf7bbe48,0x3f223f46
    .long 0x3f35bf35,0xbf7b3e48,0x3f6d3ec4,0xbf0ebf55,0xbf6d3ec4,0x3f7f3dc9,0xbf55bf0e,0x3ef13f62
    .long 0x3f800000,0xbf6dbec4,0x3f353f35,0xbec4bf6d,0xbf6dbec4,0x3f463f22,0xbf0ebf55,0x3e953f75
    .long 0x3f353f35,0xbf0ebf55,0x3ec43f6d,0xbe48bf7b,0xbec4bf6d,0x3e953f75,0xbe48bf7b,0x3dc93f7f
    .long 0x3f803f80,0x3f803f80,0x3f803f80,0x3f803f80,0x3f7f3f7f,0x3f223f22,0x3f623f62,0x3e953e95
    .long 0x3f7b3f7b,0xbe48be48,0x3f0e3f0e,0xbf55bf55,0x3f753f75,0xbf62bf62,0x3dc93dc9,0xbf46bf46
    .long 0x3f6d3f6d,0xbf6dbf6d,0xbec4bec4,0x3ec43ec4,0x3f623f62,0xbe95be95,0xbf46bf46,0x3f7f3f7f
    .long 0x3f553f55,0x3f0e3f0e,0xbf7bbf7b,0x3e483e48,0x3f463f46,0x3f7f3f7f,0xbf75bf75,0xbf62bf62
    .long 0x3f353f35,0x3f353f35,0xbf35bf35,0xbf35bf35,0x3f223f22,0xbdc9bdc9,0xbe95be95,0x3ef13ef1
    .long 0x3f0e3f0e,0xbf55bf55,0x3e483e48,0x3f7b3f7b,0x3ef13ef1,0xbf75bf75,0x3f223f22,0x3dc93dc9
    .long 0x3ec43ec4,0xbec4bec4,0x3f6d3f6d,0xbf6dbf6d,0x3e953e95,0x3ef13ef1,0x3f7f3f7f,0xbf22bf22
    .long 0x3e483e48,0x3f7b3f7b,0x3f553f55,0x3f0e3f0e,0x3dc93dc9,0x3f463f46,0x3ef13ef1,0x3f753f75
    .long 0x3f803f80,0x3f803f80,0x3f803f80,0x3f803f80,0xbdc9bdc9,0xbf46bf46,0xbef1bef1,0xbf75bf75
    .long 0xbf7bbf7b,0x3e483e48,0xbf0ebf0e,0x3f553f55,0x3e953e95,0x3ef13ef1,0x3f7f3f7f,0xbf22bf22
    .long 0x3f6d3f6d,0xbf6dbf6d,0xbec4bec4,0x3ec43ec4,0xbef1bef1,0x3f753f75,0xbf22bf22,0xbdc9bdc9
    .long 0xbf55bf55,0xbf0ebf0e,0x3f7b3f7b,0xbe48be48,0x3f223f22,0xbdc9bdc9,0xbe95be95,0x3ef13ef1
    .long 0x3f353f35,0x3f353f35,0xbf35bf35,0xbf35bf35,0xbf46bf46,0xbf7fbf7f,0x3f753f75,0x3f623f62
    .long 0xbf0ebf0e,0x3f553f55,0xbe48be48,0xbf7bbf7b,0x3f623f62,0xbe95be95,0xbf46bf46,0x3f7f3f7f
    .long 0x3ec43ec4,0xbec4bec4,0x3f6d3f6d,0xbf6dbf6d,0xbf75bf75,0x3f623f62,0xbdc9bdc9,0x3f463f46
    .long 0xbe48be48,0xbf7bbf7b,0xbf55bf55,0xbf0ebf0e,0x3f7f3f7f,0x3f223f22,0x3f623f62,0x3e953e95
    .long 0x3f803f80,0x3f803f80,0x3f803f80,0x3f803f80,0x3f753f75,0x3ef13ef1,0x3f463f46,0x3dc93dc9
    .long 0x3f553f55,0xbf0ebf0e,0x3e483e48,0xbf7bbf7b,0x3f223f22,0xbf7fbf7f,0xbef1bef1,0xbe95be95
    .long 0x3ec43ec4,0xbec4bec4,0xbf6dbf6d,0x3f6d3f6d,0x3dc93dc9,0x3f223f22,0xbf75bf75,0x3ef13ef1
    .long 0xbe48be48,0x3f7b3f7b,0xbf0ebf0e,0xbf55bf55,0xbef1bef1,0x3e953e95,0x3dc93dc9,0xbf22bf22
    .long 0xbf35bf35,0xbf35bf35,0x3f353f35,0x3f353f35,0xbf62bf62,0xbf75bf75,0x3f7f3f7f,0x3f463f46
    .long 0xbf7bbf7b,0xbe48be48,0x3f553f55,0xbf0ebf0e,0xbf7fbf7f,0x3f463f46,0x3e953e95,0xbf62bf62
    .long 0xbf6dbf6d,0x3f6d3f6d,0xbec4bec4,0x3ec43ec4,0xbf46bf46,0x3dc93dc9,0xbf62bf62,0x3f753f75
    .long 0xbf0ebf0e,0xbf55bf55,0xbf7bbf7b,0xbe48be48,0xbe95be95,0xbf62bf62,0xbf22bf22,0xbf7fbf7f
    .long 0x3f803f80,0x3f803f80,0x3f803f80,0x3f803f80,0xbe95be95,0xbf62bf62,0xbf22bf22,0xbf7fbf7f
    .long 0xbf55bf55,0x3f0e3f0e,0xbe48be48,0x3f7b3f7b,0x3f463f46,0xbdc9bdc9,0x3f623f62,0xbf75bf75
    .long 0x3ec43ec4,0xbec4bec4,0xbf6dbf6d,0x3f6d3f6d,0xbf7fbf7f,0x3f463f46,0x3e953e95,0xbf62bf62
    .long 0x3e483e48,0xbf7bbf7b,0x3f0e3f0e,0x3f553f55,0x3f623f62,0x3f753f75,0xbf7fbf7f,0xbf46bf46
    .long 0xbf35bf35,0xbf35bf35,0x3f353f35,0x3f353f35,0xbef1bef1,0x3e953e95,0x3dc93dc9,0xbf22bf22
    .long 0x3f7b3f7b,0x3e483e48,0xbf55bf55,0x3f0e3f0e,0xbdc9bdc9,0xbf22bf22,0x3f753f75,0xbef1bef1
    .long 0xbf6dbf6d,0x3f6d3f6d,0xbec4bec4,0x3ec43ec4,0x3f223f22,0xbf7fbf7f,0xbef1bef1,0xbe95be95
    .long 0x3f0e3f0e,0x3f553f55,0x3f7b3f7b,0x3e483e48,0xbf75bf75,0xbef1bef1,0xbf46bf46,0xbdc9bdc9
    .long 0x8000,0x8000,0x8000,0x8000,0x3dc9bdc9,0x3f46bf46,0x3ef1bef1,0x3f75bf75
    .long 0x3e48be48,0x3f7bbf7b,0x3f55bf55,0x3f0ebf0e,0x3e95be95,0x3ef1bef1,0x3f7fbf7f,0xbf223f22
    .long 0x3ec4bec4,0xbec43ec4,0x3f6dbf6d,0xbf6d3f6d,0x3ef1bef1,0xbf753f75,0x3f22bf22,0x3dc9bdc9
    .long 0x3f0ebf0e,0xbf553f55,0x3e48be48,0x3f7bbf7b,0x3f22bf22,0xbdc93dc9,0xbe953e95,0x3ef1bef1
    .long 0x3f35bf35,0x3f35bf35,0xbf353f35,0xbf353f35,0x3f46bf46,0x3f7fbf7f,0xbf753f75,0xbf623f62
    .long 0x3f55bf55,0x3f0ebf0e,0xbf7b3f7b,0x3e48be48,0x3f62bf62,0xbe953e95,0xbf463f46,0x3f7fbf7f
    .long 0x3f6dbf6d,0xbf6d3f6d,0xbec43ec4,0x3ec4bec4,0x3f75bf75,0xbf623f62,0x3dc9bdc9,0xbf463f46
    .long 0x3f7bbf7b,0xbe483e48,0x3f0ebf0e,0xbf553f55,0x3f7fbf7f,0x3f22bf22,0x3f62bf62,0x3e95be95
    .long 0x8000,0x8000,0x8000,0x8000,0x3f7fbf7f,0x3f22bf22,0x3f62bf62,0x3e95be95
    .long 0xbe483e48,0xbf7b3f7b,0xbf553f55,0xbf0e3f0e,0xbf753f75,0x3f62bf62,0xbdc93dc9,0x3f46bf46
    .long 0x3ec4bec4,0xbec43ec4,0x3f6dbf6d,0xbf6d3f6d,0x3f62bf62,0xbe953e95,0xbf463f46,0x3f7fbf7f
    .long 0xbf0e3f0e,0x3f55bf55,0xbe483e48,0xbf7b3f7b,0xbf463f46,0xbf7f3f7f,0x3f75bf75,0x3f62bf62
    .long 0x3f35bf35,0x3f35bf35,0xbf353f35,0xbf353f35,0x3f22bf22,0xbdc93dc9,0xbe953e95,0x3ef1bef1
    .long 0xbf553f55,0xbf0e3f0e,0x3f7bbf7b,0xbe483e48,0xbef13ef1,0x3f75bf75,0xbf223f22,0xbdc93dc9
    .long 0x3f6dbf6d,0xbf6d3f6d,0xbec43ec4,0x3ec4bec4,0x3e95be95,0x3ef1bef1,0x3f7fbf7f,0xbf223f22
    .long 0xbf7b3f7b,0x3e48be48,0xbf0e3f0e,0x3f55bf55,0xbdc93dc9,0xbf463f46,0xbef13ef1,0xbf753f75
    .long 0x8000,0x8000,0x8000,0x8000,0x3e95be95,0x3f62bf62,0x3f22bf22,0x3f7fbf7f
    .long 0x3f0ebf0e,0x3f55bf55,0x3f7bbf7b,0x3e48be48,0x3f46bf46,0xbdc93dc9,0x3f62bf62,0xbf753f75
    .long 0x3f6dbf6d,0xbf6d3f6d,0x3ec4bec4,0xbec43ec4,0x3f7fbf7f,0xbf463f46,0xbe953e95,0x3f62bf62
    .long 0x3f7bbf7b,0x3e48be48,0xbf553f55,0x3f0ebf0e,0x3f62bf62,0x3f75bf75,0xbf7f3f7f,0xbf463f46
    .long 0x3f35bf35,0x3f35bf35,0xbf353f35,0xbf353f35,0x3ef1bef1,0xbe953e95,0xbdc93dc9,0x3f22bf22
    .long 0x3e48be48,0xbf7b3f7b,0x3f0ebf0e,0x3f55bf55,0xbdc93dc9,0xbf223f22,0x3f75bf75,0xbef13ef1
    .long 0xbec43ec4,0x3ec4bec4,0x3f6dbf6d,0xbf6d3f6d,0xbf223f22,0x3f7fbf7f,0x3ef1bef1,0x3e95be95
    .long 0xbf553f55,0x3f0ebf0e,0xbe483e48,0x3f7bbf7b,0xbf753f75,0xbef13ef1,0xbf463f46,0xbdc93dc9
    .long 0x8000,0x8000,0x8000,0x8000,0x3f75bf75,0x3ef1bef1,0x3f46bf46,0x3dc9bdc9
    .long 0xbf0e3f0e,0xbf553f55,0xbf7b3f7b,0xbe483e48,0xbf223f22,0x3f7fbf7f,0x3ef1bef1,0x3e95be95
    .long 0x3f6dbf6d,0xbf6d3f6d,0x3ec4bec4,0xbec43ec4,0x3dc9bdc9,0x3f22bf22,0xbf753f75,0x3ef1bef1
    .long 0xbf7b3f7b,0xbe483e48,0x3f55bf55,0xbf0e3f0e,0x3ef1bef1,0xbe953e95,0xbdc93dc9,0x3f22bf22
    .long 0x3f35bf35,0x3f35bf35,0xbf353f35,0xbf353f35,0xbf623f62,0xbf753f75,0x3f7fbf7f,0x3f46bf46
    .long 0xbe483e48,0x3f7bbf7b,0xbf0e3f0e,0xbf553f55,0x3f7fbf7f,0xbf463f46,0xbe953e95,0x3f62bf62
    .long 0xbec43ec4,0x3ec4bec4,0x3f6dbf6d,0xbf6d3f6d,0xbf463f46,0x3dc9bdc9,0xbf623f62,0x3f75bf75
    .long 0x3f55bf55,0xbf0e3f0e,0x3e48be48,0xbf7b3f7b,0x3e95be95,0x3f62bf62,0x3f22bf22,0x3f7fbf7f
    .long 0x31000000,0x18901880,0xc080600,0x2007000,0x31010001,0x18ac189c,0xc090602,0x2017000
    .long 0x31020002,0x18c818b8,0xc0a0604,0x2027001,0x31030003,0x18e418d4,0xc0b0606,0x2037001
    .long 0x310800e0,0x190118f1,0xc180608,0x2047002,0x310900e1,0x191d190d,0xc19060a,0x2057002
    .long 0x310a00e2,0x19391929,0xc1a060c,0x2067003,0x310b00e3,0x19551945,0xc1b060e,0x2077003
    .long 0x311001c0,0x19721962,0xc280610,0x2087004,0x311101c1,0x198e197e,0xc290612,0x2097004
    .long 0x311201c2,0x19aa199a,0xc2a0614,0x20a7005,0x311301c3,0x19c619b6,0xc2b0616,0x20b7005
    .long 0x311802a0,0x19e319d3,0xc380618,0x20c7006,0x311902a1,0x19ff19ef,0xc39061a,0x20d7006
    .long 0x311a02a2,0x1a1b1a0b,0xc3a061c,0x20e7007,0x311b02a3,0x1a371a27,0xc3b061e,0x20f7007
    .long 0x31440380,0x18941884,0xc480601,0x5807010,0x31450381,0x18b018a0,0xc490603,0x5817010
    .long 0x31460382,0x18cc18bc,0xc4a0605,0x5827011,0x31470383,0x18e818d8,0xc4b0607,0x5837011
    .long 0x314c0460,0x190518f5,0xc580609,0x5847012,0x314d0461,0x19211911,0xc59060b,0x5857012
    .long 0x314e0462,0x193d192d,0xc5a060d,0x5867013,0x314f0463,0x19591949,0xc5b060f,0x5877013
    .long 0x31540540,0x19761966,0xc680611,0x5887014,0x31550541,0x19921982,0xc690613,0x5897014
    .long 0x31560542,0x19ae199e,0xc6a0615,0x58a7015,0x31570543,0x19ca19ba,0xc6b0617,0x58b7015
    .long 0x315c0620,0x19e719d7,0xc680619,0x58c7016,0x315d0621,0x1a0319f3,0xc69061b,0x58d7016
    .long 0x315e0622,0x1a1f1a0f,0xc6a061d,0x58e7017,0x315f0623,0x1a3b1a2b,0xc6b061f,0x58f7017
    .long 0x31800702,0x18981888,0xc780620,0x2807020,0x31810703,0x18b418a4,0xc790622,0x2817020
    .long 0x31820700,0x18d018c0,0xc7a0624,0x2827021,0x31830701,0x18ec18dc,0xc7b0626,0x2837021
    .long 0x318807e2,0x190918f9,0xc880628,0x2847022,0x318907e3,0x19251915,0xc89062a,0x2857022
    .long 0x318a07e0,0x19411931,0xc8a062c,0x2867023,0x318b07e1,0x195d194d,0xc8b062e,0x2877023
    .long 0x319008c2,0x197a196a,0xc980630,0x2887024,0x319108c3,0x19961986,0xc990632,0x2897024
    .long 0x319208c0,0x19b219a2,0xc9a0634,0x28a7025,0x319308c1,0x19ce19be,0xc9b0636,0x28b7025
    .long 0x319809a2,0x19eb19db,0xca80638,0x28c7026,0x319909a3,0x1a0719f7,0xca9063a,0x28d7026
    .long 0x319a09a0,0x1a231a13,0xcaa063c,0x28e7027,0x319b09a1,0x1a3f1a2f,0xcab063e,0x28f7027
    .long 0x31c40a82,0x1898188c,0xcb80621,0x6007030,0x31c50a83,0x18b418a8,0xcb90623,0x6017030
    .long 0x31c60a80,0x18d018c4,0xcba0625,0x6027031,0x31c70a81,0x18ec18e0,0xcbb0627,0x6037031
    .long 0x31cc0b62,0x190918fd,0xcc80629,0x6047032,0x31cd0b63,0x19251919,0xcc9062b,0x6057032
    .long 0x31ce0b60,0x19411935,0xcca062d,0x6067033,0x31cf0b61,0x195d1951,0xccb062f,0x6077033
    .long 0x31d40c42,0x197a196e,0xcd80631,0x6087034,0x31d50c43,0x1996198a,0xcd90633,0x6097034
    .long 0x31d60c40,0x19b219a6,0xcda0635,0x60a7035,0x31d70c41,0x19ce19c2,0xcdb0637,0x60b7035
    .long 0x31dc0d22,0x19eb19df,0xcd80639,0x60c7036,0x31dd0d23,0x1a0719fb,0xcd9063b,0x60d7036
    .long 0x31de0d20,0x1a231a17,0xcda063d,0x60e7037,0x31df0d21,0x1a3f1a33,0xcdb063f,0x60f7037
    .long 0x2000ee0,0x27c0280,0x801fc,0x8000280,0x2010ee1,0x37d0281,0x801fd,0x8010281
    .long 0x2040ee2,0x27e0284,0x801fe,0x8020282,0x2050ee3,0x37f0285,0x801ff,0x8030283
    .long 0x2080ee4,0x2800288,0x80200,0x8040284,0x2090ee5,0x3810289,0x80201,0x8050285
    .long 0x20c0ee6,0x282028c,0x80202,0x8060286,0x20d0ee7,0x383028d,0x80203,0x8070287
    .long 0x80000ee8,0x27d8000,0x8023c,0x8080288,0x80000ee9,0x37e8000,0x8023d,0x8090289
    .long 0x80000eea,0x27f8000,0x8023e,0x80a028a,0x80000eeb,0x3808000,0x8023f,0x80b028b
    .long 0x80000eec,0x2818000,0x80240,0x80c028c,0x80000eed,0x3828000,0x80241,0x80d028d
    .long 0x80000eee,0x2838000,0x80242,0x80e028e,0x80000eef,0x3848000,0x80243,0x80f028f
    .long 0x2200ef0,0x28402a0,0x80204,0x8100290,0x2210ef1,0x38502a1,0x80205,0x8110291
    .long 0x2240ef2,0x28602a4,0x80206,0x8120292,0x2250ef3,0x38702a5,0x80207,0x8130293
    .long 0x2280ef4,0x28802a8,0x80208,0x8140294,0x2290ef5,0x38902a9,0x80209,0x8150295
    .long 0x22c0ef6,0x28a02ac,0x8020a,0x8160296,0x22d0ef7,0x38b02ad,0x8020b,0x8170297
    .long 0x2300ef8,0x28502b0,0x80244,0x8180298,0x2310ef9,0x38602b1,0x80245,0x8190299
    .long 0x2340efa,0x28702b4,0x80246,0x81a029a,0x2350efb,0x38802b5,0x80247,0x81b029b
    .long 0x2380efc,0x28902b8,0x80248,0x81c029c,0x2390efd,0x38a02b9,0x80249,0x81d029d
    .long 0x23c0efe,0x28b02bc,0x8024a,0x81e029e,0x23d0eff,0x38c02bd,0x8024b,0x81f029f
    .long 0x2400f00,0x28c02c0,0xa020c,0x84002c0,0x2410f01,0x38d02c1,0xa020d,0x84102c1
    .long 0x2440f02,0x28e02c4,0xa020e,0x84202c2,0x2450f03,0x38f02c5,0xa020f,0x84302c3
    .long 0x2480f04,0x29002c8,0xa0210,0x84402c4,0x2490f05,0x39102c9,0xa0211,0x84502c5
    .long 0x24c0f06,0x29202cc,0xa0212,0x84602c6,0x24d0f07,0x39302cd,0xa0213,0x84702c7
    .long 0x2500f08,0x28d02d0,0xa024c,0x84802c8,0x2510f09,0x38e02d1,0xa024d,0x84902c9
    .long 0x2540f0a,0x28f02d4,0xa024e,0x84a02ca,0x2550f0b,0x39002d5,0xa024f,0x84b02cb
    .long 0x2580f0c,0x29102d8,0xa0250,0x84c02cc,0x2590f0d,0x39202d9,0xa0251,0x84d02cd
    .long 0x25c0f0e,0x29302dc,0xa0252,0x84e02ce,0x25d0f0f,0x39402dd,0xa0253,0x84f02cf
    .long 0x2600f10,0x29402e0,0xa0214,0x85002d0,0x2610f11,0x39502e1,0xa0215,0x85102d1
    .long 0x2640f12,0x29602e4,0xa0216,0x85202d2,0x2650f13,0x39702e5,0xa0217,0x85302d3
    .long 0x2680f14,0x29802e8,0xa0218,0x85402d4,0x2690f15,0x39902e9,0xa0219,0x85502d5
    .long 0x26c0f16,0x29a02ec,0xa021a,0x85602d6,0x26d0f17,0x39b02ed,0xa021b,0x85702d7
    .long 0x2700f17,0x29502f0,0xa0254,0x85802d8,0x2710f17,0x39602f1,0xa0255,0x85902d9
    .long 0x2740f17,0x29702f4,0xa0256,0x85a02da,0x2750f17,0x39802f5,0xa0257,0x85b02db
    .long 0x2780f17,0x29902f8,0xa0258,0x85c02dc,0x2790f17,0x39a02f9,0xa0259,0x85d02dd
    .long 0x27c0f17,0x29b02fc,0xa025a,0x85e02de,0x27d0f17,0x39c02fd,0xa025b,0x85f02df
    .long 0x3f80,0xbf80,0x3f80,0xbf80,0x3f80,0xbdc9bf7f,0x3e483f7b,0xbe95bf75
    .long 0x3f80,0xbe48bf7b,0x3ec43f6d,0xbf0ebf55,0x3f80,0xbe95bf75,0x3f0e3f55,0xbf46bf22
    .long 0x3f80,0xbec4bf6d,0x3f353f35,0xbf6dbec4,0x3f80,0xbef1bf62,0x3f553f0e,0xbf7fbdc9
    .long 0x3f80,0xbf0ebf55,0x3f6d3ec4,0xbf7b3e48,0x3f80,0xbf22bf46,0x3f7b3e48,0xbf623ef1
    .long 0x3f80,0xbf35bf35,0x3f800000,0xbf353f35,0x3f80,0xbf46bf22,0x3f7bbe48,0xbef13f62
    .long 0x3f80,0xbf55bf0e,0x3f6dbec4,0xbe483f7b,0x3f80,0xbf62bef1,0x3f55bf0e,0x3dc93f7f
    .long 0x3f80,0xbf6dbec4,0x3f35bf35,0x3ec43f6d,0x3f80,0xbf75be95,0x3f0ebf55,0x3f223f46
    .long 0x3f80,0xbf7bbe48,0x3ec4bf6d,0x3f553f0e,0x3f80,0xbf7fbdc9,0x3e48bf7b,0x3f753e95
    .long 0x3f80,0xbf80,0x3f80,0xbf80,0x3ec43f6d,0xbef1bf62,0x3f0e3f55,0xbf22bf46
    .long 0x3f353f35,0xbf55bf0e,0x3f6d3ec4,0xbf7bbe48,0x3f6d3ec4,0xbf7fbdc9,0x3f7bbe48,0xbf623ef1
    .long 0x3f800000,0xbf6d3ec4,0x3f35bf35,0xbec43f6d,0x3f6dbec4,0xbf223f46,0x3e48bf7b,0x3e953f75
    .long 0x3f35bf35,0xbe483f7b,0xbec4bf6d,0x3f553f0e,0x3ec4bf6d,0x3e953f75,0xbf55bf0e,0x3f7fbdc9
    .long 0xbf80,0x3f353f35,0xbf800000,0x3f35bf35,0xbec4bf6d,0x3f753e95,0xbf553f0e,0x3dc9bf7f
    .long 0xbf35bf35,0x3f7bbe48,0xbec43f6d,0xbf0ebf55,0xbf6dbec4,0x3f46bf22,0x3e483f7b,0xbf75be95
    .long 0xbf800000,0x3ec4bf6d,0x3f353f35,0xbf6d3ec4,0xbf6d3ec4,0xbdc9bf7f,0x3f7b3e48,0xbef13f62
    .long 0xbf353f35,0xbf0ebf55,0x3f6dbec4,0x3e483f7b,0xbec43f6d,0xbf62bef1,0x3f0ebf55,0x3f463f22
    .long 0x3f80,0xbf80,0x3f80,0xbf80,0x3f353f35,0xbf46bf22,0x3f553f0e,0xbf62bef1
    .long 0x3f800000,0xbf7b3e48,0x3f6dbec4,0xbf553f0e,0x3f35bf35,0xbef13f62,0x3e48bf7b,0x3dc93f7f
    .long 0xbf80,0x3ec43f6d,0xbf35bf35,0x3f6d3ec4,0xbf35bf35,0x3f753e95,0xbf7b3e48,0x3f46bf22
    .long 0xbf800000,0x3f55bf0e,0xbec43f6d,0xbe48bf7b,0xbf353f35,0x3dc9bf7f,0x3f0e3f55,0xbf75be95
    .long 0x3f80,0xbf35bf35,0x3f800000,0xbf353f35,0x3f353f35,0xbf7f3dc9,0x3f0ebf55,0x3e953f75
    .long 0x3f800000,0xbf0e3f55,0xbec4bf6d,0x3f7b3e48,0x3f35bf35,0x3e953f75,0xbf7bbe48,0x3f22bf46
    .long 0xbf80,0x3f6d3ec4,0xbf353f35,0xbec4bf6d,0xbf35bf35,0x3f62bef1,0x3e483f7b,0xbf7fbdc9
    .long 0xbf800000,0x3e48bf7b,0x3f6d3ec4,0xbf0e3f55,0xbf353f35,0xbf22bf46,0x3f55bf0e,0x3ef13f62
    .long 0x3f80,0xbf80,0x3f80,0xbf80,0x3f6d3ec4,0xbf75be95,0x3f7b3e48,0xbf7fbdc9
    .long 0x3f35bf35,0xbf0e3f55,0x3ec4bf6d,0xbe483f7b,0xbec4bf6d,0x3f223f46,0xbf55bf0e,0x3f753e95
    .long 0xbf800000,0x3f6dbec4,0xbf353f35,0x3ec4bf6d,0xbec43f6d,0xbdc9bf7f,0x3f0e3f55,0xbf62bef1
    .long 0x3f353f35,0xbf7bbe48,0x3f6dbec4,0xbf0e3f55,0x3f6dbec4,0xbef13f62,0xbe48bf7b,0x3f463f22
    .long 0xbf80,0x3f353f35,0xbf800000,0x3f35bf35,0xbf6dbec4,0x3f62bef1,0xbe483f7b,0xbf22bf46
    .long 0xbf353f35,0xbe48bf7b,0x3f6d3ec4,0xbf553f0e,0x3ec43f6d,0xbf7fbdc9,0x3f0ebf55,0x3ef13f62
    .long 0x3f800000,0xbec43f6d,0xbf35bf35,0x3f6dbec4,0x3ec4bf6d,0x3f463f22,0xbf553f0e,0xbe95bf75
    .long 0xbf35bf35,0x3f55bf0e,0x3ec43f6d,0xbf7b3e48,0xbf6d3ec4,0xbe95bf75,0x3f7bbe48,0x3dc93f7f
    .long 0x3f80,0xbf80,0x3f80,0xbf80,0x3f800000,0xbf7f3dc9,0x3f7bbe48,0xbf753e95
    .long 0xbf80,0x3e483f7b,0xbec4bf6d,0x3f0e3f55,0xbf800000,0x3f75be95,0xbf553f0e,0x3f22bf46
    .long 0x3f80,0xbec4bf6d,0x3f353f35,0xbf6dbec4,0x3f800000,0xbf623ef1,0x3f0ebf55,0xbdc93f7f
    .long 0xbf80,0x3f0e3f55,0xbf6dbec4,0x3f7bbe48,0xbf800000,0x3f46bf22,0xbe483f7b,0xbef1bf62
    .long 0x3f80,0xbf35bf35,0x3f800000,0xbf353f35,0x3f800000,0xbf223f46,0xbe48bf7b,0x3f623ef1
    .long 0xbf80,0x3f553f0e,0xbf6d3ec4,0x3e48bf7b,0xbf800000,0x3ef1bf62,0x3f0e3f55,0xbf7f3dc9
    .long 0x3f80,0xbf6dbec4,0x3f35bf35,0x3ec43f6d,0x3f800000,0xbe953f75,0xbf55bf0e,0x3f46bf22
    .long 0xbf80,0x3f7b3e48,0xbec43f6d,0xbf55bf0e,0xbf800000,0x3dc9bf7f,0x3f7b3e48,0xbe953f75
    .long 0x3f80,0xbf80,0x3f80,0xbf80,0x3f6dbec4,0xbf623ef1,0x3f55bf0e,0xbf463f22
    .long 0xbf35bf35,0x3f553f0e,0xbf6dbec4,0x3f7b3e48,0xbec43f6d,0x3dc9bf7f,0x3e483f7b,0xbef1bf62
    .long 0x3f800000,0xbf6d3ec4,0x3f35bf35,0xbec43f6d,0xbec4bf6d,0x3f463f22,0xbf7bbe48,0x3f75be95
    .long 0xbf353f35,0x3e48bf7b,0x3ec43f6d,0xbf55bf0e,0x3f6d3ec4,0xbf753e95,0x3f0ebf55,0x3dc93f7f
    .long 0xbf80,0x3f353f35,0xbf800000,0x3f35bf35,0xbf6d3ec4,0x3e95bf75,0x3f0e3f55,0xbf7fbdc9
    .long 0x3f353f35,0xbf7b3e48,0x3ec4bf6d,0x3f0e3f55,0x3ec4bf6d,0x3f223f46,0xbf7b3e48,0x3e95bf75
    .long 0xbf800000,0x3ec4bf6d,0x3f353f35,0xbf6d3ec4,0x3ec43f6d,0xbf7f3dc9,0x3e48bf7b,0x3f623ef1
    .long 0x3f35bf35,0x3f0e3f55,0xbf6d3ec4,0xbe48bf7b,0xbf6dbec4,0x3ef1bf62,0x3f553f0e,0xbf223f46
    .long 0x3f80,0xbf80,0x3f80,0xbf80,0x3f35bf35,0xbf223f46,0x3f0ebf55,0xbef13f62
    .long 0xbf800000,0x3f7bbe48,0xbf6d3ec4,0x3f55bf0e,0x3f353f35,0xbf62bef1,0x3f7b3e48,0xbf7f3dc9
    .long 0xbf80,0x3ec43f6d,0xbf35bf35,0x3f6d3ec4,0xbf353f35,0x3e95bf75,0x3e483f7b,0xbf22bf46
    .long 0x3f800000,0xbf553f0e,0x3ec4bf6d,0x3e483f7b,0xbf35bf35,0x3f7f3dc9,0xbf553f0e,0x3e95bf75
    .long 0x3f80,0xbf35bf35,0x3f800000,0xbf353f35,0x3f35bf35,0x3dc93f7f,0xbf55bf0e,0x3f75be95
    .long 0xbf800000,0x3f0ebf55,0x3ec43f6d,0xbf7bbe48,0x3f353f35,0xbf753e95,0x3e48bf7b,0x3f463f22
    .long 0xbf80,0x3f6d3ec4,0xbf353f35,0xbec4bf6d,0xbf353f35,0xbef1bf62,0x3f7bbe48,0xbdc93f7f
    .long 0x3f800000,0xbe483f7b,0xbf6dbec4,0x3f0ebf55,0xbf35bf35,0x3f46bf22,0x3f0e3f55,0xbf623ef1
    .long 0x3f80,0xbf80,0x3f80,0xbf80,0x3ec4bf6d,0xbe953f75,0x3e48bf7b,0xbdc93f7f
    .long 0xbf353f35,0x3f0ebf55,0xbec43f6d,0x3e48bf7b,0x3f6dbec4,0xbf463f22,0x3f0ebf55,0xbe953f75
    .long 0xbf800000,0x3f6dbec4,0xbf353f35,0x3ec4bf6d,0x3f6d3ec4,0xbf7f3dc9,0x3f55bf0e,0xbef13f62
    .long 0xbf35bf35,0x3f7b3e48,0xbf6d3ec4,0x3f0ebf55,0x3ec43f6d,0xbf62bef1,0x3f7bbe48,0xbf223f46
    .long 0xbf80,0x3f353f35,0xbf800000,0x3f35bf35,0xbec43f6d,0xbef1bf62,0x3f7b3e48,0xbf463f22
    .long 0x3f35bf35,0x3e483f7b,0xbf6dbec4,0x3f55bf0e,0xbf6d3ec4,0x3dc9bf7f,0x3f553f0e,0xbf623ef1
    .long 0x3f800000,0xbec43f6d,0xbf35bf35,0x3f6dbec4,0xbf6dbec4,0x3f22bf46,0x3f0e3f55,0xbf753e95
    .long 0x3f353f35,0xbf553f0e,0xbec4bf6d,0x3f7bbe48,0xbec4bf6d,0x3f75be95,0x3e483f7b,0xbf7f3dc9
    .long 0x3f803f80,0x3f803f80,0x3f803f80,0x3f803f80,0xbf803f80,0x3f353f35,0x3f6d3f6d,0x3ec43ec4
    .long 0x3f803f80,0x0,0x3f353f35,0xbf35bf35,0xbf803f80,0xbf35bf35,0x3ec43ec4,0xbf6dbf6d
    .long 0x3f803f80,0xbf80bf80,0x0,0x0,0xbf803f80,0xbf35bf35,0xbec4bec4,0x3f6d3f6d
    .long 0x3f803f80,0x0,0xbf35bf35,0x3f353f35,0xbf803f80,0x3f353f35,0xbf6dbf6d,0xbec4bec4
    .long 0x3f803f80,0x3f803f80,0xbf80bf80,0xbf80bf80,0xbf803f80,0x3f353f35,0xbf6dbf6d,0xbec4bec4
    .long 0x3f803f80,0x0,0xbf35bf35,0x3f353f35,0xbf803f80,0xbf35bf35,0xbec4bec4,0x3f6d3f6d
    .long 0x3f803f80,0xbf80bf80,0x0,0x0,0xbf803f80,0xbf35bf35,0x3ec43ec4,0xbf6dbf6d
    .long 0x3f803f80,0x0,0x3f353f35,0xbf35bf35,0xbf803f80,0x3f353f35,0x3f6d3f6d,0x3ec43ec4
    .long 0x3f803f80,0x3f803f80,0x3f803f80,0x3f803f80,0x0,0xbf35bf35,0xbec4bec4,0xbf6dbf6d
    .long 0xbf80bf80,0x0,0xbf35bf35,0x3f353f35,0x0,0x3f353f35,0x3f6d3f6d,0xbec4bec4
    .long 0x3f803f80,0xbf80bf80,0x0,0x0,0x0,0x3f353f35,0xbf6dbf6d,0x3ec43ec4
    .long 0xbf80bf80,0x0,0x3f353f35,0xbf35bf35,0x0,0xbf35bf35,0x3ec43ec4,0x3f6d3f6d
    .long 0x3f803f80,0x3f803f80,0xbf80bf80,0xbf80bf80,0x0,0xbf35bf35,0x3ec43ec4,0x3f6d3f6d
    .long 0xbf80bf80,0x0,0x3f353f35,0xbf35bf35,0x0,0x3f353f35,0xbf6dbf6d,0x3ec43ec4
    .long 0x3f803f80,0xbf80bf80,0x0,0x0,0x0,0x3f353f35,0x3f6d3f6d,0xbec4bec4
    .long 0xbf80bf80,0x0,0xbf35bf35,0x3f353f35,0x0,0xbf35bf35,0xbec4bec4,0xbf6dbf6d
    .long 0xbf80bf80,0xbf80bf80,0xbf80bf80,0xbf80bf80,0xbf7bbf7b,0xbf0ebf0e,0xbf55bf55,0xbe48be48
    .long 0xbf6dbf6d,0x3ec43ec4,0xbec4bec4,0x3f6d3f6d,0xbf55bf55,0x3f7b3f7b,0x3e483e48,0x3f0e3f0e
    .long 0xbf35bf35,0x3f353f35,0x3f353f35,0xbf35bf35,0xbf0ebf0e,0xbe48be48,0x3f7b3f7b,0xbf55bf55
    .long 0xbec4bec4,0xbf6dbf6d,0x3f6d3f6d,0x3ec43ec4,0xbe48be48,0xbf55bf55,0x3f0e3f0e,0x3f7b3f7b
    .long 0x0,0x0,0x0,0x0,0x3e483e48,0x3f553f55,0xbf0ebf0e,0xbf7bbf7b
    .long 0x3ec43ec4,0x3f6d3f6d,0xbf6dbf6d,0xbec4bec4,0x3f0e3f0e,0x3e483e48,0xbf7bbf7b,0x3f553f55
    .long 0x3f353f35,0xbf35bf35,0xbf35bf35,0x3f353f35,0x3f553f55,0xbf7bbf7b,0xbe48be48,0xbf0ebf0e
    .long 0x3f6d3f6d,0xbec4bec4,0x3ec43ec4,0xbf6dbf6d,0x3f7b3f7b,0x3f0e3f0e,0x3f553f55,0x3e483e48
    .long 0xbf80bf80,0xbf80bf80,0xbf80bf80,0xbf80bf80,0x3e483e48,0x3f553f55,0x3f0e3f0e,0x3f7b3f7b
    .long 0x3f6d3f6d,0xbec4bec4,0x3ec43ec4,0xbf6dbf6d,0xbf0ebf0e,0xbe48be48,0xbf7bbf7b,0x3f553f55
    .long 0xbf35bf35,0x3f353f35,0x3f353f35,0xbf35bf35,0x3f553f55,0xbf7bbf7b,0x3e483e48,0x3f0e3f0e
    .long 0x3ec43ec4,0x3f6d3f6d,0xbf6dbf6d,0xbec4bec4,0xbf7bbf7b,0xbf0ebf0e,0x3f553f55,0x3e483e48
    .long 0x0,0x0,0x0,0x0,0x3f7b3f7b,0x3f0e3f0e,0xbf55bf55,0xbe48be48
    .long 0xbec4bec4,0xbf6dbf6d,0x3f6d3f6d,0x3ec43ec4,0xbf55bf55,0x3f7b3f7b,0xbe48be48,0xbf0ebf0e
    .long 0x3f353f35,0xbf35bf35,0xbf35bf35,0x3f353f35,0x3f0e3f0e,0x3e483e48,0x3f7b3f7b,0xbf55bf55
    .long 0xbf6dbf6d,0x3ec43ec4,0xbec4bec4,0x3f6d3f6d,0xbe48be48,0xbf55bf55,0xbf0ebf0e,0xbf7bbf7b
    .long 0x8000,0x8000,0x8000,0x8000,0x8000,0x3f35bf35,0x3ec4bec4,0x3f6dbf6d
    .long 0x8000,0x3f80bf80,0x3f35bf35,0x3f35bf35,0x8000,0x3f35bf35,0x3f6dbf6d,0xbec43ec4
    .long 0x8000,0x8000,0x3f80bf80,0xbf803f80,0x8000,0xbf353f35,0x3f6dbf6d,0xbec43ec4
    .long 0x8000,0xbf803f80,0x3f35bf35,0x3f35bf35,0x8000,0xbf353f35,0x3ec4bec4,0x3f6dbf6d
    .long 0x8000,0x8000,0x8000,0x8000,0x8000,0x3f35bf35,0xbec43ec4,0xbf6d3f6d
    .long 0x8000,0x3f80bf80,0xbf353f35,0xbf353f35,0x8000,0x3f35bf35,0xbf6d3f6d,0x3ec4bec4
    .long 0x8000,0x8000,0xbf803f80,0x3f80bf80,0x8000,0xbf353f35,0xbf6d3f6d,0x3ec4bec4
    .long 0x8000,0xbf803f80,0xbf353f35,0xbf353f35,0x8000,0xbf353f35,0xbec43ec4,0xbf6d3f6d
    .long 0x8000,0x8000,0x8000,0x8000,0x3f80bf80,0x3f35bf35,0x3f6dbf6d,0x3ec4bec4
    .long 0x8000,0xbf803f80,0xbf353f35,0xbf353f35,0xbf803f80,0x3f35bf35,0xbec43ec4,0x3f6dbf6d
    .long 0x8000,0x8000,0x3f80bf80,0xbf803f80,0x3f80bf80,0xbf353f35,0xbec43ec4,0x3f6dbf6d
    .long 0x8000,0x3f80bf80,0xbf353f35,0xbf353f35,0xbf803f80,0xbf353f35,0x3f6dbf6d,0x3ec4bec4
    .long 0x8000,0x8000,0x8000,0x8000,0x3f80bf80,0x3f35bf35,0xbf6d3f6d,0xbec43ec4
    .long 0x8000,0xbf803f80,0x3f35bf35,0x3f35bf35,0xbf803f80,0x3f35bf35,0x3ec4bec4,0xbf6d3f6d
    .long 0x8000,0x8000,0xbf803f80,0x3f80bf80,0x3f80bf80,0xbf353f35,0x3ec4bec4,0xbf6d3f6d
    .long 0x8000,0x3f80bf80,0x3f35bf35,0x3f35bf35,0xbf803f80,0xbf353f35,0xbf6d3f6d,0xbec43ec4
    .long 0x8000,0x8000,0x8000,0x8000,0xbe483e48,0xbf553f55,0xbf0e3f0e,0xbf7b3f7b
    .long 0xbec43ec4,0xbf6d3f6d,0xbf6d3f6d,0xbec43ec4,0xbf0e3f0e,0xbe483e48,0xbf7b3f7b,0x3f55bf55
    .long 0xbf353f35,0x3f35bf35,0xbf353f35,0x3f35bf35,0xbf553f55,0x3f7bbf7b,0xbe483e48,0xbf0e3f0e
    .long 0xbf6d3f6d,0x3ec4bec4,0x3ec4bec4,0xbf6d3f6d,0xbf7b3f7b,0xbf0e3f0e,0x3f55bf55,0x3e48be48
    .long 0xbf803f80,0xbf803f80,0x3f80bf80,0x3f80bf80,0xbf7b3f7b,0xbf0e3f0e,0x3f55bf55,0x3e48be48
    .long 0xbf6d3f6d,0x3ec4bec4,0x3ec4bec4,0xbf6d3f6d,0xbf553f55,0x3f7bbf7b,0xbe483e48,0xbf0e3f0e
    .long 0xbf353f35,0x3f35bf35,0xbf353f35,0x3f35bf35,0xbf0e3f0e,0xbe483e48,0xbf7b3f7b,0x3f55bf55
    .long 0xbec43ec4,0xbf6d3f6d,0xbf6d3f6d,0xbec43ec4,0xbe483e48,0xbf553f55,0xbf0e3f0e,0xbf7b3f7b
    .long 0x8000,0x8000,0x8000,0x8000,0xbf7b3f7b,0xbf0e3f0e,0xbf553f55,0xbe483e48
    .long 0x3ec4bec4,0x3f6dbf6d,0x3f6dbf6d,0x3ec4bec4,0x3f55bf55,0xbf7b3f7b,0xbe483e48,0xbf0e3f0e
    .long 0xbf353f35,0x3f35bf35,0xbf353f35,0x3f35bf35,0xbf0e3f0e,0xbe483e48,0x3f7bbf7b,0xbf553f55
    .long 0x3f6dbf6d,0xbec43ec4,0xbec43ec4,0x3f6dbf6d,0x3e48be48,0x3f55bf55,0xbf0e3f0e,0xbf7b3f7b
    .long 0xbf803f80,0xbf803f80,0x3f80bf80,0x3f80bf80,0x3e48be48,0x3f55bf55,0xbf0e3f0e,0xbf7b3f7b
    .long 0x3f6dbf6d,0xbec43ec4,0xbec43ec4,0x3f6dbf6d,0xbf0e3f0e,0xbe483e48,0x3f7bbf7b,0xbf553f55
    .long 0xbf353f35,0x3f35bf35,0xbf353f35,0x3f35bf35,0x3f55bf55,0xbf7b3f7b,0xbe483e48,0xbf0e3f0e
    .long 0x3ec4bec4,0x3f6dbf6d,0x3f6dbf6d,0x3ec4bec4,0xbf7b3f7b,0xbf0e3f0e,0xbf553f55,0xbe483e48
    .long 0x40800000,0x20502040,0xc0c0700,0x3008f00,0x40810001,0x206c205c,0xc0d0702,0x3018f00
    .long 0x40820002,0x20882078,0xc0e0704,0x3028f01,0x40830003,0x20a42094,0xc0f0706,0x3038f01
    .long 0x408800e0,0x20c120b1,0xc1c0708,0x3048f02,0x408900e1,0x20dd20cd,0xc1d070a,0x3058f02
    .long 0x408a00e2,0x20f920e9,0xc1e070c,0x3068f03,0x408b00e3,0x21152105,0xc1f070e,0x3078f03
    .long 0x409001c0,0x21322122,0xc2c0710,0x3088f04,0x409101c1,0x214e213e,0xc2d0712,0x3098f04
    .long 0x409201c2,0x216a215a,0xc2e0714,0x30a8f05,0x409301c3,0x21862176,0xc2f0716,0x30b8f05
    .long 0x409802a0,0x21a32193,0xc3c0718,0x30c8f06,0x409902a1,0x21bf21af,0xc3d071a,0x30d8f06
    .long 0x409a02a2,0x21db21cb,0xc3e071c,0x30e8f07,0x409b02a3,0x21f721e7,0xc3f071e,0x30f8f07
    .long 0x40c40380,0x20542044,0xc4c0701,0x6808f10,0x40c50381,0x20702060,0xc4d0703,0x6818f10
    .long 0x40c60382,0x208c207c,0xc4e0705,0x6828f11,0x40c70383,0x20a82098,0xc4f0707,0x6838f11
    .long 0x40cc0460,0x20c520b5,0xc5c0709,0x6848f12,0x40cd0461,0x20e120d1,0xc5d070b,0x6858f12
    .long 0x40ce0462,0x20fd20ed,0xc5e070d,0x6868f13,0x40cf0463,0x21192109,0xc5f070f,0x6878f13
    .long 0x40d40540,0x21362126,0xc6c0711,0x6888f14,0x40d50541,0x21522142,0xc6d0713,0x6898f14
    .long 0x40d60542,0x216e215e,0xc6e0715,0x68a8f15,0x40d70543,0x218a217a,0xc6f0717,0x68b8f15
    .long 0x40dc0620,0x21a72197,0xc6c0719,0x68c8f16,0x40dd0621,0x21c321b3,0xc6d071b,0x68d8f16
    .long 0x40de0622,0x21df21cf,0xc6e071d,0x68e8f17,0x40df0623,0x21fb21eb,0xc6f071f,0x68f8f17
    .long 0x41000702,0x20582048,0xc7c0720,0x3808f20,0x41010703,0x20742064,0xc7d0722,0x3818f20
    .long 0x41020700,0x20902080,0xc7e0724,0x3828f21,0x41030701,0x20ac209c,0xc7f0726,0x3838f21
    .long 0x410807e2,0x20c920b9,0xc8c0728,0x3848f22,0x410907e3,0x20e520d5,0xc8d072a,0x3858f22
    .long 0x410a07e0,0x210120f1,0xc8e072c,0x3868f23,0x410b07e1,0x211d210d,0xc8f072e,0x3878f23
    .long 0x411008c2,0x213a212a,0xc9c0730,0x3888f24,0x411108c3,0x21562146,0xc9d0732,0x3898f24
    .long 0x411208c0,0x21722162,0xc9e0734,0x38a8f25,0x411308c1,0x218e217e,0xc9f0736,0x38b8f25
    .long 0x411809a2,0x21ab219b,0xcac0738,0x38c8f26,0x411909a3,0x21c721b7,0xcad073a,0x38d8f26
    .long 0x411a09a0,0x21e321d3,0xcae073c,0x38e8f27,0x411b09a1,0x21ff21ef,0xcaf073e,0x38f8f27
    .long 0x41440a82,0x2058204c,0xcbc0721,0x7008f30,0x41450a83,0x20742068,0xcbd0723,0x7018f30
    .long 0x41460a80,0x20902084,0xcbe0725,0x7028f31,0x41470a81,0x20ac20a0,0xcbf0727,0x7038f31
    .long 0x414c0b62,0x20c920bd,0xccc0729,0x7048f32,0x414d0b63,0x20e520d9,0xccd072b,0x7058f32
    .long 0x414e0b60,0x210120f5,0xcce072d,0x7068f33,0x414f0b61,0x211d2111,0xccf072f,0x7078f33
    .long 0x41540c42,0x213a212e,0xcdc0731,0x7088f34,0x41550c43,0x2156214a,0xcdd0733,0x7098f34
    .long 0x41560c40,0x21722166,0xcde0735,0x70a8f35,0x41570c41,0x218e2182,0xcdf0737,0x70b8f35
    .long 0x415c0d22,0x21ab219f,0xcdc0739,0x70c8f36,0x415d0d23,0x21c721bb,0xcdd073b,0x70d8f36
    .long 0x415e0d20,0x21e321d7,0xcde073d,0x70e8f37,0x415f0d21,0x21ff21f3,0xcdf073f,0x70f8f37
    .long 0x3000ee0,0x2bc0380,0xc01fc,0x8800300,0x3010ee1,0x3bd0381,0xc01fd,0x8810301
    .long 0x3040ee2,0x2be0384,0xc01fe,0x8820302,0x3050ee3,0x3bf0385,0xc01ff,0x8830303
    .long 0x3080ee4,0x2c00388,0xc0200,0x8840304,0x3090ee5,0x3c10389,0xc0201,0x8850305
    .long 0x30c0ee6,0x2c2038c,0xc0202,0x8860306,0x30d0ee7,0x3c3038d,0xc0203,0x8870307
    .long 0x80000ee8,0x2bd8000,0xc023c,0x8880308,0x80000ee9,0x3be8000,0xc023d,0x8890309
    .long 0x80000eea,0x2bf8000,0xc023e,0x88a030a,0x80000eeb,0x3c08000,0xc023f,0x88b030b
    .long 0x80000eec,0x2c18000,0xc0240,0x88c030c,0x80000eed,0x3c28000,0xc0241,0x88d030d
    .long 0x80000eee,0x2c38000,0xc0242,0x88e030e,0x80000eef,0x3c48000,0xc0243,0x88f030f
    .long 0x3200ef0,0x2c403a0,0xc0204,0x8900310,0x3210ef1,0x3c503a1,0xc0205,0x8910311
    .long 0x3240ef2,0x2c603a4,0xc0206,0x8920312,0x3250ef3,0x3c703a5,0xc0207,0x8930313
    .long 0x3280ef4,0x2c803a8,0xc0208,0x8940314,0x3290ef5,0x3c903a9,0xc0209,0x8950315
    .long 0x32c0ef6,0x2ca03ac,0xc020a,0x8960316,0x32d0ef7,0x3cb03ad,0xc020b,0x8970317
    .long 0x3300ef8,0x2c503b0,0xc0244,0x8980318,0x3310ef9,0x3c603b1,0xc0245,0x8990319
    .long 0x3340efa,0x2c703b4,0xc0246,0x89a031a,0x3350efb,0x3c803b5,0xc0247,0x89b031b
    .long 0x3380efc,0x2c903b8,0xc0248,0x89c031c,0x3390efd,0x3ca03b9,0xc0249,0x89d031d
    .long 0x33c0efe,0x2cb03bc,0xc024a,0x89e031e,0x33d0eff,0x3cc03bd,0xc024b,0x89f031f
    .long 0x3400f00,0x2cc03c0,0xc020c,0x8800340,0x3410f01,0x3cd03c1,0xc020d,0x8810341
    .long 0x3440f02,0x2ce03c4,0xc020e,0x8820342,0x3450f03,0x3cf03c5,0xc020f,0x8830343
    .long 0x3480f04,0x2d003c8,0xc0210,0x8840344,0x3490f05,0x3d103c9,0xc0211,0x8850345
    .long 0x34c0f06,0x2d203cc,0xc0212,0x8860346,0x34d0f07,0x3d303cd,0xc0213,0x8870347
    .long 0x3500f08,0x2cd03d0,0xc024c,0x8880348,0x3510f09,0x3ce03d1,0xc024d,0x8890349
    .long 0x3540f0a,0x2cf03d4,0xc024e,0x88a034a,0x3550f0b,0x3d003d5,0xc024f,0x88b034b
    .long 0x3580f0c,0x2d103d8,0xc0250,0x88c034c,0x3590f0d,0x3d203d9,0xc0251,0x88d034d
    .long 0x35c0f0e,0x2d303dc,0xc0252,0x88e034e,0x35d0f0f,0x3d403dd,0xc0253,0x88f034f
    .long 0x3600f10,0x2d403e0,0xc0214,0x8900350,0x3610f11,0x3d503e1,0xc0215,0x8910351
    .long 0x3640f12,0x2d603e4,0xc0216,0x8920352,0x3650f13,0x3d703e5,0xc0217,0x8930353
    .long 0x3680f14,0x2d803e8,0xc0218,0x8940354,0x3690f15,0x3d903e9,0xc0219,0x8950355
    .long 0x36c0f16,0x2da03ec,0xc021a,0x8960356,0x36d0f17,0x3db03ed,0xc021b,0x8970357
    .long 0x3700f17,0x2d503f0,0xc0254,0x8980358,0x3710f17,0x3d603f1,0xc0255,0x8990359
    .long 0x3740f17,0x2d703f4,0xc0256,0x89a035a,0x3750f17,0x3d803f5,0xc0257,0x89b035b
    .long 0x3780f17,0x2d903f8,0xc0258,0x89c035c,0x3790f17,0x3da03f9,0xc0259,0x89d035d
    .long 0x37c0f17,0x2db03fc,0xc025a,0x89e035e,0x37d0f17,0x3dc03fd,0xc025b,0x89f035f
    .long 0x3f80,0xbf800000,0xbf80,0x3f800000,0x3f80,0xbf7f3dc9,0xbe48bf7b,0x3f75be95
    .long 0x3f80,0xbf7b3e48,0xbec4bf6d,0x3f55bf0e,0x3f80,0xbf753e95,0xbf0ebf55,0x3f22bf46
    .long 0x3f80,0xbf6d3ec4,0xbf35bf35,0x3ec4bf6d,0x3f80,0xbf623ef1,0xbf55bf0e,0x3dc9bf7f
    .long 0x3f80,0xbf553f0e,0xbf6dbec4,0xbe48bf7b,0x3f80,0xbf463f22,0xbf7bbe48,0xbef1bf62
    .long 0x3f80,0xbf353f35,0xbf800000,0xbf35bf35,0x3f80,0xbf223f46,0xbf7b3e48,0xbf62bef1
    .long 0x3f80,0xbf0e3f55,0xbf6d3ec4,0xbf7bbe48,0x3f80,0xbef13f62,0xbf553f0e,0xbf7f3dc9
    .long 0x3f80,0xbec43f6d,0xbf353f35,0xbf6d3ec4,0x3f80,0xbe953f75,0xbf0e3f55,0xbf463f22
    .long 0x3f80,0xbe483f7b,0xbec43f6d,0xbf0e3f55,0x3f80,0xbdc93f7f,0xbe483f7b,0xbe953f75
    .long 0x3f80,0xbf800000,0xbf80,0x3f800000,0x3ec43f6d,0xbf623ef1,0xbf0ebf55,0x3f46bf22
    .long 0x3f353f35,0xbf0e3f55,0xbf6dbec4,0x3e48bf7b,0x3f6d3ec4,0xbdc93f7f,0xbf7b3e48,0xbef1bf62
    .long 0x3f800000,0x3ec43f6d,0xbf353f35,0xbf6dbec4,0x3f6dbec4,0x3f463f22,0xbe483f7b,0xbf753e95
    .long 0x3f35bf35,0x3f7b3e48,0x3ec43f6d,0xbf0e3f55,0x3ec4bf6d,0x3f75be95,0x3f553f0e,0x3dc93f7f
    .long 0xbf80,0x3f35bf35,0x3f800000,0x3f353f35,0xbec4bf6d,0x3e95bf75,0x3f55bf0e,0x3f7f3dc9
    .long 0xbf35bf35,0xbe48bf7b,0x3ec4bf6d,0x3f55bf0e,0xbf6dbec4,0xbf22bf46,0xbe48bf7b,0x3e95bf75
    .long 0xbf800000,0xbf6dbec4,0xbf35bf35,0xbec4bf6d,0xbf6d3ec4,0xbf7f3dc9,0xbf7bbe48,0xbf62bef1
    .long 0xbf353f35,0xbf553f0e,0xbf6d3ec4,0xbf7b3e48,0xbec43f6d,0xbef13f62,0xbf0e3f55,0xbf223f46
    .long 0x3f80,0xbf800000,0xbf80,0x3f800000,0x3f353f35,0xbf223f46,0xbf55bf0e,0x3ef1bf62
    .long 0x3f800000,0x3e483f7b,0xbf6d3ec4,0xbf0ebf55,0x3f35bf35,0x3f623ef1,0xbe483f7b,0xbf7f3dc9
    .long 0xbf80,0x3f6dbec4,0x3f353f35,0xbec43f6d,0xbf35bf35,0x3e95bf75,0x3f7bbe48,0x3f223f46
    .long 0xbf800000,0xbf0ebf55,0x3ec4bf6d,0x3f7bbe48,0xbf353f35,0xbf7fbdc9,0xbf0ebf55,0x3e95bf75
    .long 0x3f80,0xbf353f35,0xbf800000,0xbf35bf35,0x3f353f35,0x3dc93f7f,0xbf0e3f55,0xbf753e95
    .long 0x3f800000,0x3f553f0e,0x3ec43f6d,0xbe483f7b,0x3f35bf35,0x3f75be95,0x3f7b3e48,0x3f463f22
    .long 0xbf80,0x3ec4bf6d,0x3f35bf35,0x3f6dbec4,0xbf35bf35,0xbef1bf62,0xbe48bf7b,0x3dc9bf7f
    .long 0xbf800000,0xbf7bbe48,0xbf6dbec4,0xbf55bf0e,0xbf353f35,0xbf463f22,0xbf553f0e,0xbf623ef1
    .long 0x3f80,0xbf800000,0xbf80,0x3f800000,0x3f6d3ec4,0xbe953f75,0xbf7bbe48,0x3dc9bf7f
    .long 0x3f35bf35,0x3f553f0e,0xbec43f6d,0xbf7bbe48,0xbec4bf6d,0x3f46bf22,0x3f553f0e,0xbe953f75
    .long 0xbf800000,0xbec4bf6d,0x3f35bf35,0x3f6d3ec4,0xbec43f6d,0xbf7f3dc9,0xbf0ebf55,0x3ef1bf62
    .long 0x3f353f35,0xbe483f7b,0xbf6d3ec4,0xbf55bf0e,0x3f6dbec4,0x3f623ef1,0x3e483f7b,0xbf223f46
    .long 0xbf80,0x3f35bf35,0x3f800000,0x3f353f35,0xbf6dbec4,0xbef1bf62,0x3e48bf7b,0x3f46bf22
    .long 0xbf353f35,0xbf7b3e48,0xbf6dbec4,0xbf0ebf55,0x3ec43f6d,0xbdc93f7f,0xbf0e3f55,0xbf623ef1
    .long 0x3f800000,0x3f6d3ec4,0x3f353f35,0x3ec43f6d,0x3ec4bf6d,0x3f22bf46,0x3f55bf0e,0x3f75be95
    .long 0xbf35bf35,0xbf0ebf55,0xbec4bf6d,0xbe48bf7b,0xbf6d3ec4,0xbf753e95,0xbf7b3e48,0xbf7f3dc9
    .long 0x3f80,0xbf800000,0xbf80,0x3f800000,0x3f800000,0x3dc93f7f,0xbf7b3e48,0xbe95bf75
    .long 0xbf80,0x3f7bbe48,0x3ec43f6d,0xbf553f0e,0xbf800000,0xbe95bf75,0x3f55bf0e,0x3f463f22
    .long 0x3f80,0xbf6d3ec4,0xbf35bf35,0x3ec4bf6d,0x3f800000,0x3ef13f62,0xbf0e3f55,0xbf7fbdc9
    .long 0xbf80,0x3f55bf0e,0x3f6d3ec4,0x3e483f7b,0xbf800000,0xbf22bf46,0x3e48bf7b,0x3f62bef1
    .long 0x3f80,0xbf353f35,0xbf800000,0xbf35bf35,0x3f800000,0x3f463f22,0x3e483f7b,0xbef13f62
    .long 0xbf80,0x3f0ebf55,0x3f6dbec4,0x3f7b3e48,0xbf800000,0xbf62bef1,0xbf0ebf55,0xbdc9bf7f
    .long 0x3f80,0xbec43f6d,0xbf353f35,0xbf6d3ec4,0x3f800000,0x3f753e95,0x3f553f0e,0x3f223f46
    .long 0xbf80,0x3e48bf7b,0x3ec4bf6d,0x3f0ebf55,0xbf800000,0xbf7fbdc9,0xbf7bbe48,0xbf75be95
    .long 0x3f80,0xbf800000,0xbf80,0x3f800000,0x3f6dbec4,0x3ef13f62,0xbf553f0e,0xbf22bf46
    .long 0xbf35bf35,0x3f0ebf55,0x3f6d3ec4,0xbe483f7b,0xbec43f6d,0xbf7fbdc9,0xbe48bf7b,0x3f62bef1
    .long 0x3f800000,0x3ec43f6d,0xbf353f35,0xbf6dbec4,0xbec4bf6d,0x3f22bf46,0x3f7b3e48,0x3e953f75
    .long 0xbf353f35,0xbf7bbe48,0xbec4bf6d,0x3f0ebf55,0x3f6d3ec4,0x3e953f75,0xbf0e3f55,0xbf7f3dc9
    .long 0xbf80,0x3f35bf35,0x3f800000,0x3f353f35,0xbf6d3ec4,0xbf75be95,0xbf0ebf55,0x3dc9bf7f
    .long 0x3f353f35,0x3e483f7b,0xbec43f6d,0xbf553f0e,0x3ec4bf6d,0x3f46bf22,0x3f7bbe48,0x3f753e95
    .long 0xbf800000,0xbf6dbec4,0xbf35bf35,0xbec4bf6d,0x3ec43f6d,0x3dc93f7f,0xbe483f7b,0xbef13f62
    .long 0x3f35bf35,0x3f55bf0e,0x3f6dbec4,0x3f7bbe48,0xbf6dbec4,0xbf62bef1,0xbf55bf0e,0xbf46bf22
    .long 0x3f80,0xbf800000,0xbf80,0x3f800000,0x3f35bf35,0x3f463f22,0xbf0e3f55,0xbf62bef1
    .long 0xbf800000,0xbe48bf7b,0x3f6dbec4,0x3f0e3f55,0x3f353f35,0xbef13f62,0xbf7bbe48,0xbdc9bf7f
    .long 0xbf80,0x3f6dbec4,0x3f353f35,0xbec43f6d,0xbf353f35,0xbf75be95,0xbe48bf7b,0x3f46bf22
    .long 0x3f800000,0x3f0e3f55,0xbec43f6d,0xbf7b3e48,0xbf35bf35,0x3dc9bf7f,0x3f55bf0e,0x3f753e95
    .long 0x3f80,0xbf353f35,0xbf800000,0xbf35bf35,0x3f35bf35,0x3f7fbdc9,0x3f553f0e,0x3e953f75
    .long 0xbf800000,0xbf55bf0e,0xbec4bf6d,0x3e48bf7b,0x3f353f35,0x3e953f75,0xbe483f7b,0xbf223f46
    .long 0xbf80,0x3ec4bf6d,0x3f35bf35,0x3f6dbec4,0xbf353f35,0xbf623ef1,0xbf7b3e48,0xbf7fbdc9
    .long 0x3f800000,0x3f7b3e48,0x3f6d3ec4,0x3f553f0e,0xbf35bf35,0xbf22bf46,0xbf0ebf55,0xbef1bf62
    .long 0x3f80,0xbf800000,0xbf80,0x3f800000,0x3ec4bf6d,0x3f753e95,0xbe483f7b,0xbf7fbdc9
    .long 0xbf353f35,0xbf55bf0e,0x3ec4bf6d,0x3f7b3e48,0x3f6dbec4,0x3f223f46,0xbf0e3f55,0xbf75be95
    .long 0xbf800000,0xbec4bf6d,0x3f35bf35,0x3f6d3ec4,0x3f6d3ec4,0x3dc93f7f,0xbf553f0e,0xbf62bef1
    .long 0xbf35bf35,0x3e48bf7b,0x3f6dbec4,0x3f553f0e,0x3ec43f6d,0xbef13f62,0xbf7b3e48,0xbf46bf22
    .long 0xbf80,0x3f35bf35,0x3f800000,0x3f353f35,0xbec43f6d,0xbf623ef1,0xbf7bbe48,0xbf22bf46
    .long 0x3f35bf35,0x3f7bbe48,0x3f6d3ec4,0x3f0e3f55,0xbf6d3ec4,0xbf7fbdc9,0xbf55bf0e,0xbef1bf62
    .long 0x3f800000,0x3f6d3ec4,0x3f353f35,0x3ec43f6d,0xbf6dbec4,0xbf46bf22,0xbf0ebf55,0xbe95bf75
    .long 0x3f353f35,0x3f0e3f55,0x3ec43f6d,0x3e483f7b,0xbec4bf6d,0xbe95bf75,0xbe48bf7b,0xbdc9bf7f
    .long 0x0,0x0,0x0,0x0,0xbdc9bdc9,0xbf46bf46,0xbef1bef1,0xbf75bf75
    .long 0xbe48be48,0xbf7bbf7b,0xbf55bf55,0xbf0ebf0e,0xbe95be95,0xbef1bef1,0xbf7fbf7f,0x3f223f22
    .long 0xbec4bec4,0x3ec43ec4,0xbf6dbf6d,0x3f6d3f6d,0xbef1bef1,0x3f753f75,0xbf22bf22,0xbdc9bdc9
    .long 0xbf0ebf0e,0x3f553f55,0xbe48be48,0xbf7bbf7b,0xbf22bf22,0x3dc93dc9,0x3e953e95,0xbef1bef1
    .long 0xbf35bf35,0xbf35bf35,0x3f353f35,0x3f353f35,0xbf46bf46,0xbf7fbf7f,0x3f753f75,0x3f623f62
    .long 0xbf55bf55,0xbf0ebf0e,0x3f7b3f7b,0xbe48be48,0xbf62bf62,0x3e953e95,0x3f463f46,0xbf7fbf7f
    .long 0xbf6dbf6d,0x3f6d3f6d,0x3ec43ec4,0xbec4bec4,0xbf75bf75,0x3f623f62,0xbdc9bdc9,0x3f463f46
    .long 0xbf7bbf7b,0x3e483e48,0xbf0ebf0e,0x3f553f55,0xbf7fbf7f,0xbf22bf22,0xbf62bf62,0xbe95be95
    .long 0x0,0x0,0x0,0x0,0xbf7fbf7f,0xbf22bf22,0xbf62bf62,0xbe95be95
    .long 0x3e483e48,0x3f7b3f7b,0x3f553f55,0x3f0e3f0e,0x3f753f75,0xbf62bf62,0x3dc93dc9,0xbf46bf46
    .long 0xbec4bec4,0x3ec43ec4,0xbf6dbf6d,0x3f6d3f6d,0xbf62bf62,0x3e953e95,0x3f463f46,0xbf7fbf7f
    .long 0x3f0e3f0e,0xbf55bf55,0x3e483e48,0x3f7b3f7b,0x3f463f46,0x3f7f3f7f,0xbf75bf75,0xbf62bf62
    .long 0xbf35bf35,0xbf35bf35,0x3f353f35,0x3f353f35,0xbf22bf22,0x3dc93dc9,0x3e953e95,0xbef1bef1
    .long 0x3f553f55,0x3f0e3f0e,0xbf7bbf7b,0x3e483e48,0x3ef13ef1,0xbf75bf75,0x3f223f22,0x3dc93dc9
    .long 0xbf6dbf6d,0x3f6d3f6d,0x3ec43ec4,0xbec4bec4,0xbe95be95,0xbef1bef1,0xbf7fbf7f,0x3f223f22
    .long 0x3f7b3f7b,0xbe48be48,0x3f0e3f0e,0xbf55bf55,0x3dc93dc9,0x3f463f46,0x3ef13ef1,0x3f753f75
    .long 0x0,0x0,0x0,0x0,0x3e953e95,0x3f623f62,0x3f223f22,0x3f7f3f7f
    .long 0x3f0e3f0e,0x3f553f55,0x3f7b3f7b,0x3e483e48,0x3f463f46,0xbdc9bdc9,0x3f623f62,0xbf75bf75
    .long 0x3f6d3f6d,0xbf6dbf6d,0x3ec43ec4,0xbec4bec4,0x3f7f3f7f,0xbf46bf46,0xbe95be95,0x3f623f62
    .long 0x3f7b3f7b,0x3e483e48,0xbf55bf55,0x3f0e3f0e,0x3f623f62,0x3f753f75,0xbf7fbf7f,0xbf46bf46
    .long 0x3f353f35,0x3f353f35,0xbf35bf35,0xbf35bf35,0x3ef13ef1,0xbe95be95,0xbdc9bdc9,0x3f223f22
    .long 0x3e483e48,0xbf7bbf7b,0x3f0e3f0e,0x3f553f55,0xbdc9bdc9,0xbf22bf22,0x3f753f75,0xbef1bef1
    .long 0xbec4bec4,0x3ec43ec4,0x3f6d3f6d,0xbf6dbf6d,0xbf22bf22,0x3f7f3f7f,0x3ef13ef1,0x3e953e95
    .long 0xbf55bf55,0x3f0e3f0e,0xbe48be48,0x3f7b3f7b,0xbf75bf75,0xbef1bef1,0xbf46bf46,0xbdc9bdc9
    .long 0x0,0x0,0x0,0x0,0x3f753f75,0x3ef13ef1,0x3f463f46,0x3dc93dc9
    .long 0xbf0ebf0e,0xbf55bf55,0xbf7bbf7b,0xbe48be48,0xbf22bf22,0x3f7f3f7f,0x3ef13ef1,0x3e953e95
    .long 0x3f6d3f6d,0xbf6dbf6d,0x3ec43ec4,0xbec4bec4,0x3dc93dc9,0x3f223f22,0xbf75bf75,0x3ef13ef1
    .long 0xbf7bbf7b,0xbe48be48,0x3f553f55,0xbf0ebf0e,0x3ef13ef1,0xbe95be95,0xbdc9bdc9,0x3f223f22
    .long 0x3f353f35,0x3f353f35,0xbf35bf35,0xbf35bf35,0xbf62bf62,0xbf75bf75,0x3f7f3f7f,0x3f463f46
    .long 0xbe48be48,0x3f7b3f7b,0xbf0ebf0e,0xbf55bf55,0x3f7f3f7f,0xbf46bf46,0xbe95be95,0x3f623f62
    .long 0xbec4bec4,0x3ec43ec4,0x3f6d3f6d,0xbf6dbf6d,0xbf46bf46,0x3dc93dc9,0xbf62bf62,0x3f753f75
    .long 0x3f553f55,0xbf0ebf0e,0x3e483e48,0xbf7bbf7b,0x3e953e95,0x3f623f62,0x3f223f22,0x3f7f3f7f
    .long 0x3f80bf80,0x3f80bf80,0x3f80bf80,0x3f80bf80,0x3f7fbf7f,0x3f22bf22,0x3f62bf62,0x3e95be95
    .long 0x3f7bbf7b,0xbe483e48,0x3f0ebf0e,0xbf553f55,0x3f75bf75,0xbf623f62,0x3dc9bdc9,0xbf463f46
    .long 0x3f6dbf6d,0xbf6d3f6d,0xbec43ec4,0x3ec4bec4,0x3f62bf62,0xbe953e95,0xbf463f46,0x3f7fbf7f
    .long 0x3f55bf55,0x3f0ebf0e,0xbf7b3f7b,0x3e48be48,0x3f46bf46,0x3f7fbf7f,0xbf753f75,0xbf623f62
    .long 0x3f35bf35,0x3f35bf35,0xbf353f35,0xbf353f35,0x3f22bf22,0xbdc93dc9,0xbe953e95,0x3ef1bef1
    .long 0x3f0ebf0e,0xbf553f55,0x3e48be48,0x3f7bbf7b,0x3ef1bef1,0xbf753f75,0x3f22bf22,0x3dc9bdc9
    .long 0x3ec4bec4,0xbec43ec4,0x3f6dbf6d,0xbf6d3f6d,0x3e95be95,0x3ef1bef1,0x3f7fbf7f,0xbf223f22
    .long 0x3e48be48,0x3f7bbf7b,0x3f55bf55,0x3f0ebf0e,0x3dc9bdc9,0x3f46bf46,0x3ef1bef1,0x3f75bf75
    .long 0x3f80bf80,0x3f80bf80,0x3f80bf80,0x3f80bf80,0xbdc93dc9,0xbf463f46,0xbef13ef1,0xbf753f75
    .long 0xbf7b3f7b,0x3e48be48,0xbf0e3f0e,0x3f55bf55,0x3e95be95,0x3ef1bef1,0x3f7fbf7f,0xbf223f22
    .long 0x3f6dbf6d,0xbf6d3f6d,0xbec43ec4,0x3ec4bec4,0xbef13ef1,0x3f75bf75,0xbf223f22,0xbdc93dc9
    .long 0xbf553f55,0xbf0e3f0e,0x3f7bbf7b,0xbe483e48,0x3f22bf22,0xbdc93dc9,0xbe953e95,0x3ef1bef1
    .long 0x3f35bf35,0x3f35bf35,0xbf353f35,0xbf353f35,0xbf463f46,0xbf7f3f7f,0x3f75bf75,0x3f62bf62
    .long 0xbf0e3f0e,0x3f55bf55,0xbe483e48,0xbf7b3f7b,0x3f62bf62,0xbe953e95,0xbf463f46,0x3f7fbf7f
    .long 0x3ec4bec4,0xbec43ec4,0x3f6dbf6d,0xbf6d3f6d,0xbf753f75,0x3f62bf62,0xbdc93dc9,0x3f46bf46
    .long 0xbe483e48,0xbf7b3f7b,0xbf553f55,0xbf0e3f0e,0x3f7fbf7f,0x3f22bf22,0x3f62bf62,0x3e95be95
    .long 0xbf803f80,0xbf803f80,0xbf803f80,0xbf803f80,0xbf753f75,0xbef13ef1,0xbf463f46,0xbdc93dc9
    .long 0xbf553f55,0x3f0ebf0e,0xbe483e48,0x3f7bbf7b,0xbf223f22,0x3f7fbf7f,0x3ef1bef1,0x3e95be95
    .long 0xbec43ec4,0x3ec4bec4,0x3f6dbf6d,0xbf6d3f6d,0xbdc93dc9,0xbf223f22,0x3f75bf75,0xbef13ef1
    .long 0x3e48be48,0xbf7b3f7b,0x3f0ebf0e,0x3f55bf55,0x3ef1bef1,0xbe953e95,0xbdc93dc9,0x3f22bf22
    .long 0x3f35bf35,0x3f35bf35,0xbf353f35,0xbf353f35,0x3f62bf62,0x3f75bf75,0xbf7f3f7f,0xbf463f46
    .long 0x3f7bbf7b,0x3e48be48,0xbf553f55,0x3f0ebf0e,0x3f7fbf7f,0xbf463f46,0xbe953e95,0x3f62bf62
    .long 0x3f6dbf6d,0xbf6d3f6d,0x3ec4bec4,0xbec43ec4,0x3f46bf46,0xbdc93dc9,0x3f62bf62,0xbf753f75
    .long 0x3f0ebf0e,0x3f55bf55,0x3f7bbf7b,0x3e48be48,0x3e95be95,0x3f62bf62,0x3f22bf22,0x3f7fbf7f
    .long 0xbf803f80,0xbf803f80,0xbf803f80,0xbf803f80,0x3e95be95,0x3f62bf62,0x3f22bf22,0x3f7fbf7f
    .long 0x3f55bf55,0xbf0e3f0e,0x3e48be48,0xbf7b3f7b,0xbf463f46,0x3dc9bdc9,0xbf623f62,0x3f75bf75
    .long 0xbec43ec4,0x3ec4bec4,0x3f6dbf6d,0xbf6d3f6d,0x3f7fbf7f,0xbf463f46,0xbe953e95,0x3f62bf62
    .long 0xbe483e48,0x3f7bbf7b,0xbf0e3f0e,0xbf553f55,0xbf623f62,0xbf753f75,0x3f7fbf7f,0x3f46bf46
    .long 0x3f35bf35,0x3f35bf35,0xbf353f35,0xbf353f35,0x3ef1bef1,0xbe953e95,0xbdc93dc9,0x3f22bf22
    .long 0xbf7b3f7b,0xbe483e48,0x3f55bf55,0xbf0e3f0e,0x3dc9bdc9,0x3f22bf22,0xbf753f75,0x3ef1bef1
    .long 0x3f6dbf6d,0xbf6d3f6d,0x3ec4bec4,0xbec43ec4,0xbf223f22,0x3f7fbf7f,0x3ef1bef1,0x3e95be95
    .long 0xbf0e3f0e,0xbf553f55,0xbf7b3f7b,0xbe483e48,0x3f75bf75,0x3ef1bef1,0x3f46bf46,0x3dc9bdc9
L_last:
    .long 0
.size L_ct, L_last-L_ct+4
.section .rodata,"a"
.p2align 6
.amdhsa_kernel adaLN_cond__spectral_gfnet__glu_gated_reglu__prompt_kernel
  .amdhsa_next_free_vgpr 512
  .amdhsa_next_free_sgpr 102
  .amdhsa_accum_offset 256
  .amdhsa_group_segment_fixed_size 0
  .amdhsa_kernarg_size 96
  .amdhsa_user_sgpr_count 2
  .amdhsa_user_sgpr_kernarg_segment_ptr 1
  .amdhsa_system_sgpr_workgroup_id_x 1
  .amdhsa_float_denorm_mode_32 3
  .amdhsa_float_denorm_mode_16_64 3
.end_amdhsa_kernel
```
